```python
import torch

def _softmax(x, axis=-1):
    return torch.softmax(x, dim=axis)
def _gelu(x):
    return torch.nn.functional.gelu(x, approximate="tanh")
def _silu(x):
    return torch.nn.functional.silu(x)
def _sigmoid(x):
    return torch.sigmoid(x)
def _layernorm(x, axis=-1, eps=1e-5):
    m = x.mean(dim=axis, keepdim=True)
    v = x.var(dim=axis, keepdim=True, unbiased=False)
    return (x - m) / torch.sqrt(v + eps)
def _scatter_add(tgt, idx, src, axis=0):
    return tgt.clone().index_add_(axis, idx, src)
def _segment_sum(src, seg, n):
    out = torch.zeros((n,) + src.shape[1:], dtype=src.dtype)
    return out.index_add_(0, seg, src)
def _pad(x, pw):
    flat = tuple(v for pair in reversed(pw) for v in pair)
    return torch.nn.functional.pad(x, flat)

kernel_name = 'interleave_layers__ssm_conv_h3__glu_gated_reglu__prompt'

def setup_inputs():

    _w = (lambda a: (lambda t: t.to(torch.bfloat16) if t.is_floating_point() else t)(torch.as_tensor(a)))
    def _A_setup():
        B, S, D = 1, 2048, 640
        ks = 4
        return {
            "q": _w((lambda *s: torch.randn(*s, dtype=torch.bfloat16) * 0.05)(B, S, D)),
            "k": _w((lambda *s: torch.randn(*s, dtype=torch.bfloat16) * 0.2)(B, S, D)),
            "v": _w((lambda *s: torch.randn(*s, dtype=torch.bfloat16) * 0.2)(B, S, D)),
            "shift_k": _w((lambda *s: torch.randn(*s, dtype=torch.bfloat16) * 0.2)(D, ks) * 0.5),
            "ssm_k": _w((lambda *s: torch.randn(*s, dtype=torch.bfloat16) * 0.8)(D, S) * (1.0 / S ** 0.5)),
            "ssm_D": _w((lambda *s: torch.randn(*s, dtype=torch.bfloat16) * 0.2)(D)),
        }
    _A_in = _A_setup()

    def _B_setup():
        B, S, D, F = 1, 2048, 640, 1536
        return {
            "x": _w((lambda *s: torch.randn(*s, dtype=torch.bfloat16) * 0.05)(B, S, D)),
            "W_gate": _w((lambda *s: torch.randn(*s, dtype=torch.bfloat16) * 0.4)(D, F) * (2.0 / D) ** 0.5),
            "W_up": _w((lambda *s: torch.randn(*s, dtype=torch.bfloat16) * 0.4)(D, F) * (2.0 / D) ** 0.5),
            "W_down": _w((lambda *s: torch.randn(*s, dtype=torch.bfloat16) * 0.4)(F, D) * (1.0 / F) ** 0.5),
        }
    _B_in = _B_setup()

    return {
        "A_q": _A_in["q"],
        "A_k": _A_in["k"],
        "A_v": _A_in["v"],
        "A_shift_k": _A_in["shift_k"],
        "A_ssm_k": _A_in["ssm_k"],
        "A_ssm_D": _A_in["ssm_D"],
        "B_x": _B_in["x"],
        "B_W_gate": _B_in["W_gate"],
        "B_W_up": _B_in["W_up"],
        "B_W_down": _B_in["W_down"],
    }

def reference(A_q, A_k, A_v, A_shift_k, A_ssm_k, A_ssm_D, B_x, B_W_gate, B_W_up, B_W_down):
    def _A_ref(q, k, v, shift_k, ssm_k, ssm_D):
        B, S, D = q.shape
        ks = shift_k.shape[-1]
        k_pad = _pad(k, ((0, 0), (ks - 1, 0), (0, 0)))
        k_shift = torch.zeros_like(k)
        for t in range(ks):
            k_shift = k_shift + k_pad[:, t:t + S, :] * shift_k[:, ks - 1 - t][None, None, :]
        kv = k_shift * v
        L = 2 * S
        kv_pad = _pad(kv, ((0, 0), (0, S), (0, 0)))
        kf_pad = _pad(ssm_k, ((0, 0), (0, S)))
        kv_f = (lambda x, axes=(-2,-1): torch.fft.rfft2(x.float(), dim=axes))(kv_pad[:, None, :, :], axes=(1, 2))
        kf_f = (lambda x, axes=(-2,-1): torch.fft.rfft2(x.float(), dim=axes))(kf_pad[:, None, :], axes=(1, 2))
        kf_f = (lambda x, *d: x.permute(*d))(kf_f, 1, 2, 0)
        y_f = kv_f * kf_f[None, :, :, :]
        y = (lambda x, s, axes=(-2,-1): torch.fft.irfft2(x, s=s, dim=axes).to(torch.bfloat16))(y_f, (1, L), axes=(1, 2))[:, 0, :S, :]
        y = y + kv * ssm_D[None, None, :]
        return q * y

    def _B_ref(x, W_gate, W_up, W_down):
        gate = torch.einsum("bsd,df->bsf", x, W_gate)
        up = torch.einsum("bsd,df->bsf", x, W_up)
        gate = gate * (lambda x, dt: x.to(dt))(gate > 0, gate.dtype)
        h = gate * up
        return torch.einsum("bsf,fd->bsd", h, W_down)

    x = A_q
    x = x + _A_ref(_layernorm(x, axis=-1), A_k, A_v, A_shift_k, A_ssm_k, A_ssm_D)
    x = x + _B_ref(_layernorm(x, axis=-1), B_W_gate, B_W_up, B_W_down)
    x = x + _A_ref(_layernorm(x, axis=-1), A_k, A_v, A_shift_k, A_ssm_k, A_ssm_D)
    x = x + _B_ref(_layernorm(x, axis=-1), B_W_gate, B_W_up, B_W_down)
    return x
```

```asm
; @launch grid=(256,1,1) block=(256,1,1) lds=163840
.amdgcn_target "amdgcn-amd-amdhsa--gfx950"
.text
.globl interleave_layers__ssm_conv_h3__glu_gated_reglu__prompt_kernel
.p2align 8
.type interleave_layers__ssm_conv_h3__glu_gated_reglu__prompt_kernel,@function
interleave_layers__ssm_conv_h3__glu_gated_reglu__prompt_kernel:
    s_cmp_ge_u32 s2, 256
    s_cbranch_scc1 L_exit
    s_load_dwordx16 s[36:51], s[0:1], 0
    s_load_dwordx8 s[52:59], s[0:1], 64
    s_load_dwordx2 s[60:61], s[0:1], 96
    s_memrealtime s[84:85]
    v_lshrrev_b32 v1, 6, v0
    s_and_b32 s86, s2, 7
    v_readfirstlane_b32 s62, v1
    v_and_b32 v1, 63, v0
    v_lshlrev_b32 v0, 4, v1
    s_lshr_b32 s87, s2, 5
    s_bfe_u32 s88, s2, 0x20003
    s_and_b32 s69, s62, 1
    s_cmp_eq_u32 s88, 3
    s_cbranch_scc1 L_p0
    s_lshl_b32 s89, s87, 1
    s_add_u32 s89, s89, s88
    s_add_u32 s90, s87, 12
    s_cmp_eq_u32 s88, 2
    s_cselect_b32 s89, s90, s89
    s_cselect_b32 s90, s87, 4
    s_cmp_lt_u32 s90, 4
    s_cbranch_scc1 L_other
    s_mul_i32 s67, s86, 20
    s_add_u32 s67, s67, s89
    s_lshr_b32 s86, s67, 4
    s_and_b32 s87, s67, 15
    s_lshl_b32 s88, s67, 2
    s_add_u32 s88, s88, s62
    v_lshrrev_b32 v1, 7, v0
    v_bfe_u32 v2, v0, 8, 1
    v_bfe_u32 v3, v0, 5, 2
    v_xor_b32 v3, v3, v2
    v_and_b32 v4, 16, v0
    v_mul_u32_u24 v1, 1280, v1
    s_mul_i32 s93, s87, 163840
    s_lshl_b32 s90, s86, 7
    s_add_u32 s93, s93, s90
    v_add3_u32 v1, v1, v4, s93
    s_waitcnt lgkmcnt(0)
    s_mov_b32 s12, s38
    s_mov_b32 s13, s39
    s_mov_b32 s14, 2621440
    s_mov_b32 s15, 0x20000
    s_mov_b32 s16, s40
    s_mov_b32 s17, s41
    s_mov_b32 s18, 2621440
    s_mov_b32 s19, 0x20000
    s_cmp_lg_u32 s62, 0
    s_cbranch_scc1 L_k16_1
    v_lshl_add_u32 v5, v3, 5, v1
    s_mov_b32 m0, 82944
    s_mov_b32 s90, 153600
    buffer_load_dwordx4 v5, s[12:15], s90 offen lds
L_k16_1:
    s_lshl_b32 s90, s69, 1
    v_xor_b32 v3, s90, v3
    v_lshl_add_u32 v1, v3, 5, v1
    s_mul_i32 s90, s62, 10240
    v_add_u32 v1, s90, v1
    v_subrev_u32 v2, 10240, v1
    s_lshl_b32 s91, s62, 10
    s_add_u32 m0, s91, 66560
    s_nop 0
    buffer_load_dwordx4 v2, s[12:15], 0 offen lds
    s_add_u32 m0, s91, 83968
    s_mov_b32 s90, 0
    buffer_load_dwordx4 v1, s[16:19], s90 offen lds
    v_bfe_u32 v8, v0, 4, 4
    s_lshl_b32 s90, s86, 6
    s_lshl_b32 s93, s62, 4
    s_add_u32 s90, s90, s93
    v_add_u32 v8, s90, v8
    v_lshlrev_b32 v9, 3, v8
    global_load_dwordx2 v[14:15], v9, s[42:43]
    s_add_u32 m0, s91, 70656
    v_add_u32 v2, 40960, v2
    buffer_load_dwordx4 v2, s[12:15], 0 offen lds
    s_add_u32 m0, s91, 88064
    s_mov_b32 s90, 40960
    buffer_load_dwordx4 v1, s[16:19], s90 offen lds
    s_add_u32 m0, s91, 74752
    v_add_u32 v2, 40960, v2
    buffer_load_dwordx4 v2, s[12:15], 0 offen lds
    s_add_u32 m0, s91, 92160
    s_mov_b32 s90, 81920
    buffer_load_dwordx4 v1, s[16:19], s90 offen lds
    s_add_u32 m0, s91, 78848
    v_add_u32 v2, 40960, v2
    buffer_load_dwordx4 v2, s[12:15], 0 offen lds
    s_add_u32 m0, s91, 96256
    s_mov_b32 s90, 122880
    buffer_load_dwordx4 v1, s[16:19], s90 offen lds
    s_lshr_b32 s90, s88, 1
    s_lshl_b32 s90, s90, 2
    s_load_dword s71, s[46:47], s90
    s_getpc_b64 s[92:93]
L_pc:
    s_lshl_b32 s90, s89, 2
    s_add_u32 s90, s90, s62
    s_mul_i32 s90, s90, 896
    v_lshl_add_u32 v2, v0, 2, s90
    v_min_u32 v2, L_code_end-interleave_layers__ssm_conv_h3__glu_gated_reglu__prompt_kernel-4, v2
    v_add_u32 v2, interleave_layers__ssm_conv_h3__glu_gated_reglu__prompt_kernel-L_pc, v2
    v_ashrrev_i32 v3, 31, v2
    v_add_co_u32 v2, vcc, s92, v2
    v_mov_b32 v4, s93
    s_nop 0
    v_addc_co_u32 v3, vcc, v4, v3, vcc
    s_mov_b64 exec, 0x3fff
    global_load_dword v21, v[2:3], off
    s_mov_b64 exec, -1
    s_mov_b32 s72, 60000
    s_mov_b32 s70, 0xffff0000
    s_mov_b32 s82, 1120
    s_cmp_eq_u32 s62, 0
    s_cselect_b32 s83, 0, 36175872
    s_lshr_b32 s65, s2, 5
    s_and_b32 s66, s2, 1
    s_lshl_b32 s64, s66, 3
    s_add_u32 s64, s64, s65
    s_bfe_u32 s63, s2, 0x20001
    s_lshl_b32 s63, s63, 2
    s_bfe_u32 s85, s2, 0x20003
    s_add_u32 s63, s63, s85
    s_and_b32 s1, s2, 3
    s_lshl_b32 s1, s1, 2
    s_bfe_u32 s84, s2, 0x20005
    s_add_u32 s1, s1, s84
    s_bfe_u32 s3, s2, 0x10002
    s_lshl_b32 s3, s3, 1
    s_lshr_b32 s84, s2, 7
    s_add_u32 s3, s3, s84
    s_lshl_b32 s3, s3, 2
    s_add_u32 s3, s3, s85
    s_mov_b32 s8, s60
    s_mov_b32 s9, s61
    s_mov_b32 s10, 36175872
    s_mov_b32 s11, 0x20000
    s_cmp_lt_u32 s62, 2
    s_cselect_b32 s20, s50, s52
    s_cselect_b32 s21, s51, s53
    s_mov_b32 s22, 1966080
    s_mov_b32 s23, 0x20000
    s_mov_b32 s24, s54
    s_mov_b32 s25, s55
    s_mov_b32 s26, 1966080
    s_mov_b32 s27, 0x20000
    s_mov_b32 s28, s56
    s_mov_b32 s29, s57
    s_mov_b32 s30, 2621440
    s_mov_b32 s31, 0x20000
    v_lshrrev_b32 v240, 4, v0
    v_add_u32 v240, 0, v240
    v_mul_u32_u24 v245, 43691, v240
    v_lshrrev_b32 v245, 19, v245
    v_mul_u32_u24 v246, 12, v245
    v_sub_u32 v240, v240, v246
    v_bfe_u32 v246, v245, 2, 1
    v_xor_b32 v240, v240, v246
    v_lshlrev_b32 v240, 4, v240
    v_mul_u32_u24 v245, 3072, v245
    v_add_u32 v240, v240, v245
    v_lshrrev_b32 v241, 4, v0
    v_add_u32 v241, 64, v241
    v_mul_u32_u24 v245, 43691, v241
    v_lshrrev_b32 v245, 19, v245
    v_mul_u32_u24 v246, 12, v245
    v_sub_u32 v241, v241, v246
    v_bfe_u32 v246, v245, 2, 1
    v_xor_b32 v241, v241, v246
    v_lshlrev_b32 v241, 4, v241
    v_mul_u32_u24 v245, 3072, v245
    v_add_u32 v241, v241, v245
    v_subrev_u32 v241, 1024, v241
    v_lshrrev_b32 v242, 4, v0
    v_add_u32 v242, 128, v242
    v_mul_u32_u24 v245, 43691, v242
    v_lshrrev_b32 v245, 19, v245
    v_mul_u32_u24 v246, 12, v245
    v_sub_u32 v242, v242, v246
    v_bfe_u32 v246, v245, 2, 1
    v_xor_b32 v242, v242, v246
    v_lshlrev_b32 v242, 4, v242
    v_mul_u32_u24 v245, 3072, v245
    v_add_u32 v242, v242, v245
    v_subrev_u32 v242, 2048, v242
    s_mul_i32 s84, s69, 49152
    s_mul_i32 s85, s1, 192
    s_add_u32 s98, s84, s85
    s_mul_i32 s99, s62, 3072
    s_add_u32 s99, s99, 84992
    v_lshrrev_b32 v245, 6, v0
    v_mul_u32_u24 v245, 192, v245
    v_add_u32 v245, 84992, v245
    v_bfe_u32 v246, v0, 8, 1
    v_bfe_u32 v249, v0, 4, 1
    v_bfe_u32 v250, v0, 5, 1
    s_lshr_b32 s84, s62, 1
    s_lshl_b32 s85, s84, 2
    s_add_u32 s85, s85, s69
    v_lshl_add_u32 v243, v250, 1, s85
    v_xor_b32 v243, v243, v246
    v_lshlrev_b32 v243, 4, v243
    v_lshl_add_u32 v243, v249, 3, v243
    v_add_u32 v243, v243, v245
    s_add_u32 s84, s84, 8
    v_lshl_add_u32 v244, v249, 1, s84
    v_xor_b32 v244, v244, v246
    v_lshlrev_b32 v244, 4, v244
    s_lshl_b32 s85, s69, 3
    v_add_u32 v244, s85, v244
    v_mul_u32_u24 v250, 6144, v250
    v_add3_u32 v244, v244, v250, v245
    s_mul_i32 s84, s69, 12288
    s_sub_u32 s85, 12288, s84
    v_add_u32 v245, s85, v243
    v_add_u32 v243, s84, v243
    v_add_u32 v246, s85, v244
    v_add_u32 v244, s84, v244
    v_bfe_u32 v1, v0, 6, 2
    v_lshrrev_b32 v2, 8, v0
    v_lshl_add_u32 v3, v2, 3, v1
    v_lshlrev_b32 v3, 7, v3
    v_bfe_u32 v4, v0, 4, 2
    v_lshl_add_u32 v3, v4, 3, v3
    v_add_u32 v3, 66560, v3
    v_lshrrev_b32 v1, 1, v1
    v_and_b32 v4, 1, v2
    v_lshl_or_b32 v1, v4, 1, v1
    v_xor_b32 v1, s62, v1
    v_lshl_add_u32 v4, v1, 5, v3
    v_xor_b32 v1, 2, v1
    v_lshl_add_u32 v3, v1, 5, v3
    v_and_b32 v8, 0xfffffff7, v8
    v_lshlrev_b32 v8, 12, v8
    v_lshl_add_u32 v8, v2, 4, v8
    v_bfe_u32 v1, v0, 7, 1
    v_lshl_add_u32 v8, v1, 6, v8
    s_lshl_b32 s90, s87, 8
    v_add_u32 v8, s90, v8
    s_waitcnt vmcnt(4)
    s_barrier
    ds_read_b64_tr_b16 v[24:25], v4 offset:512
    ds_read_b64_tr_b16 v[26:27], v3 offset:1024
    ds_read_b64_tr_b16 v[28:29], v3 offset:1536
    ds_read_b64_tr_b16 v[30:31], v4 offset:17408
    ds_read_b64_tr_b16 v[32:33], v4 offset:17920
    ds_read_b64_tr_b16 v[34:35], v4 offset:4608
    ds_read_b64_tr_b16 v[36:37], v3 offset:5120
    ds_read_b64_tr_b16 v[38:39], v3 offset:5632
    ds_read_b64_tr_b16 v[40:41], v4 offset:21504
    ds_read_b64_tr_b16 v[42:43], v4 offset:22016
    s_mov_b32 s90, 0xffff
    v_alignbit_b32 v16, v14, v14, 16
    v_alignbit_b32 v17, v15, v15, 16
    v_and_b32 v18, s90, v14
    v_bfi_b32 v19, s90, v15, v14
    v_and_b32 v20, s70, v15
    s_mov_b32 s90, 32768
    s_waitcnt lgkmcnt(0)
    v_dot2_f32_bf16 v64, v26, v18, 0
    v_dot2_f32_bf16 v65, v26, v16, 0
    v_dot2_f32_bf16 v66, v27, v18, 0
    v_dot2_f32_bf16 v67, v27, v16, 0
    v_dot2_f32_bf16 v68, v28, v18, 0
    v_dot2_f32_bf16 v69, v28, v16, 0
    v_dot2_f32_bf16 v70, v29, v18, 0
    v_dot2_f32_bf16 v71, v29, v16, 0
    v_dot2_f32_bf16 v64, v25, v19, v64
    v_dot2_f32_bf16 v65, v25, v17, v65
    v_dot2_f32_bf16 v66, v26, v19, v66
    v_dot2_f32_bf16 v67, v26, v17, v67
    v_dot2_f32_bf16 v68, v27, v19, v68
    v_dot2_f32_bf16 v69, v27, v17, v69
    v_dot2_f32_bf16 v70, v28, v19, v70
    v_dot2_f32_bf16 v71, v28, v17, v71
    v_dot2_f32_bf16 v64, v24, v20, v64
    v_dot2_f32_bf16 v66, v25, v20, v66
    v_dot2_f32_bf16 v68, v26, v20, v68
    v_dot2_f32_bf16 v70, v27, v20, v70
    v_lshlrev_b32 v72, 16, v30
    v_and_b32 v73, s70, v30
    v_lshlrev_b32 v74, 16, v31
    v_and_b32 v75, s70, v31
    v_lshlrev_b32 v76, 16, v32
    v_and_b32 v77, s70, v32
    v_lshlrev_b32 v78, 16, v33
    v_and_b32 v79, s70, v33
    v_pk_mul_f32 v[64:65], v[64:65], v[72:73]
    v_pk_mul_f32 v[66:67], v[66:67], v[74:75]
    v_pk_mul_f32 v[68:69], v[68:69], v[76:77]
    v_pk_mul_f32 v[70:71], v[70:71], v[78:79]
    v_cvt_pk_bf16_f32 v80, v64, v65
    v_cvt_pk_bf16_f32 v81, v66, v67
    v_cvt_pk_bf16_f32 v82, v68, v69
    v_cvt_pk_bf16_f32 v83, v70, v71
    s_waitcnt vmcnt(1)
    s_barrier
    ds_read_b64_tr_b16 v[44:45], v4 offset:8704
    ds_read_b64_tr_b16 v[46:47], v3 offset:9216
    ds_read_b64_tr_b16 v[48:49], v3 offset:9728
    ds_read_b64_tr_b16 v[50:51], v4 offset:25600
    ds_read_b64_tr_b16 v[52:53], v4 offset:26112
    ds_read_b64_tr_b16 v[54:55], v4 offset:12800
    ds_read_b64_tr_b16 v[56:57], v3 offset:13312
    ds_read_b64_tr_b16 v[58:59], v3 offset:13824
    ds_read_b64_tr_b16 v[60:61], v4 offset:29696
    ds_read_b64_tr_b16 v[62:63], v4 offset:30208
    s_lshl_b32 s90, s88, 12
    v_sub_u32 v6, 1008, v0
    v_add_u32 v6, s90, v6
    v_lshl_or_b32 v7, v0, 24, s90
    s_mov_b32 s12, s44
    s_mov_b32 s13, s45
    s_mov_b32 s14, 2621440
    s_mov_b32 s15, 0x20000
    buffer_load_dwordx4 v[128:131], v6, s[12:15], 0 offen offset:3072
    buffer_load_dwordx2 v[132:133], v6, s[12:15], 0 offen offset:3088
    buffer_load_dwordx4 v[136:139], v6, s[12:15], 0 offen offset:2048
    buffer_load_dwordx2 v[140:141], v6, s[12:15], 0 offen offset:2064
    buffer_load_dwordx4 v[144:147], v6, s[12:15], 0 offen offset:1024
    buffer_load_dwordx2 v[148:149], v6, s[12:15], 0 offen offset:1040
    buffer_load_dwordx4 v[152:155], v6, s[12:15], 0 offen offset:0
    buffer_load_dwordx2 v[156:157], v6, s[12:15], 0 offen offset:16
    buffer_load_dwordx2 v[164:165], v7, s[12:15], 0 offen
    s_mov_b32 s90, 32768
    v_dot2_f32_bf16 v64, v36, v18, 0
    v_dot2_f32_bf16 v65, v36, v16, 0
    v_dot2_f32_bf16 v66, v37, v18, 0
    v_dot2_f32_bf16 v67, v37, v16, 0
    v_dot2_f32_bf16 v68, v38, v18, 0
    v_dot2_f32_bf16 v69, v38, v16, 0
    v_dot2_f32_bf16 v70, v39, v18, 0
    v_dot2_f32_bf16 v71, v39, v16, 0
    v_dot2_f32_bf16 v64, v35, v19, v64
    v_dot2_f32_bf16 v65, v35, v17, v65
    v_dot2_f32_bf16 v66, v36, v19, v66
    v_dot2_f32_bf16 v67, v36, v17, v67
    v_dot2_f32_bf16 v68, v37, v19, v68
    v_dot2_f32_bf16 v69, v37, v17, v69
    v_dot2_f32_bf16 v70, v38, v19, v70
    v_dot2_f32_bf16 v71, v38, v17, v71
    v_dot2_f32_bf16 v64, v34, v20, v64
    v_dot2_f32_bf16 v66, v35, v20, v66
    v_dot2_f32_bf16 v68, v36, v20, v68
    v_dot2_f32_bf16 v70, v37, v20, v70
    v_lshlrev_b32 v72, 16, v40
    v_and_b32 v73, s70, v40
    v_lshlrev_b32 v74, 16, v41
    v_and_b32 v75, s70, v41
    v_lshlrev_b32 v76, 16, v42
    v_and_b32 v77, s70, v42
    v_lshlrev_b32 v78, 16, v43
    v_and_b32 v79, s70, v43
    v_pk_mul_f32 v[64:65], v[64:65], v[72:73]
    v_pk_mul_f32 v[66:67], v[66:67], v[74:75]
    v_pk_mul_f32 v[68:69], v[68:69], v[76:77]
    v_pk_mul_f32 v[70:71], v[70:71], v[78:79]
    v_cvt_pk_bf16_f32 v84, v64, v65
    v_cvt_pk_bf16_f32 v85, v66, v67
    v_cvt_pk_bf16_f32 v86, v68, v69
    v_cvt_pk_bf16_f32 v87, v70, v71
    v_mov_b32 v72, v80
    v_mov_b32 v73, v81
    v_mov_b32 v74, v82
    v_mov_b32 v75, v83
    v_mov_b32_dpp v80, v84 row_ror:8 row_mask:0xf bank_mask:0xc
    v_mov_b32_dpp v81, v85 row_ror:8 row_mask:0xf bank_mask:0xc
    v_mov_b32_dpp v82, v86 row_ror:8 row_mask:0xf bank_mask:0xc
    v_mov_b32_dpp v83, v87 row_ror:8 row_mask:0xf bank_mask:0xc
    v_mov_b32_dpp v84, v72 row_ror:8 row_mask:0xf bank_mask:0x3
    v_mov_b32_dpp v85, v73 row_ror:8 row_mask:0xf bank_mask:0x3
    v_mov_b32_dpp v86, v74 row_ror:8 row_mask:0xf bank_mask:0x3
    v_mov_b32_dpp v87, v75 row_ror:8 row_mask:0xf bank_mask:0x3
    buffer_store_dwordx4 v[80:83], v8, s[8:11], 0 offen offset:0 sc1
    buffer_store_dwordx4 v[84:87], v8, s[8:11], s90 offen offset:0 sc1
    s_waitcnt lgkmcnt(8)
    v_dot2_f32_bf16 v64, v46, v18, 0
    v_dot2_f32_bf16 v65, v46, v16, 0
    v_dot2_f32_bf16 v66, v47, v18, 0
    v_dot2_f32_bf16 v67, v47, v16, 0
    s_waitcnt lgkmcnt(7)
    v_dot2_f32_bf16 v68, v48, v18, 0
    v_dot2_f32_bf16 v69, v48, v16, 0
    v_dot2_f32_bf16 v70, v49, v18, 0
    v_dot2_f32_bf16 v71, v49, v16, 0
    v_dot2_f32_bf16 v64, v45, v19, v64
    v_dot2_f32_bf16 v65, v45, v17, v65
    v_dot2_f32_bf16 v66, v46, v19, v66
    v_dot2_f32_bf16 v67, v46, v17, v67
    v_dot2_f32_bf16 v68, v47, v19, v68
    v_dot2_f32_bf16 v69, v47, v17, v69
    v_dot2_f32_bf16 v70, v48, v19, v70
    v_dot2_f32_bf16 v71, v48, v17, v71
    v_dot2_f32_bf16 v64, v44, v20, v64
    v_dot2_f32_bf16 v66, v45, v20, v66
    v_dot2_f32_bf16 v68, v46, v20, v68
    v_dot2_f32_bf16 v70, v47, v20, v70
    s_waitcnt lgkmcnt(6)
    v_lshlrev_b32 v72, 16, v50
    v_and_b32 v73, s70, v50
    v_lshlrev_b32 v74, 16, v51
    v_and_b32 v75, s70, v51
    s_waitcnt lgkmcnt(5)
    v_lshlrev_b32 v76, 16, v52
    v_and_b32 v77, s70, v52
    v_lshlrev_b32 v78, 16, v53
    v_and_b32 v79, s70, v53
    v_pk_mul_f32 v[64:65], v[64:65], v[72:73]
    v_pk_mul_f32 v[66:67], v[66:67], v[74:75]
    v_pk_mul_f32 v[68:69], v[68:69], v[76:77]
    v_pk_mul_f32 v[70:71], v[70:71], v[78:79]
    v_cvt_pk_bf16_f32 v88, v64, v65
    v_cvt_pk_bf16_f32 v89, v66, v67
    v_cvt_pk_bf16_f32 v90, v68, v69
    v_cvt_pk_bf16_f32 v91, v70, v71
    s_waitcnt lgkmcnt(3)
    v_dot2_f32_bf16 v64, v56, v18, 0
    v_dot2_f32_bf16 v65, v56, v16, 0
    v_dot2_f32_bf16 v66, v57, v18, 0
    v_dot2_f32_bf16 v67, v57, v16, 0
    s_waitcnt lgkmcnt(2)
    v_dot2_f32_bf16 v68, v58, v18, 0
    v_dot2_f32_bf16 v69, v58, v16, 0
    v_dot2_f32_bf16 v70, v59, v18, 0
    v_dot2_f32_bf16 v71, v59, v16, 0
    v_dot2_f32_bf16 v64, v55, v19, v64
    v_dot2_f32_bf16 v65, v55, v17, v65
    v_dot2_f32_bf16 v66, v56, v19, v66
    v_dot2_f32_bf16 v67, v56, v17, v67
    v_dot2_f32_bf16 v68, v57, v19, v68
    v_dot2_f32_bf16 v69, v57, v17, v69
    v_dot2_f32_bf16 v70, v58, v19, v70
    v_dot2_f32_bf16 v71, v58, v17, v71
    v_dot2_f32_bf16 v64, v54, v20, v64
    v_dot2_f32_bf16 v66, v55, v20, v66
    v_dot2_f32_bf16 v68, v56, v20, v68
    v_dot2_f32_bf16 v70, v57, v20, v70
    s_waitcnt lgkmcnt(1)
    v_lshlrev_b32 v72, 16, v60
    v_and_b32 v73, s70, v60
    v_lshlrev_b32 v74, 16, v61
    v_and_b32 v75, s70, v61
    s_waitcnt lgkmcnt(0)
    v_lshlrev_b32 v76, 16, v62
    v_and_b32 v77, s70, v62
    v_lshlrev_b32 v78, 16, v63
    v_and_b32 v79, s70, v63
    v_pk_mul_f32 v[64:65], v[64:65], v[72:73]
    v_pk_mul_f32 v[66:67], v[66:67], v[74:75]
    v_pk_mul_f32 v[68:69], v[68:69], v[76:77]
    v_pk_mul_f32 v[70:71], v[70:71], v[78:79]
    v_cvt_pk_bf16_f32 v92, v64, v65
    v_cvt_pk_bf16_f32 v93, v66, v67
    v_cvt_pk_bf16_f32 v94, v68, v69
    v_cvt_pk_bf16_f32 v95, v70, v71
    v_mov_b32 v72, v88
    v_mov_b32 v73, v89
    v_mov_b32 v74, v90
    v_mov_b32 v75, v91
    v_mov_b32_dpp v88, v92 row_ror:8 row_mask:0xf bank_mask:0xc
    v_mov_b32_dpp v89, v93 row_ror:8 row_mask:0xf bank_mask:0xc
    v_mov_b32_dpp v90, v94 row_ror:8 row_mask:0xf bank_mask:0xc
    v_mov_b32_dpp v91, v95 row_ror:8 row_mask:0xf bank_mask:0xc
    v_mov_b32_dpp v92, v72 row_ror:8 row_mask:0xf bank_mask:0x3
    v_mov_b32_dpp v93, v73 row_ror:8 row_mask:0xf bank_mask:0x3
    v_mov_b32_dpp v94, v74 row_ror:8 row_mask:0xf bank_mask:0x3
    v_mov_b32_dpp v95, v75 row_ror:8 row_mask:0xf bank_mask:0x3
    buffer_store_dwordx4 v[88:91], v8, s[8:11], 0 offen offset:128 sc1
    buffer_store_dwordx4 v[92:95], v8, s[8:11], s90 offen offset:128 sc1
    s_mov_b32 s16, s58
    s_mov_b32 s17, s59
    s_mov_b32 s18, 256
    s_mov_b32 s19, 0x20000
    v_mov_b32 v251, 0
    buffer_load_dword v11, v251, s[16:19], 0 offen sc1
    s_add_u32 s84, s98, 0
    s_add_u32 m0, s99, 24576
    s_nop 0
    buffer_load_dwordx4 v240, s[20:23], s84 offen offset:0 lds
    s_mul_i32 s90, s62, 16640
    v_add_u32 v6, s90, v0
    v_mov_b32 v160, 0
    v_mov_b32 v161, 0
    v_mov_b32 v162, 0
    v_mov_b32 v163, 0
    s_mov_b32 s90, 0xffff
    s_waitcnt vmcnt(13)
    v_bfi_b32 v172, s90, v132, v131
    v_bfi_b32 v173, s90, v131, v130
    v_bfi_b32 v174, s90, v130, v129
    v_bfi_b32 v175, s90, v129, v128
    ds_write_b128 v6, v[172:175] offset:0
    v_alignbit_b32 v176, v132, v132, 16
    v_alignbit_b32 v177, v131, v131, 16
    buffer_load_dwordx4 v241, s[20:23], s84 offen offset:1024 lds
    v_alignbit_b32 v178, v130, v130, 16
    v_alignbit_b32 v179, v129, v129, 16
    ds_write_b128 v6, v[176:179] offset:4160
    v_bfi_b32 v180, s90, v133, v132
    v_bfi_b32 v181, s90, v132, v131
    v_bfi_b32 v182, s90, v131, v130
    v_bfi_b32 v183, s90, v130, v129
    ds_write_b128 v6, v[180:183] offset:8320
    v_alignbit_b32 v184, v133, v133, 16
    v_alignbit_b32 v185, v132, v132, 16
    v_alignbit_b32 v186, v131, v131, 16
    v_alignbit_b32 v187, v130, v130, 16
    ds_write_b128 v6, v[184:187] offset:12480
    s_waitcnt vmcnt(12)
    v_bfi_b32 v188, s90, v140, v139
    buffer_load_dwordx4 v242, s[20:23], s84 offen offset:2048 lds
    v_bfi_b32 v189, s90, v139, v138
    v_bfi_b32 v190, s90, v138, v137
    v_bfi_b32 v191, s90, v137, v136
    ds_write_b128 v6, v[188:191] offset:1024
    v_alignbit_b32 v192, v140, v140, 16
    v_alignbit_b32 v193, v139, v139, 16
    v_alignbit_b32 v194, v138, v138, 16
    v_alignbit_b32 v195, v137, v137, 16
    ds_write_b128 v6, v[192:195] offset:5184
    v_bfi_b32 v196, s90, v141, v140
    v_bfi_b32 v197, s90, v140, v139
    v_bfi_b32 v198, s90, v139, v138
    v_bfi_b32 v199, s90, v138, v137
    ds_write_b128 v6, v[196:199] offset:9344
    s_add_u32 s84, s98, 98304
    s_add_u32 m0, s99, 36864
    s_nop 0
    buffer_load_dwordx4 v240, s[20:23], s84 offen offset:0 lds
    v_alignbit_b32 v200, v141, v141, 16
    v_alignbit_b32 v201, v140, v140, 16
    v_alignbit_b32 v202, v139, v139, 16
    v_alignbit_b32 v203, v138, v138, 16
    ds_write_b128 v6, v[200:203] offset:13504
    s_waitcnt vmcnt(12)
    v_bfi_b32 v172, s90, v148, v147
    v_bfi_b32 v173, s90, v147, v146
    v_bfi_b32 v174, s90, v146, v145
    v_bfi_b32 v175, s90, v145, v144
    ds_write_b128 v6, v[172:175] offset:2048
    v_alignbit_b32 v176, v148, v148, 16
    v_alignbit_b32 v177, v147, v147, 16
    v_alignbit_b32 v178, v146, v146, 16
    v_alignbit_b32 v179, v145, v145, 16
    buffer_load_dwordx4 v241, s[20:23], s84 offen offset:1024 lds
    ds_write_b128 v6, v[176:179] offset:6208
    v_bfi_b32 v180, s90, v149, v148
    v_bfi_b32 v181, s90, v148, v147
    v_bfi_b32 v182, s90, v147, v146
    v_bfi_b32 v183, s90, v146, v145
    ds_write_b128 v6, v[180:183] offset:10368
    v_alignbit_b32 v184, v149, v149, 16
    v_alignbit_b32 v185, v148, v148, 16
    v_alignbit_b32 v186, v147, v147, 16
    v_alignbit_b32 v187, v146, v146, 16
    ds_write_b128 v6, v[184:187] offset:14528
    s_waitcnt vmcnt(11)
    v_bfi_b32 v188, s90, v156, v155
    v_bfi_b32 v189, s90, v155, v154
    v_bfi_b32 v190, s90, v154, v153
    buffer_load_dwordx4 v242, s[20:23], s84 offen offset:2048 lds
    v_bfi_b32 v191, s90, v153, v152
    ds_write_b128 v6, v[188:191] offset:3072
    v_alignbit_b32 v192, v156, v156, 16
    v_alignbit_b32 v193, v155, v155, 16
    v_alignbit_b32 v194, v154, v154, 16
    v_alignbit_b32 v195, v153, v153, 16
    ds_write_b128 v6, v[192:195] offset:7232
    v_bfi_b32 v196, s90, v157, v156
    v_bfi_b32 v197, s90, v156, v155
    v_bfi_b32 v198, s90, v155, v154
    v_bfi_b32 v199, s90, v154, v153
    ds_write_b128 v6, v[196:199] offset:11392
    v_alignbit_b32 v200, v157, v157, 16
    v_alignbit_b32 v201, v156, v156, 16
    v_alignbit_b32 v202, v155, v155, 16
    v_alignbit_b32 v203, v154, v154, 16
    s_waitcnt vmcnt(6)
    v_readfirstlane_b32 s68, v11
    s_nop 0
    s_cmp_lg_u32 s68, 0
    s_cbranch_scc1 L_nd_3
L_nn_2:
    s_cmp_eq_u32 s72, 0
    s_cbranch_scc1 L_nd_3
    s_sub_u32 s72, s72, 1
    buffer_load_dword v11, v251, s[16:19], 0 offen sc1
    s_waitcnt vmcnt(0)
    v_readfirstlane_b32 s68, v11
    s_nop 0
    s_cmp_eq_u32 s68, 0
    s_cbranch_scc1 L_nn_2
L_nd_3:
    s_barrier
    s_lshl_b32 s85, s67, 6
    s_add_u32 s85, s85, 28311552
    v_mov_b32 v11, s68
    s_add_u32 s85, s85, s83
    s_mov_b64 exec, 15
    buffer_store_dword v11, v0, s[8:11], s85 offen sc1
    s_mov_b64 exec, -1
    s_add_u32 s84, s98, 196608
    s_add_u32 m0, s99, 49152
    s_nop 0
    buffer_load_dwordx4 v240, s[20:23], s84 offen offset:0 lds
    s_mul_i32 s89, s62, 4608
    s_add_u32 s89, s89, 66560
    v_lshrrev_b32 v1, 1, v0
    v_add_u32 v1, s89, v1
    v_mov_b32 v2, 0
    v_mov_b32 v3, 0
    ds_write_b64 v1, v[2:3]
    ds_write_b128 v6, v[200:203] offset:15552
    s_mov_b64 exec, 3
    v_bfi_b32 v172, s90, v164, v163
    v_bfi_b32 v173, s90, v163, v162
    v_bfi_b32 v174, s90, v162, v161
    v_bfi_b32 v175, s90, v161, v160
    ds_write_b128 v6, v[172:175] offset:4096
    v_alignbit_b32 v176, v164, v164, 16
    v_alignbit_b32 v177, v163, v163, 16
    v_alignbit_b32 v178, v162, v162, 16
    v_alignbit_b32 v179, v161, v161, 16
    ds_write_b128 v6, v[176:179] offset:8256
    v_bfi_b32 v180, s90, v165, v164
    v_bfi_b32 v181, s90, v164, v163
    v_bfi_b32 v182, s90, v163, v162
    v_bfi_b32 v183, s90, v162, v161
    ds_write_b128 v6, v[180:183] offset:12416
    v_alignbit_b32 v184, v165, v165, 16
    v_alignbit_b32 v185, v164, v164, 16
    v_alignbit_b32 v186, v163, v163, 16
    v_alignbit_b32 v187, v162, v162, 16
    ds_write_b128 v6, v[184:187] offset:16576
    s_mov_b64 exec, -1
    buffer_load_dwordx4 v241, s[20:23], s84 offen offset:1024 lds
    v_bfe_u32 v1, v0, 4, 2
    v_mul_u32_u24 v1, 4160, v1
    v_lshrrev_b32 v2, 8, v0
    v_lshl_add_u32 v1, v2, 4, v1
    v_bfe_u32 v3, v0, 6, 2
    v_lshlrev_b32 v3, 3, v3
    v_sub_u32 v1, v1, v3
    s_mul_i32 s90, s62, 16640
    s_add_u32 s90, s90, 32
    buffer_load_dwordx4 v242, s[20:23], s84 offen offset:2048 lds
    v_add_u32 v1, s90, v1
    v_bfe_u32 v4, v0, 4, 4
    v_lshlrev_b32 v5, 5, v4
    v_lshl_add_u32 v3, v2, 3, v5
    v_lshl_add_u32 v2, v2, 4, v5
    s_add_u32 s90, s89, 32
    v_add_u32 v2, s90, v2
    v_lshlrev_b32 v9, 1, v3
    v_add_u32 v9, 85248, v9
    s_add_u32 s84, s98, 294912
    s_add_u32 m0, s99, 61440
    s_nop 0
    buffer_load_dwordx4 v240, s[20:23], s84 offen offset:0 lds
    s_lshl_b32 s90, s88, 12
    v_add_u32 v7, s90, v3
    s_add_u32 s90, s89, 512
    v_add_u32 v3, s90, v3
    v_lshrrev_b32 v6, 2, v4
    s_mov_b32 s90, 81920
    v_mul_lo_u32 v6, v6, s90
    v_lshrrev_b32 v5, 8, v0
    v_lshl_add_u32 v6, v5, 3, v6
    buffer_load_dwordx4 v241, s[20:23], s84 offen offset:1024 lds
    s_lshl_b32 s90, s88, 6
    v_add_u32 v6, s90, v6
    v_bfe_u32 v5, v4, 0, 1
    v_mul_u32_u24 v8, 40960, v5
    v_add_u32 v8, v8, v6
    v_bfe_u32 v5, v4, 1, 1
    v_lshl_add_u32 v8, v5, 5, v8
    v_add_u32 v6, s90, v6
    v_and_b32 v5, 3, v4
    buffer_load_dwordx4 v242, s[20:23], s84 offen offset:2048 lds
    v_lshl_add_u32 v6, v5, 5, v6
    s_bitcmp1_b32 s88, 0
    s_cselect_b32 s90, 0, 16
    s_lshl_b32 s71, s71, s90
    s_and_b32 s71, s71, s70
    s_lshr_b32 s95, s71, 16
    v_mov_b32 v12, 0x3f803f80
    v_mov_b32 v13, 0x3f803f80
    v_mov_b32 v14, 0x3f803f80
    s_add_u32 s84, s98, 393216
    s_add_u32 m0, s99, 0
    s_nop 0
    buffer_load_dwordx4 v240, s[20:23], s84 offen offset:0 lds
    v_mov_b32 v15, 0x3f803f80
    buffer_load_dwordx4 v241, s[20:23], s84 offen offset:1024 lds
    buffer_load_dwordx4 v242, s[20:23], s84 offen offset:2048 lds
    s_add_u32 s84, s98, 491520
    s_add_u32 m0, s99, 12288
    s_nop 0
    buffer_load_dwordx4 v240, s[20:23], s84 offen offset:0 lds
    buffer_load_dwordx4 v241, s[20:23], s84 offen offset:1024 lds
    buffer_load_dwordx4 v242, s[20:23], s84 offen offset:2048 lds
    s_and_b32 s91, s67, 0xf0
    s_lshl_b32 s91, s91, 6
    s_add_u32 s91, s91, 28311552
    s_lshr_b32 s94, s67, 5
    s_lshl_b32 s94, s94, 10
    s_waitcnt vmcnt(13)
    s_barrier
    ds_read_b64_tr_b16 a[0:1], v243 offset:24576
    ds_read_b64_tr_b16 a[2:3], v243 offset:27648
    ds_read_b64_tr_b16 a[4:5], v243 offset:30720
    ds_read_b64_tr_b16 a[6:7], v243 offset:33792
    ds_read_b64_tr_b16 a[8:9], v244 offset:24576
    ds_read_b64_tr_b16 a[10:11], v244 offset:27648
    ds_read_b64_tr_b16 a[60:61], v245 offset:24576
    ds_read_b64_tr_b16 a[62:63], v245 offset:27648
    ds_read_b64_tr_b16 a[64:65], v245 offset:30720
    ds_read_b64_tr_b16 a[66:67], v245 offset:33792
    ds_read_b64_tr_b16 a[68:69], v246 offset:24576
    ds_read_b64_tr_b16 a[70:71], v246 offset:27648
    s_waitcnt vmcnt(6) lgkmcnt(0)
    s_barrier
    ds_read_b64_tr_b16 a[12:13], v243 offset:49152
    ds_read_b64_tr_b16 a[14:15], v243 offset:52224
    ds_read_b64_tr_b16 a[16:17], v243 offset:55296
    ds_read_b64_tr_b16 a[18:19], v243 offset:58368
    ds_read_b64_tr_b16 a[20:21], v244 offset:49152
    ds_read_b64_tr_b16 a[22:23], v244 offset:52224
    ds_read_b64_tr_b16 a[72:73], v245 offset:49152
    ds_read_b64_tr_b16 a[74:75], v245 offset:52224
    ds_read_b64_tr_b16 a[76:77], v245 offset:55296
    ds_read_b64_tr_b16 a[78:79], v245 offset:58368
    ds_read_b64_tr_b16 a[80:81], v246 offset:49152
    ds_read_b64_tr_b16 a[82:83], v246 offset:52224
    s_add_u32 s84, s98, 589824
    s_add_u32 m0, s99, 24576
    s_nop 0
    buffer_load_dwordx4 v240, s[20:23], s84 offen offset:0 lds
    v_mfma_f32_16x16x32_bf16 v[28:31], a[0:3], v[12:15], 0
    buffer_load_dwordx4 v241, s[20:23], s84 offen offset:1024 lds
    v_mfma_f32_16x16x32_bf16 v[32:35], a[4:7], v[12:15], 0
    buffer_load_dwordx4 v242, s[20:23], s84 offen offset:2048 lds
    v_mfma_f32_16x16x32_bf16 v[36:39], a[8:11], v[12:15], 0
    s_add_u32 s84, s98, 688128
    s_add_u32 m0, s99, 36864
    s_nop 0
    buffer_load_dwordx4 v240, s[20:23], s84 offen offset:0 lds
    v_mfma_f32_16x16x32_bf16 v[28:31], a[60:63], v[12:15], v[28:31]
    buffer_load_dwordx4 v241, s[20:23], s84 offen offset:1024 lds
    v_mfma_f32_16x16x32_bf16 v[32:35], a[64:67], v[12:15], v[32:35]
    buffer_load_dwordx4 v242, s[20:23], s84 offen offset:2048 lds
    v_mfma_f32_16x16x32_bf16 v[36:39], a[68:71], v[12:15], v[36:39]
    s_waitcnt vmcnt(6) lgkmcnt(0)
    s_barrier
    ds_read_b64_tr_b16 a[24:25], v243 offset:0
    ds_read_b64_tr_b16 a[26:27], v243 offset:3072
    ds_read_b64_tr_b16 a[28:29], v243 offset:6144
    ds_read_b64_tr_b16 a[30:31], v243 offset:9216
    ds_read_b64_tr_b16 a[32:33], v244 offset:0
    ds_read_b64_tr_b16 a[34:35], v244 offset:3072
    ds_read_b64_tr_b16 a[84:85], v245 offset:0
    ds_read_b64_tr_b16 a[86:87], v245 offset:3072
    ds_read_b64_tr_b16 a[88:89], v245 offset:6144
    ds_read_b64_tr_b16 a[90:91], v245 offset:9216
    ds_read_b64_tr_b16 a[92:93], v246 offset:0
    ds_read_b64_tr_b16 a[94:95], v246 offset:3072
    buffer_load_dword v11, v0, s[8:11], s91 offen sc1
    s_add_u32 s84, s98, 786432
    s_add_u32 m0, s99, 49152
    s_nop 0
    buffer_load_dwordx4 v240, s[20:23], s84 offen offset:0 lds
    buffer_load_dwordx4 v241, s[20:23], s84 offen offset:1024 lds
    buffer_load_dwordx4 v242, s[20:23], s84 offen offset:2048 lds
    s_add_u32 s84, s98, 884736
    s_add_u32 m0, s99, 61440
    s_nop 0
    buffer_load_dwordx4 v240, s[20:23], s84 offen offset:0 lds
    buffer_load_dwordx4 v241, s[20:23], s84 offen offset:1024 lds
    buffer_load_dwordx4 v242, s[20:23], s84 offen offset:2048 lds
    v_mfma_f32_16x16x32_bf16 v[28:31], a[12:15], v[12:15], v[28:31]
    v_mfma_f32_16x16x32_bf16 v[32:35], a[16:19], v[12:15], v[32:35]
    v_mfma_f32_16x16x32_bf16 v[36:39], a[20:23], v[12:15], v[36:39]
    v_mfma_f32_16x16x32_bf16 v[28:31], a[72:75], v[12:15], v[28:31]
    v_mfma_f32_16x16x32_bf16 v[32:35], a[76:79], v[12:15], v[32:35]
    v_mfma_f32_16x16x32_bf16 v[36:39], a[80:83], v[12:15], v[36:39]
    s_waitcnt vmcnt(7) lgkmcnt(0)
    s_barrier
    ds_read_b64_tr_b16 a[36:37], v243 offset:24576
    ds_read_b64_tr_b16 a[38:39], v243 offset:27648
    ds_read_b64_tr_b16 a[40:41], v243 offset:30720
    ds_read_b64_tr_b16 a[42:43], v243 offset:33792
    ds_read_b64_tr_b16 a[44:45], v244 offset:24576
    ds_read_b64_tr_b16 a[46:47], v244 offset:27648
    ds_read_b64_tr_b16 a[96:97], v245 offset:24576
    ds_read_b64_tr_b16 a[98:99], v245 offset:27648
    ds_read_b64_tr_b16 a[100:101], v245 offset:30720
    ds_read_b64_tr_b16 a[102:103], v245 offset:33792
    ds_read_b64_tr_b16 a[104:105], v246 offset:24576
    ds_read_b64_tr_b16 a[106:107], v246 offset:27648
    v_mfma_f32_16x16x32_bf16 v[28:31], a[24:27], v[12:15], v[28:31]
    v_mfma_f32_16x16x32_bf16 v[32:35], a[28:31], v[12:15], v[32:35]
    v_mfma_f32_16x16x32_bf16 v[36:39], a[32:35], v[12:15], v[36:39]
    v_mfma_f32_16x16x32_bf16 v[28:31], a[84:87], v[12:15], v[28:31]
    v_mfma_f32_16x16x32_bf16 v[32:35], a[88:91], v[12:15], v[32:35]
    v_mfma_f32_16x16x32_bf16 v[36:39], a[92:95], v[12:15], v[36:39]
    s_waitcnt vmcnt(6)
    v_cmp_ne_u32 vcc, s68, v11
    s_cbranch_vccz L_pd_5
L_pl_4:
    s_cmp_eq_u32 s72, 0
    s_cbranch_scc1 L_pd_5
    s_sub_u32 s72, s72, 1
    buffer_load_dword v11, v0, s[8:11], s91 offen sc1
    s_waitcnt vmcnt(0)
    v_cmp_ne_u32 vcc, s68, v11
    s_cbranch_vccnz L_pl_4
L_pd_5:
    s_lshl_b32 s90, s88, 12
    s_add_u32 m0, s89, 512
    s_nop 0
    buffer_load_dwordx4 v0, s[8:11], s90 offen offset:0 sc1 lds
    buffer_load_dwordx4 v0, s[8:11], s90 offen offset:1024 sc1 lds
    buffer_load_dwordx4 v0, s[8:11], s90 offen offset:2048 sc1 lds
    buffer_load_dwordx4 v0, s[8:11], s90 offen offset:3072 sc1 lds
    s_mov_b32 s91, 28327936
    buffer_load_dword v11, v0, s[8:11], s91 offen sc1
    s_add_u32 s85, s94, 28573696
    buffer_load_dword v24, v0, s[8:11], s85 offen sc1
    s_waitcnt vmcnt(6) lgkmcnt(0)
    s_barrier
    ds_read_b64_tr_b16 a[48:49], v243 offset:49152
    ds_read_b64_tr_b16 a[50:51], v243 offset:52224
    ds_read_b64_tr_b16 a[52:53], v243 offset:55296
    ds_read_b64_tr_b16 a[54:55], v243 offset:58368
    ds_read_b64_tr_b16 a[56:57], v244 offset:49152
    ds_read_b64_tr_b16 a[58:59], v244 offset:52224
    ds_read_b64_tr_b16 a[108:109], v245 offset:49152
    ds_read_b64_tr_b16 a[110:111], v245 offset:52224
    ds_read_b64_tr_b16 a[112:113], v245 offset:55296
    ds_read_b64_tr_b16 a[114:115], v245 offset:58368
    ds_read_b64_tr_b16 a[116:117], v246 offset:49152
    ds_read_b64_tr_b16 a[118:119], v246 offset:52224
    v_mfma_f32_16x16x32_bf16 v[28:31], a[36:39], v[12:15], v[28:31]
    v_mfma_f32_16x16x32_bf16 v[32:35], a[40:43], v[12:15], v[32:35]
    v_mfma_f32_16x16x32_bf16 v[36:39], a[44:47], v[12:15], v[36:39]
    v_mfma_f32_16x16x32_bf16 v[28:31], a[96:99], v[12:15], v[28:31]
    v_mfma_f32_16x16x32_bf16 v[32:35], a[100:103], v[12:15], v[32:35]
    v_mfma_f32_16x16x32_bf16 v[36:39], a[104:107], v[12:15], v[36:39]
    s_waitcnt vmcnt(2)
    ds_read_b64 v[112:113], v1 offset:4032
    ds_read_b64 v[114:115], v1 offset:4040
    ds_read_b128 v[144:147], v2 offset:448
    ds_read_b128 v[148:151], v2 offset:960
    ds_read_b128 v[152:155], v2 offset:1472
    ds_read_b128 v[156:159], v2 offset:1984
    ds_read_b64 v[116:117], v1 offset:3520
    ds_read_b64 v[118:119], v1 offset:3528
    ds_read_b64 v[120:121], v1 offset:3008
    ds_read_b64 v[122:123], v1 offset:3016
    ds_read_b64 v[124:125], v1 offset:2496
    ds_read_b64 v[126:127], v1 offset:2504
    s_mul_i32 s98, s1, 245760
    s_mul_i32 s84, s62, 3072
    s_add_u32 s98, s98, s84
    s_add_u32 s98, s98, 29360128
    s_mul_i32 s84, s69, 12288
    s_add_u32 s99, s98, 12288
    s_sub_u32 s99, s99, s84
    s_add_u32 s98, s98, s84
    s_waitcnt lgkmcnt(4)
    v_mfma_f32_16x16x32_bf16 v[64:67], v[112:115], v[144:147], 0
    ds_read_b64 v[176:177], v1 offset:3968
    ds_read_b64 v[178:179], v1 offset:3976
    v_mfma_f32_16x16x32_bf16 v[68:71], v[112:115], v[148:151], 0
    ds_read_b128 v[208:211], v2 offset:384
    ds_read_b128 v[212:215], v2 offset:896
    v_mfma_f32_16x16x32_bf16 v[72:75], v[112:115], v[152:155], 0
    ds_read_b128 v[216:219], v2 offset:1408
    v_mfma_f32_16x16x32_bf16 v[76:79], v[112:115], v[156:159], 0
    ds_read_b128 v[220:223], v2 offset:1920
    v_mfma_f32_16x16x32_bf16 v[68:71], v[116:119], v[144:147], v[68:71]
    ds_read_b64 v[180:181], v1 offset:3456
    v_mfma_f32_16x16x32_bf16 v[72:75], v[116:119], v[148:151], v[72:75]
    ds_read_b64 v[182:183], v1 offset:3464
    v_mfma_f32_16x16x32_bf16 v[76:79], v[116:119], v[152:155], v[76:79]
    ds_read_b64 v[184:185], v1 offset:2944
    s_waitcnt lgkmcnt(9)
    v_mfma_f32_16x16x32_bf16 v[72:75], v[120:123], v[144:147], v[72:75]
    ds_read_b64 v[186:187], v1 offset:2952
    v_mfma_f32_16x16x32_bf16 v[76:79], v[120:123], v[148:151], v[76:79]
    ds_read_b64 v[188:189], v1 offset:2432
    v_mfma_f32_16x16x32_bf16 v[76:79], v[124:127], v[144:147], v[76:79]
    ds_read_b64 v[190:191], v1 offset:2440
    s_waitcnt lgkmcnt(4)
    v_mfma_f32_16x16x32_bf16 v[64:67], v[176:179], v[208:211], v[64:67]
    ds_read_b64 v[112:113], v1 offset:3904
    ds_read_b64 v[114:115], v1 offset:3912
    v_mfma_f32_16x16x32_bf16 v[68:71], v[176:179], v[212:215], v[68:71]
    ds_read_b128 v[144:147], v2 offset:320
    ds_read_b128 v[148:151], v2 offset:832
    v_mfma_f32_16x16x32_bf16 v[72:75], v[176:179], v[216:219], v[72:75]
    ds_read_b128 v[152:155], v2 offset:1344
    v_mfma_f32_16x16x32_bf16 v[76:79], v[176:179], v[220:223], v[76:79]
    ds_read_b128 v[156:159], v2 offset:1856
    v_mfma_f32_16x16x32_bf16 v[68:71], v[180:183], v[208:211], v[68:71]
    ds_read_b64 v[116:117], v1 offset:3392
    v_mfma_f32_16x16x32_bf16 v[72:75], v[180:183], v[212:215], v[72:75]
    ds_read_b64 v[118:119], v1 offset:3400
    v_mfma_f32_16x16x32_bf16 v[76:79], v[180:183], v[216:219], v[76:79]
    ds_read_b64 v[120:121], v1 offset:2880
    s_waitcnt lgkmcnt(9)
    v_mfma_f32_16x16x32_bf16 v[72:75], v[184:187], v[208:211], v[72:75]
    ds_read_b64 v[122:123], v1 offset:2888
    v_mfma_f32_16x16x32_bf16 v[76:79], v[184:187], v[212:215], v[76:79]
    ds_read_b64 v[124:125], v1 offset:2368
    v_mfma_f32_16x16x32_bf16 v[76:79], v[188:191], v[208:211], v[76:79]
    ds_read_b64 v[126:127], v1 offset:2376
    s_waitcnt vmcnt(1)
    v_cmp_ne_u32 vcc, s68, v11
    s_cbranch_vccz L_pd_7
L_pl_6:
    s_cmp_eq_u32 s72, 0
    s_cbranch_scc1 L_pd_7
    s_sub_u32 s72, s72, 1
    buffer_load_dword v11, v0, s[8:11], s91 offen sc1
    s_waitcnt vmcnt(0)
    v_cmp_ne_u32 vcc, s68, v11
    s_cbranch_vccnz L_pl_6
L_pd_7:
    s_waitcnt vmcnt(0)
    v_cmp_ne_u32 vcc, s68, v24
    s_cbranch_vccz L_pd_9
L_pl_8:
    s_cmp_eq_u32 s72, 0
    s_cbranch_scc1 L_pd_9
    s_sub_u32 s72, s72, 1
    buffer_load_dword v24, v0, s[8:11], s85 offen sc1
    s_waitcnt vmcnt(0)
    v_cmp_ne_u32 vcc, s68, v24
    s_cbranch_vccnz L_pl_8
L_pd_9:
    s_waitcnt lgkmcnt(4)
    v_mfma_f32_16x16x32_bf16 v[64:67], v[112:115], v[144:147], v[64:67]
    ds_read_b64 v[176:177], v1 offset:3840
    ds_read_b64 v[178:179], v1 offset:3848
    s_lshl_b32 s93, s62, 12
    s_add_u32 m0, s93, 85248
    v_mfma_f32_16x16x32_bf16 v[68:71], v[112:115], v[148:151], v[68:71]
    ds_read_b128 v[208:211], v2 offset:256
    ds_read_b128 v[212:215], v2 offset:768
    s_add_u32 s93, s93, 5242880
    v_mfma_f32_16x16x32_bf16 v[72:75], v[112:115], v[152:155], v[72:75]
    ds_read_b128 v[216:219], v2 offset:1280
    buffer_load_dwordx4 v0, s[8:11], s93 offen offset:0 sc1 lds
    v_mfma_f32_16x16x32_bf16 v[76:79], v[112:115], v[156:159], v[76:79]
    ds_read_b128 v[220:223], v2 offset:1792
    v_mfma_f32_16x16x32_bf16 v[68:71], v[116:119], v[144:147], v[68:71]
    ds_read_b64 v[180:181], v1 offset:3328
    v_mfma_f32_16x16x32_bf16 v[72:75], v[116:119], v[148:151], v[72:75]
    ds_read_b64 v[182:183], v1 offset:3336
    v_mfma_f32_16x16x32_bf16 v[76:79], v[116:119], v[152:155], v[76:79]
    ds_read_b64 v[184:185], v1 offset:2816
    s_waitcnt lgkmcnt(9)
    buffer_load_dwordx4 v0, s[8:11], s93 offen offset:1024 sc1 lds
    v_mfma_f32_16x16x32_bf16 v[72:75], v[120:123], v[144:147], v[72:75]
    ds_read_b64 v[186:187], v1 offset:2824
    v_mfma_f32_16x16x32_bf16 v[76:79], v[120:123], v[148:151], v[76:79]
    ds_read_b64 v[188:189], v1 offset:2304
    v_mfma_f32_16x16x32_bf16 v[76:79], v[124:127], v[144:147], v[76:79]
    ds_read_b64 v[190:191], v1 offset:2312
    s_waitcnt lgkmcnt(4)
    v_mfma_f32_16x16x32_bf16 v[64:67], v[176:179], v[208:211], v[64:67]
    ds_read_b64 v[112:113], v1 offset:3776
    ds_read_b64 v[114:115], v1 offset:3784
    v_mfma_f32_16x16x32_bf16 v[68:71], v[176:179], v[212:215], v[68:71]
    ds_read_b128 v[144:147], v2 offset:192
    ds_read_b128 v[148:151], v2 offset:704
    buffer_load_dwordx4 v0, s[8:11], s93 offen offset:2048 sc1 lds
    v_mfma_f32_16x16x32_bf16 v[72:75], v[176:179], v[216:219], v[72:75]
    ds_read_b128 v[152:155], v2 offset:1216
    v_mfma_f32_16x16x32_bf16 v[76:79], v[176:179], v[220:223], v[76:79]
    ds_read_b128 v[156:159], v2 offset:1728
    v_mfma_f32_16x16x32_bf16 v[68:71], v[180:183], v[208:211], v[68:71]
    ds_read_b64 v[116:117], v1 offset:3264
    v_mfma_f32_16x16x32_bf16 v[72:75], v[180:183], v[212:215], v[72:75]
    ds_read_b64 v[118:119], v1 offset:3272
    buffer_load_dwordx4 v0, s[8:11], s93 offen offset:3072 sc1 lds
    s_mov_b32 s92, 2621440
    v_mfma_f32_16x16x32_bf16 v[76:79], v[180:183], v[216:219], v[76:79]
    ds_read_b64 v[120:121], v1 offset:2752
    s_waitcnt lgkmcnt(9)
    v_mfma_f32_16x16x32_bf16 v[72:75], v[184:187], v[208:211], v[72:75]
    ds_read_b64 v[122:123], v1 offset:2760
    v_mfma_f32_16x16x32_bf16 v[76:79], v[184:187], v[212:215], v[76:79]
    ds_read_b64 v[124:125], v1 offset:2240
    v_mfma_f32_16x16x32_bf16 v[76:79], v[188:191], v[208:211], v[76:79]
    ds_read_b64 v[126:127], v1 offset:2248
    s_waitcnt lgkmcnt(4)
    v_mfma_f32_16x16x32_bf16 v[64:67], v[112:115], v[144:147], v[64:67]
    ds_read_b64 v[176:177], v1 offset:3712
    ds_read_b64 v[178:179], v1 offset:3720
    buffer_load_dwordx2 v[40:41], v7, s[8:11], s92 offen offset:0 sc1
    v_mfma_f32_16x16x32_bf16 v[68:71], v[112:115], v[148:151], v[68:71]
    ds_read_b128 v[208:211], v2 offset:128
    ds_read_b128 v[212:215], v2 offset:640
    v_mfma_f32_16x16x32_bf16 v[72:75], v[112:115], v[152:155], v[72:75]
    ds_read_b128 v[216:219], v2 offset:1152
    buffer_load_dwordx2 v[42:43], v7, s[8:11], s92 offen offset:512 sc1
    v_mfma_f32_16x16x32_bf16 v[76:79], v[112:115], v[156:159], v[76:79]
    ds_read_b128 v[220:223], v2 offset:1664
    v_mfma_f32_16x16x32_bf16 v[68:71], v[116:119], v[144:147], v[68:71]
    ds_read_b64 v[180:181], v1 offset:3200
    buffer_load_dwordx2 v[44:45], v7, s[8:11], s92 offen offset:1024 sc1
    v_mfma_f32_16x16x32_bf16 v[72:75], v[116:119], v[148:151], v[72:75]
    ds_read_b64 v[182:183], v1 offset:3208
    v_mfma_f32_16x16x32_bf16 v[76:79], v[116:119], v[152:155], v[76:79]
    ds_read_b64 v[184:185], v1 offset:2688
    s_waitcnt lgkmcnt(9)
    v_mfma_f32_16x16x32_bf16 v[72:75], v[120:123], v[144:147], v[72:75]
    ds_read_b64 v[186:187], v1 offset:2696
    buffer_load_dwordx2 v[46:47], v7, s[8:11], s92 offen offset:1536 sc1
    s_lshl_b32 s91, s1, 10
    s_add_u32 s91, s91, 28590592
    v_mfma_f32_16x16x32_bf16 v[76:79], v[120:123], v[148:151], v[76:79]
    ds_read_b64 v[188:189], v1 offset:2176
    v_min_u32 v11, 304, v0
    buffer_load_dword v11, v11, s[8:11], s91 offen sc1
    v_mfma_f32_16x16x32_bf16 v[76:79], v[124:127], v[144:147], v[76:79]
    ds_read_b64 v[190:191], v1 offset:2184
    s_waitcnt lgkmcnt(4)
    v_mfma_f32_16x16x32_bf16 v[64:67], v[176:179], v[208:211], v[64:67]
    ds_read_b64 v[112:113], v1 offset:3648
    ds_read_b64 v[114:115], v1 offset:3656
    v_mfma_f32_16x16x32_bf16 v[68:71], v[176:179], v[212:215], v[68:71]
    ds_read_b128 v[144:147], v2 offset:64
    ds_read_b128 v[148:151], v2 offset:576
    v_mfma_f32_16x16x32_bf16 v[72:75], v[176:179], v[216:219], v[72:75]
    ds_read_b128 v[152:155], v2 offset:1088
    v_mfma_f32_16x16x32_bf16 v[76:79], v[176:179], v[220:223], v[76:79]
    ds_read_b128 v[156:159], v2 offset:1600
    v_mfma_f32_16x16x32_bf16 v[68:71], v[180:183], v[208:211], v[68:71]
    ds_read_b64 v[116:117], v1 offset:3136
    v_mfma_f32_16x16x32_bf16 v[72:75], v[180:183], v[212:215], v[72:75]
    ds_read_b64 v[118:119], v1 offset:3144
    v_mfma_f32_16x16x32_bf16 v[76:79], v[180:183], v[216:219], v[76:79]
    ds_read_b64 v[120:121], v1 offset:2624
    s_waitcnt lgkmcnt(9)
    v_mfma_f32_16x16x32_bf16 v[72:75], v[184:187], v[208:211], v[72:75]
    ds_read_b64 v[122:123], v1 offset:2632
    v_mfma_f32_16x16x32_bf16 v[76:79], v[184:187], v[212:215], v[76:79]
    ds_read_b64 v[124:125], v1 offset:2112
    v_mfma_f32_16x16x32_bf16 v[76:79], v[188:191], v[208:211], v[76:79]
    ds_read_b64 v[126:127], v1 offset:2120
    s_waitcnt lgkmcnt(4)
    v_mfma_f32_16x16x32_bf16 v[64:67], v[112:115], v[144:147], v[64:67]
    ds_read_b64 v[176:177], v1 offset:3584
    ds_read_b64 v[178:179], v1 offset:3592
    v_mfma_f32_16x16x32_bf16 v[68:71], v[112:115], v[148:151], v[68:71]
    ds_read_b128 v[208:211], v2 offset:0
    ds_read_b128 v[212:215], v2 offset:512
    v_mfma_f32_16x16x32_bf16 v[72:75], v[112:115], v[152:155], v[72:75]
    ds_read_b128 v[216:219], v2 offset:1024
    v_mfma_f32_16x16x32_bf16 v[76:79], v[112:115], v[156:159], v[76:79]
    ds_read_b128 v[220:223], v2 offset:1536
    v_mfma_f32_16x16x32_bf16 v[68:71], v[116:119], v[144:147], v[68:71]
    ds_read_b64 v[180:181], v1 offset:3072
    v_mfma_f32_16x16x32_bf16 v[72:75], v[116:119], v[148:151], v[72:75]
    ds_read_b64 v[182:183], v1 offset:3080
    v_mfma_f32_16x16x32_bf16 v[76:79], v[116:119], v[152:155], v[76:79]
    ds_read_b64 v[184:185], v1 offset:2560
    s_waitcnt lgkmcnt(9)
    v_mfma_f32_16x16x32_bf16 v[72:75], v[120:123], v[144:147], v[72:75]
    ds_read_b64 v[186:187], v1 offset:2568
    v_mfma_f32_16x16x32_bf16 v[76:79], v[120:123], v[148:151], v[76:79]
    ds_read_b64 v[188:189], v1 offset:2048
    v_mfma_f32_16x16x32_bf16 v[76:79], v[124:127], v[144:147], v[76:79]
    ds_read_b64 v[190:191], v1 offset:2056
    s_waitcnt lgkmcnt(4)
    v_mfma_f32_16x16x32_bf16 v[64:67], v[176:179], v[208:211], v[64:67]
    ds_read_b64 v[112:113], v1 offset:4032
    ds_read_b64 v[114:115], v1 offset:4040
    ds_read_b128 v[160:163], v2 offset:2496
    v_mfma_f32_16x16x32_bf16 v[68:71], v[176:179], v[212:215], v[68:71]
    ds_read_b128 v[164:167], v2 offset:3008
    ds_read_b128 v[168:171], v2 offset:3520
    ds_read_b128 v[172:175], v2 offset:4032
    v_mfma_f32_16x16x32_bf16 v[72:75], v[176:179], v[216:219], v[72:75]
    ds_read_b64 v[116:117], v1 offset:3520
    ds_read_b64 v[118:119], v1 offset:3528
    ds_read_b128 v[156:159], v2 offset:1984
    v_mfma_f32_16x16x32_bf16 v[76:79], v[176:179], v[220:223], v[76:79]
    ds_read_b64 v[120:121], v1 offset:3008
    ds_read_b64 v[122:123], v1 offset:3016
    ds_read_b128 v[152:155], v2 offset:1472
    v_mfma_f32_16x16x32_bf16 v[68:71], v[180:183], v[208:211], v[68:71]
    ds_read_b64 v[124:125], v1 offset:2496
    ds_read_b64 v[126:127], v1 offset:2504
    v_mfma_f32_16x16x32_bf16 v[72:75], v[180:183], v[212:215], v[72:75]
    ds_read_b128 v[148:151], v2 offset:960
    ds_read_b64 v[128:129], v1 offset:1984
    v_mfma_f32_16x16x32_bf16 v[76:79], v[180:183], v[216:219], v[76:79]
    ds_read_b64 v[130:131], v1 offset:1992
    ds_read_b128 v[144:147], v2 offset:448
    s_waitcnt lgkmcnt(15)
    v_mfma_f32_16x16x32_bf16 v[72:75], v[184:187], v[208:211], v[72:75]
    ds_read_b64 v[132:133], v1 offset:1472
    ds_read_b64 v[134:135], v1 offset:1480
    v_mfma_f32_16x16x32_bf16 v[76:79], v[184:187], v[212:215], v[76:79]
    ds_read_b64 v[136:137], v1 offset:960
    ds_read_b64 v[138:139], v1 offset:968
    v_mfma_f32_16x16x32_bf16 v[76:79], v[188:191], v[208:211], v[76:79]
    ds_read_b64 v[140:141], v1 offset:448
    ds_read_b64 v[142:143], v1 offset:456
    s_waitcnt vmcnt(5)
    s_barrier
    ds_read_b64 v[176:177], v3 offset:0
    ds_read_b64 v[178:179], v3 offset:512
    ds_read_b64 v[180:181], v3 offset:1024
    ds_read_b64 v[182:183], v3 offset:1536
    ds_read_b128 v[48:51], v9 offset:0
    ds_read_b128 v[96:99], v9 offset:8192
    ds_read_b128 v[52:55], v9 offset:1024
    ds_read_b128 v[100:103], v9 offset:9216
    ds_read_b128 v[56:59], v9 offset:2048
    ds_read_b128 v[104:107], v9 offset:10240
    ds_read_b128 v[60:63], v9 offset:3072
    ds_read_b128 v[108:111], v9 offset:11264
    s_waitcnt vmcnt(4)
    v_lshlrev_b32 v184, 16, v40
    v_and_b32 v185, s70, v40
    v_lshlrev_b32 v186, 16, v41
    v_and_b32 v187, s70, v41
    s_waitcnt vmcnt(3)
    v_lshlrev_b32 v188, 16, v42
    v_and_b32 v189, s70, v42
    v_lshlrev_b32 v190, 16, v43
    v_and_b32 v191, s70, v43
    s_waitcnt vmcnt(2)
    v_lshlrev_b32 v192, 16, v44
    v_and_b32 v193, s70, v44
    v_lshlrev_b32 v194, 16, v45
    v_and_b32 v195, s70, v45
    s_waitcnt vmcnt(1)
    v_lshlrev_b32 v196, 16, v46
    v_and_b32 v197, s70, v46
    v_lshlrev_b32 v198, 16, v47
    v_and_b32 v199, s70, v47
    s_waitcnt lgkmcnt(11)
    v_dot2_f32_bf16 v64, v176, s95, v64
    v_dot2_f32_bf16 v65, v176, s71, v65
    v_dot2_f32_bf16 v66, v177, s95, v66
    v_dot2_f32_bf16 v67, v177, s71, v67
    s_waitcnt lgkmcnt(10)
    v_dot2_f32_bf16 v68, v178, s95, v68
    v_dot2_f32_bf16 v69, v178, s71, v69
    v_dot2_f32_bf16 v70, v179, s95, v70
    v_dot2_f32_bf16 v71, v179, s71, v71
    s_waitcnt lgkmcnt(9)
    v_dot2_f32_bf16 v72, v180, s95, v72
    v_dot2_f32_bf16 v73, v180, s71, v73
    v_dot2_f32_bf16 v74, v181, s95, v74
    v_dot2_f32_bf16 v75, v181, s71, v75
    s_waitcnt lgkmcnt(8)
    v_dot2_f32_bf16 v76, v182, s95, v76
    v_dot2_f32_bf16 v77, v182, s71, v77
    v_dot2_f32_bf16 v78, v183, s95, v78
    v_dot2_f32_bf16 v79, v183, s71, v79
    s_waitcnt lgkmcnt(6)
    v_pk_fma_f32 v[48:49], v[184:185], v[48:49], v[96:97]
    v_pk_fma_f32 v[50:51], v[186:187], v[50:51], v[98:99]
    s_waitcnt lgkmcnt(4)
    v_pk_fma_f32 v[52:53], v[188:189], v[52:53], v[100:101]
    v_pk_fma_f32 v[54:55], v[190:191], v[54:55], v[102:103]
    s_waitcnt lgkmcnt(2)
    v_pk_fma_f32 v[56:57], v[192:193], v[56:57], v[104:105]
    v_pk_fma_f32 v[58:59], v[194:195], v[58:59], v[106:107]
    s_waitcnt lgkmcnt(0)
    v_pk_fma_f32 v[60:61], v[196:197], v[60:61], v[108:109]
    v_pk_fma_f32 v[62:63], v[198:199], v[62:63], v[110:111]
    v_cvt_pk_bf16_f32 v176, v64, v65
    v_cvt_pk_bf16_f32 v177, v66, v67
    v_lshlrev_b32 v64, 16, v176
    v_and_b32 v65, s70, v176
    v_lshlrev_b32 v66, 16, v177
    v_and_b32 v67, s70, v177
    v_pk_fma_f32 v[184:185], v[48:49], v[64:65], v[184:185]
    v_pk_fma_f32 v[186:187], v[50:51], v[66:67], v[186:187]
    v_cvt_pk_bf16_f32 v40, v184, v185
    v_cvt_pk_bf16_f32 v41, v186, v187
    v_mov_b32 v16, v176
    v_mov_b32 v17, v177
    v_cvt_pk_bf16_f32 v178, v68, v69
    v_cvt_pk_bf16_f32 v179, v70, v71
    v_lshlrev_b32 v68, 16, v178
    v_and_b32 v69, s70, v178
    v_lshlrev_b32 v70, 16, v179
    v_and_b32 v71, s70, v179
    v_pk_fma_f32 v[188:189], v[52:53], v[68:69], v[188:189]
    v_pk_fma_f32 v[190:191], v[54:55], v[70:71], v[190:191]
    v_cvt_pk_bf16_f32 v42, v188, v189
    v_cvt_pk_bf16_f32 v43, v190, v191
    v_mov_b32 v18, v178
    v_mov_b32 v19, v179
    v_cvt_pk_bf16_f32 v180, v72, v73
    v_cvt_pk_bf16_f32 v181, v74, v75
    v_lshlrev_b32 v72, 16, v180
    v_and_b32 v73, s70, v180
    v_lshlrev_b32 v74, 16, v181
    v_and_b32 v75, s70, v181
    v_pk_fma_f32 v[192:193], v[56:57], v[72:73], v[192:193]
    v_pk_fma_f32 v[194:195], v[58:59], v[74:75], v[194:195]
    v_cvt_pk_bf16_f32 v44, v192, v193
    v_cvt_pk_bf16_f32 v45, v194, v195
    v_mov_b32 v20, v180
    v_mov_b32 v21, v181
    v_cvt_pk_bf16_f32 v182, v76, v77
    v_cvt_pk_bf16_f32 v183, v78, v79
    v_lshlrev_b32 v76, 16, v182
    v_and_b32 v77, s70, v182
    v_lshlrev_b32 v78, 16, v183
    v_and_b32 v79, s70, v183
    v_pk_fma_f32 v[196:197], v[60:61], v[76:77], v[196:197]
    v_pk_fma_f32 v[198:199], v[62:63], v[78:79], v[198:199]
    v_cvt_pk_bf16_f32 v46, v196, v197
    v_cvt_pk_bf16_f32 v47, v198, v199
    v_mov_b32 v22, v182
    v_mov_b32 v23, v183
    v_mfma_f32_16x16x32_bf16 v[80:83], v[112:115], v[160:163], 0
    ds_read_b64 v[176:177], v1 offset:3968
    s_mov_b32 s90, 7864320
    v_mfma_f32_16x16x32_bf16 v[84:87], v[112:115], v[164:167], 0
    ds_read_b64 v[178:179], v1 offset:3976
    buffer_store_dwordx2 v[40:41], v8, s[8:11], s90 offen sc1
    v_mfma_f32_16x16x32_bf16 v[88:91], v[112:115], v[168:171], 0
    ds_read_b128 v[224:227], v2 offset:2432
    s_mov_b32 s90, 8192000
    v_mfma_f32_16x16x32_bf16 v[92:95], v[112:115], v[172:175], 0
    ds_read_b128 v[228:231], v2 offset:2944
    v_mfma_f32_16x16x32_bf16 v[80:83], v[116:119], v[156:159], v[80:83]
    ds_read_b128 v[232:235], v2 offset:3456
    v_mfma_f32_16x16x32_bf16 v[84:87], v[116:119], v[160:163], v[84:87]
    ds_read_b128 v[236:239], v2 offset:3968
    v_mfma_f32_16x16x32_bf16 v[88:91], v[116:119], v[164:167], v[88:91]
    ds_read_b64 v[180:181], v1 offset:3456
    buffer_store_dwordx2 v[42:43], v8, s[8:11], s90 offen sc1
    v_mfma_f32_16x16x32_bf16 v[92:95], v[116:119], v[168:171], v[92:95]
    ds_read_b64 v[182:183], v1 offset:3464
    s_mov_b32 s90, 8519680
    v_mfma_f32_16x16x32_bf16 v[80:83], v[120:123], v[152:155], v[80:83]
    ds_read_b128 v[220:223], v2 offset:1920
    v_mfma_f32_16x16x32_bf16 v[84:87], v[120:123], v[156:159], v[84:87]
    ds_read_b64 v[184:185], v1 offset:2944
    v_mfma_f32_16x16x32_bf16 v[88:91], v[120:123], v[160:163], v[88:91]
    ds_read_b64 v[186:187], v1 offset:2952
    v_mfma_f32_16x16x32_bf16 v[92:95], v[120:123], v[164:167], v[92:95]
    ds_read_b128 v[216:219], v2 offset:1408
    v_mfma_f32_16x16x32_bf16 v[80:83], v[124:127], v[148:151], v[80:83]
    ds_read_b64 v[188:189], v1 offset:2432
    buffer_store_dwordx2 v[44:45], v8, s[8:11], s90 offen sc1
    v_mfma_f32_16x16x32_bf16 v[84:87], v[124:127], v[152:155], v[84:87]
    ds_read_b64 v[190:191], v1 offset:2440
    s_mov_b32 s90, 8847360
    v_mfma_f32_16x16x32_bf16 v[88:91], v[124:127], v[156:159], v[88:91]
    ds_read_b128 v[212:215], v2 offset:896
    v_mfma_f32_16x16x32_bf16 v[92:95], v[124:127], v[160:163], v[92:95]
    ds_read_b64 v[192:193], v1 offset:1920
    v_mfma_f32_16x16x32_bf16 v[80:83], v[128:131], v[144:147], v[80:83]
    ds_read_b64 v[194:195], v1 offset:1928
    v_mfma_f32_16x16x32_bf16 v[84:87], v[128:131], v[148:151], v[84:87]
    ds_read_b128 v[208:211], v2 offset:384
    buffer_store_dwordx2 v[46:47], v8, s[8:11], s90 offen sc1
    v_mfma_f32_16x16x32_bf16 v[88:91], v[128:131], v[152:155], v[88:91]
    ds_read_b64 v[196:197], v1 offset:1408
    v_mfma_f32_16x16x32_bf16 v[92:95], v[128:131], v[156:159], v[92:95]
    ds_read_b64 v[198:199], v1 offset:1416
    v_mfma_f32_16x16x32_bf16 v[84:87], v[132:135], v[144:147], v[84:87]
    ds_read_b64 v[200:201], v1 offset:896
    v_mfma_f32_16x16x32_bf16 v[88:91], v[132:135], v[148:151], v[88:91]
    ds_read_b64 v[202:203], v1 offset:904
    v_mfma_f32_16x16x32_bf16 v[92:95], v[132:135], v[152:155], v[92:95]
    ds_read_b64 v[204:205], v1 offset:384
    v_mfma_f32_16x16x32_bf16 v[88:91], v[136:139], v[144:147], v[88:91]
    ds_read_b64 v[206:207], v1 offset:392
    v_mfma_f32_16x16x32_bf16 v[92:95], v[136:139], v[148:151], v[92:95]
    v_mfma_f32_16x16x32_bf16 v[92:95], v[140:143], v[144:147], v[92:95]
    s_waitcnt vmcnt(4)
    v_cmp_ne_u32 vcc, s68, v11
    s_cbranch_vccz L_pd_11
L_pl_10:
    s_cmp_eq_u32 s72, 0
    s_cbranch_scc1 L_pd_11
    s_sub_u32 s72, s72, 1
    v_min_u32 v11, 304, v0
    buffer_load_dword v11, v11, s[8:11], s91 offen sc1
    s_waitcnt vmcnt(0)
    v_cmp_ne_u32 vcc, s68, v11
    s_cbranch_vccnz L_pl_10
L_pd_11:
    s_waitcnt lgkmcnt(12)
    v_mfma_f32_16x16x32_bf16 v[80:83], v[176:179], v[224:227], v[80:83]
    ds_read_b64 v[112:113], v1 offset:3904
    s_add_u32 s86, s98, 122880
    v_mfma_f32_16x16x32_bf16 v[84:87], v[176:179], v[228:231], v[84:87]
    ds_read_b64 v[114:115], v1 offset:3912
    buffer_load_dwordx4 a[120:123], v0, s[8:11], s86 offen offset:0 sc1
    v_mfma_f32_16x16x32_bf16 v[88:91], v[176:179], v[232:235], v[88:91]
    ds_read_b128 v[160:163], v2 offset:2368
    v_mfma_f32_16x16x32_bf16 v[92:95], v[176:179], v[236:239], v[92:95]
    ds_read_b128 v[164:167], v2 offset:2880
    v_mfma_f32_16x16x32_bf16 v[80:83], v[180:183], v[220:223], v[80:83]
    ds_read_b128 v[168:171], v2 offset:3392
    v_mfma_f32_16x16x32_bf16 v[84:87], v[180:183], v[224:227], v[84:87]
    ds_read_b128 v[172:175], v2 offset:3904
    buffer_load_dwordx4 a[124:127], v0, s[8:11], s86 offen offset:1024 sc1
    v_mfma_f32_16x16x32_bf16 v[88:91], v[180:183], v[228:231], v[88:91]
    ds_read_b64 v[116:117], v1 offset:3392
    v_mfma_f32_16x16x32_bf16 v[92:95], v[180:183], v[232:235], v[92:95]
    ds_read_b64 v[118:119], v1 offset:3400
    v_mfma_f32_16x16x32_bf16 v[80:83], v[184:187], v[216:219], v[80:83]
    ds_read_b128 v[156:159], v2 offset:1856
    v_mfma_f32_16x16x32_bf16 v[84:87], v[184:187], v[220:223], v[84:87]
    ds_read_b64 v[120:121], v1 offset:2880
    v_mfma_f32_16x16x32_bf16 v[88:91], v[184:187], v[224:227], v[88:91]
    ds_read_b64 v[122:123], v1 offset:2888
    buffer_load_dwordx4 a[128:131], v0, s[8:11], s86 offen offset:2048 sc1
    v_mfma_f32_16x16x32_bf16 v[92:95], v[184:187], v[228:231], v[92:95]
    ds_read_b128 v[152:155], v2 offset:1344
    s_waitcnt lgkmcnt(12)
    v_mfma_f32_16x16x32_bf16 v[80:83], v[188:191], v[212:215], v[80:83]
    ds_read_b64 v[124:125], v1 offset:2368
    s_add_u32 s86, s98, 147456
    v_mfma_f32_16x16x32_bf16 v[84:87], v[188:191], v[216:219], v[84:87]
    ds_read_b64 v[126:127], v1 offset:2376
    v_mfma_f32_16x16x32_bf16 v[88:91], v[188:191], v[220:223], v[88:91]
    ds_read_b128 v[148:151], v2 offset:832
    buffer_load_dwordx4 a[132:135], v0, s[8:11], s86 offen offset:0 sc1
    v_mfma_f32_16x16x32_bf16 v[92:95], v[188:191], v[224:227], v[92:95]
    ds_read_b64 v[128:129], v1 offset:1856
    v_mfma_f32_16x16x32_bf16 v[80:83], v[192:195], v[208:211], v[80:83]
    ds_read_b64 v[130:131], v1 offset:1864
    v_mfma_f32_16x16x32_bf16 v[84:87], v[192:195], v[212:215], v[84:87]
    ds_read_b128 v[144:147], v2 offset:320
    v_mfma_f32_16x16x32_bf16 v[88:91], v[192:195], v[216:219], v[88:91]
    ds_read_b64 v[132:133], v1 offset:1344
    v_mfma_f32_16x16x32_bf16 v[92:95], v[192:195], v[220:223], v[92:95]
    ds_read_b64 v[134:135], v1 offset:1352
    buffer_load_dwordx4 a[136:139], v0, s[8:11], s86 offen offset:1024 sc1
    v_mfma_f32_16x16x32_bf16 v[84:87], v[196:199], v[208:211], v[84:87]
    ds_read_b64 v[136:137], v1 offset:832
    v_mfma_f32_16x16x32_bf16 v[88:91], v[196:199], v[212:215], v[88:91]
    ds_read_b64 v[138:139], v1 offset:840
    v_mfma_f32_16x16x32_bf16 v[92:95], v[196:199], v[216:219], v[92:95]
    ds_read_b64 v[140:141], v1 offset:320
    v_mfma_f32_16x16x32_bf16 v[88:91], v[200:203], v[208:211], v[88:91]
    ds_read_b64 v[142:143], v1 offset:328
    buffer_load_dwordx4 a[140:143], v0, s[8:11], s86 offen offset:2048 sc1
    v_mfma_f32_16x16x32_bf16 v[92:95], v[200:203], v[212:215], v[92:95]
    s_add_u32 s86, s98, 172032
    v_mfma_f32_16x16x32_bf16 v[92:95], v[204:207], v[208:211], v[92:95]
    s_waitcnt vmcnt(6)
    s_barrier
    s_lshl_b32 s85, s67, 6
    s_add_u32 s85, s85, 28344320
    v_mov_b32 v11, s68
    s_add_u32 s85, s85, s83
    s_mov_b64 exec, 1
    buffer_store_dword v11, v0, s[8:11], s85 offen sc1
    s_mov_b64 exec, -1
    s_waitcnt lgkmcnt(12)
    v_mfma_f32_16x16x32_bf16 v[80:83], v[112:115], v[160:163], v[80:83]
    ds_read_b64 v[176:177], v1 offset:3840
    v_mfma_f32_16x16x32_bf16 v[84:87], v[112:115], v[164:167], v[84:87]
    ds_read_b64 v[178:179], v1 offset:3848
    v_mfma_f32_16x16x32_bf16 v[88:91], v[112:115], v[168:171], v[88:91]
    ds_read_b128 v[224:227], v2 offset:2304
    buffer_load_dwordx4 a[144:147], v0, s[8:11], s86 offen offset:0 sc1
    v_mfma_f32_16x16x32_bf16 v[92:95], v[112:115], v[172:175], v[92:95]
    ds_read_b128 v[228:231], v2 offset:2816
    v_mfma_f32_16x16x32_bf16 v[80:83], v[116:119], v[156:159], v[80:83]
    ds_read_b128 v[232:235], v2 offset:3328
    v_mfma_f32_16x16x32_bf16 v[84:87], v[116:119], v[160:163], v[84:87]
    ds_read_b128 v[236:239], v2 offset:3840
    v_mfma_f32_16x16x32_bf16 v[88:91], v[116:119], v[164:167], v[88:91]
    ds_read_b64 v[180:181], v1 offset:3328
    buffer_load_dwordx4 a[148:151], v0, s[8:11], s86 offen offset:1024 sc1
    v_mfma_f32_16x16x32_bf16 v[92:95], v[116:119], v[168:171], v[92:95]
    ds_read_b64 v[182:183], v1 offset:3336
    v_mfma_f32_16x16x32_bf16 v[80:83], v[120:123], v[152:155], v[80:83]
    ds_read_b128 v[220:223], v2 offset:1792
    v_mfma_f32_16x16x32_bf16 v[84:87], v[120:123], v[156:159], v[84:87]
    ds_read_b64 v[184:185], v1 offset:2816
    v_mfma_f32_16x16x32_bf16 v[88:91], v[120:123], v[160:163], v[88:91]
    ds_read_b64 v[186:187], v1 offset:2824
    v_mfma_f32_16x16x32_bf16 v[92:95], v[120:123], v[164:167], v[92:95]
    ds_read_b128 v[216:219], v2 offset:1280
    s_waitcnt lgkmcnt(12)
    v_mfma_f32_16x16x32_bf16 v[80:83], v[124:127], v[148:151], v[80:83]
    ds_read_b64 v[188:189], v1 offset:2304
    buffer_load_dwordx4 a[152:155], v0, s[8:11], s86 offen offset:2048 sc1
    v_mfma_f32_16x16x32_bf16 v[84:87], v[124:127], v[152:155], v[84:87]
    ds_read_b64 v[190:191], v1 offset:2312
    s_add_u32 s86, s98, 196608
    v_mfma_f32_16x16x32_bf16 v[88:91], v[124:127], v[156:159], v[88:91]
    ds_read_b128 v[212:215], v2 offset:768
    v_mfma_f32_16x16x32_bf16 v[92:95], v[124:127], v[160:163], v[92:95]
    ds_read_b64 v[192:193], v1 offset:1792
    v_mfma_f32_16x16x32_bf16 v[80:83], v[128:131], v[144:147], v[80:83]
    ds_read_b64 v[194:195], v1 offset:1800
    buffer_load_dwordx4 a[156:159], v0, s[8:11], s86 offen offset:0 sc1
    v_mfma_f32_16x16x32_bf16 v[84:87], v[128:131], v[148:151], v[84:87]
    ds_read_b128 v[208:211], v2 offset:256
    s_mov_b32 s92, 2621440
    v_mfma_f32_16x16x32_bf16 v[88:91], v[128:131], v[152:155], v[88:91]
    ds_read_b64 v[196:197], v1 offset:1280
    v_mfma_f32_16x16x32_bf16 v[92:95], v[128:131], v[156:159], v[92:95]
    ds_read_b64 v[198:199], v1 offset:1288
    v_mfma_f32_16x16x32_bf16 v[84:87], v[132:135], v[144:147], v[84:87]
    ds_read_b64 v[200:201], v1 offset:768
    v_mfma_f32_16x16x32_bf16 v[88:91], v[132:135], v[148:151], v[88:91]
    ds_read_b64 v[202:203], v1 offset:776
    buffer_load_dwordx2 v[40:41], v7, s[8:11], s92 offen offset:2048 sc1
    v_mfma_f32_16x16x32_bf16 v[92:95], v[132:135], v[152:155], v[92:95]
    ds_read_b64 v[204:205], v1 offset:256
    v_mfma_f32_16x16x32_bf16 v[88:91], v[136:139], v[144:147], v[88:91]
    ds_read_b64 v[206:207], v1 offset:264
    buffer_load_dwordx2 v[42:43], v7, s[8:11], s92 offen offset:2560 sc1
    v_mfma_f32_16x16x32_bf16 v[92:95], v[136:139], v[148:151], v[92:95]
    v_mfma_f32_16x16x32_bf16 v[92:95], v[140:143], v[144:147], v[92:95]
    buffer_load_dwordx2 v[44:45], v7, s[8:11], s92 offen offset:3072 sc1
    s_waitcnt lgkmcnt(12)
    v_mfma_f32_16x16x32_bf16 v[80:83], v[176:179], v[224:227], v[80:83]
    ds_read_b64 v[112:113], v1 offset:3776
    v_mfma_f32_16x16x32_bf16 v[84:87], v[176:179], v[228:231], v[84:87]
    ds_read_b64 v[114:115], v1 offset:3784
    v_mfma_f32_16x16x32_bf16 v[88:91], v[176:179], v[232:235], v[88:91]
    ds_read_b128 v[160:163], v2 offset:2240
    buffer_load_dwordx2 v[46:47], v7, s[8:11], s92 offen offset:3584 sc1
    v_mfma_f32_16x16x32_bf16 v[92:95], v[176:179], v[236:239], v[92:95]
    ds_read_b128 v[164:167], v2 offset:2752
    s_mov_b32 s90, 10485760
    v_mfma_f32_16x16x32_bf16 v[80:83], v[180:183], v[220:223], v[80:83]
    ds_read_b128 v[168:171], v2 offset:3264
    buffer_store_dwordx2 v[16:17], v6, s[8:11], s90 offen sc1
    v_mfma_f32_16x16x32_bf16 v[84:87], v[180:183], v[224:227], v[84:87]
    ds_read_b128 v[172:175], v2 offset:3776
    s_mov_b32 s90, 10813440
    v_mfma_f32_16x16x32_bf16 v[88:91], v[180:183], v[228:231], v[88:91]
    ds_read_b64 v[116:117], v1 offset:3264
    v_mfma_f32_16x16x32_bf16 v[92:95], v[180:183], v[232:235], v[92:95]
    ds_read_b64 v[118:119], v1 offset:3272
    v_mfma_f32_16x16x32_bf16 v[80:83], v[184:187], v[216:219], v[80:83]
    ds_read_b128 v[156:159], v2 offset:1728
    v_mfma_f32_16x16x32_bf16 v[84:87], v[184:187], v[220:223], v[84:87]
    ds_read_b64 v[120:121], v1 offset:2752
    buffer_store_dwordx2 v[18:19], v6, s[8:11], s90 offen sc1
    v_mfma_f32_16x16x32_bf16 v[88:91], v[184:187], v[224:227], v[88:91]
    ds_read_b64 v[122:123], v1 offset:2760
    s_mov_b32 s90, 11141120
    v_mfma_f32_16x16x32_bf16 v[92:95], v[184:187], v[228:231], v[92:95]
    ds_read_b128 v[152:155], v2 offset:1216
    s_waitcnt lgkmcnt(12)
    v_mfma_f32_16x16x32_bf16 v[80:83], v[188:191], v[212:215], v[80:83]
    ds_read_b64 v[124:125], v1 offset:2240
    v_mfma_f32_16x16x32_bf16 v[84:87], v[188:191], v[216:219], v[84:87]
    ds_read_b64 v[126:127], v1 offset:2248
    v_mfma_f32_16x16x32_bf16 v[88:91], v[188:191], v[220:223], v[88:91]
    ds_read_b128 v[148:151], v2 offset:704
    buffer_store_dwordx2 v[20:21], v6, s[8:11], s90 offen sc1
    v_mfma_f32_16x16x32_bf16 v[92:95], v[188:191], v[224:227], v[92:95]
    ds_read_b64 v[128:129], v1 offset:1728
    s_mov_b32 s90, 11468800
    v_mfma_f32_16x16x32_bf16 v[80:83], v[192:195], v[208:211], v[80:83]
    ds_read_b64 v[130:131], v1 offset:1736
    v_mfma_f32_16x16x32_bf16 v[84:87], v[192:195], v[212:215], v[84:87]
    ds_read_b128 v[144:147], v2 offset:192
    v_mfma_f32_16x16x32_bf16 v[88:91], v[192:195], v[216:219], v[88:91]
    ds_read_b64 v[132:133], v1 offset:1216
    v_mfma_f32_16x16x32_bf16 v[92:95], v[192:195], v[220:223], v[92:95]
    ds_read_b64 v[134:135], v1 offset:1224
    buffer_store_dwordx2 v[22:23], v6, s[8:11], s90 offen sc1
    v_mfma_f32_16x16x32_bf16 v[84:87], v[196:199], v[208:211], v[84:87]
    ds_read_b64 v[136:137], v1 offset:704
    v_mfma_f32_16x16x32_bf16 v[88:91], v[196:199], v[212:215], v[88:91]
    ds_read_b64 v[138:139], v1 offset:712
    v_mfma_f32_16x16x32_bf16 v[92:95], v[196:199], v[216:219], v[92:95]
    ds_read_b64 v[140:141], v1 offset:192
    v_mfma_f32_16x16x32_bf16 v[88:91], v[200:203], v[208:211], v[88:91]
    ds_read_b64 v[142:143], v1 offset:200
    v_mfma_f32_16x16x32_bf16 v[92:95], v[200:203], v[212:215], v[92:95]
    buffer_load_dwordx4 a[160:163], v0, s[8:11], s86 offen offset:1024 sc1
    v_mfma_f32_16x16x32_bf16 v[92:95], v[204:207], v[208:211], v[92:95]
    s_waitcnt lgkmcnt(12)
    v_mfma_f32_16x16x32_bf16 v[80:83], v[112:115], v[160:163], v[80:83]
    ds_read_b64 v[176:177], v1 offset:3712
    v_mfma_f32_16x16x32_bf16 v[84:87], v[112:115], v[164:167], v[84:87]
    ds_read_b64 v[178:179], v1 offset:3720
    v_mfma_f32_16x16x32_bf16 v[88:91], v[112:115], v[168:171], v[88:91]
    ds_read_b128 v[224:227], v2 offset:2176
    buffer_load_dwordx4 a[164:167], v0, s[8:11], s86 offen offset:2048 sc1
    v_mfma_f32_16x16x32_bf16 v[92:95], v[112:115], v[172:175], v[92:95]
    ds_read_b128 v[228:231], v2 offset:2688
    s_add_u32 s86, s98, 221184
    v_mfma_f32_16x16x32_bf16 v[80:83], v[116:119], v[156:159], v[80:83]
    ds_read_b128 v[232:235], v2 offset:3200
    v_mfma_f32_16x16x32_bf16 v[84:87], v[116:119], v[160:163], v[84:87]
    ds_read_b128 v[236:239], v2 offset:3712
    v_mfma_f32_16x16x32_bf16 v[88:91], v[116:119], v[164:167], v[88:91]
    ds_read_b64 v[180:181], v1 offset:3200
    v_mfma_f32_16x16x32_bf16 v[92:95], v[116:119], v[168:171], v[92:95]
    ds_read_b64 v[182:183], v1 offset:3208
    buffer_load_dwordx4 a[168:171], v0, s[8:11], s86 offen offset:0 sc1
    v_mfma_f32_16x16x32_bf16 v[80:83], v[120:123], v[152:155], v[80:83]
    ds_read_b128 v[220:223], v2 offset:1664
    v_mfma_f32_16x16x32_bf16 v[84:87], v[120:123], v[156:159], v[84:87]
    ds_read_b64 v[184:185], v1 offset:2688
    v_mfma_f32_16x16x32_bf16 v[88:91], v[120:123], v[160:163], v[88:91]
    ds_read_b64 v[186:187], v1 offset:2696
    v_mfma_f32_16x16x32_bf16 v[92:95], v[120:123], v[164:167], v[92:95]
    ds_read_b128 v[216:219], v2 offset:1152
    s_waitcnt lgkmcnt(12)
    v_mfma_f32_16x16x32_bf16 v[80:83], v[124:127], v[148:151], v[80:83]
    ds_read_b64 v[188:189], v1 offset:2176
    buffer_load_dwordx4 a[172:175], v0, s[8:11], s86 offen offset:1024 sc1
    v_mfma_f32_16x16x32_bf16 v[84:87], v[124:127], v[152:155], v[84:87]
    ds_read_b64 v[190:191], v1 offset:2184
    v_mfma_f32_16x16x32_bf16 v[88:91], v[124:127], v[156:159], v[88:91]
    ds_read_b128 v[212:215], v2 offset:640
    v_mfma_f32_16x16x32_bf16 v[92:95], v[124:127], v[160:163], v[92:95]
    ds_read_b64 v[192:193], v1 offset:1664
    v_mfma_f32_16x16x32_bf16 v[80:83], v[128:131], v[144:147], v[80:83]
    ds_read_b64 v[194:195], v1 offset:1672
    buffer_load_dwordx4 a[176:179], v0, s[8:11], s86 offen offset:2048 sc1
    v_mfma_f32_16x16x32_bf16 v[84:87], v[128:131], v[148:151], v[84:87]
    ds_read_b128 v[208:211], v2 offset:128
    s_add_u32 s86, s99, 122880
    v_mfma_f32_16x16x32_bf16 v[88:91], v[128:131], v[152:155], v[88:91]
    ds_read_b64 v[196:197], v1 offset:1152
    v_mfma_f32_16x16x32_bf16 v[92:95], v[128:131], v[156:159], v[92:95]
    ds_read_b64 v[198:199], v1 offset:1160
    v_mfma_f32_16x16x32_bf16 v[84:87], v[132:135], v[144:147], v[84:87]
    ds_read_b64 v[200:201], v1 offset:640
    v_mfma_f32_16x16x32_bf16 v[88:91], v[132:135], v[148:151], v[88:91]
    ds_read_b64 v[202:203], v1 offset:648
    buffer_load_dwordx4 a[180:183], v0, s[8:11], s86 offen offset:0 sc1
    v_mfma_f32_16x16x32_bf16 v[92:95], v[132:135], v[152:155], v[92:95]
    ds_read_b64 v[204:205], v1 offset:128
    v_mfma_f32_16x16x32_bf16 v[88:91], v[136:139], v[144:147], v[88:91]
    ds_read_b64 v[206:207], v1 offset:136
    v_mfma_f32_16x16x32_bf16 v[92:95], v[136:139], v[148:151], v[92:95]
    v_mfma_f32_16x16x32_bf16 v[92:95], v[140:143], v[144:147], v[92:95]
    buffer_load_dwordx4 a[184:187], v0, s[8:11], s86 offen offset:1024 sc1
    s_waitcnt lgkmcnt(12)
    v_mfma_f32_16x16x32_bf16 v[80:83], v[176:179], v[224:227], v[80:83]
    ds_read_b64 v[112:113], v1 offset:3648
    v_mfma_f32_16x16x32_bf16 v[84:87], v[176:179], v[228:231], v[84:87]
    ds_read_b64 v[114:115], v1 offset:3656
    v_mfma_f32_16x16x32_bf16 v[88:91], v[176:179], v[232:235], v[88:91]
    ds_read_b128 v[160:163], v2 offset:2112
    v_mfma_f32_16x16x32_bf16 v[92:95], v[176:179], v[236:239], v[92:95]
    ds_read_b128 v[164:167], v2 offset:2624
    v_mfma_f32_16x16x32_bf16 v[80:83], v[180:183], v[220:223], v[80:83]
    ds_read_b128 v[168:171], v2 offset:3136
    buffer_load_dwordx4 a[188:191], v0, s[8:11], s86 offen offset:2048 sc1
    v_mfma_f32_16x16x32_bf16 v[84:87], v[180:183], v[224:227], v[84:87]
    ds_read_b128 v[172:175], v2 offset:3648
    s_add_u32 s86, s99, 147456
    v_mfma_f32_16x16x32_bf16 v[88:91], v[180:183], v[228:231], v[88:91]
    ds_read_b64 v[116:117], v1 offset:3136
    v_mfma_f32_16x16x32_bf16 v[92:95], v[180:183], v[232:235], v[92:95]
    ds_read_b64 v[118:119], v1 offset:3144
    v_mfma_f32_16x16x32_bf16 v[80:83], v[184:187], v[216:219], v[80:83]
    ds_read_b128 v[156:159], v2 offset:1600
    buffer_load_dwordx4 a[192:195], v0, s[8:11], s86 offen offset:0 sc1
    v_mfma_f32_16x16x32_bf16 v[84:87], v[184:187], v[220:223], v[84:87]
    ds_read_b64 v[120:121], v1 offset:2624
    v_mfma_f32_16x16x32_bf16 v[88:91], v[184:187], v[224:227], v[88:91]
    ds_read_b64 v[122:123], v1 offset:2632
    v_mfma_f32_16x16x32_bf16 v[92:95], v[184:187], v[228:231], v[92:95]
    ds_read_b128 v[152:155], v2 offset:1088
    s_waitcnt lgkmcnt(12)
    v_mfma_f32_16x16x32_bf16 v[80:83], v[188:191], v[212:215], v[80:83]
    ds_read_b64 v[124:125], v1 offset:2112
    v_mfma_f32_16x16x32_bf16 v[84:87], v[188:191], v[216:219], v[84:87]
    ds_read_b64 v[126:127], v1 offset:2120
    buffer_load_dwordx4 a[196:199], v0, s[8:11], s86 offen offset:1024 sc1
    v_mfma_f32_16x16x32_bf16 v[88:91], v[188:191], v[220:223], v[88:91]
    ds_read_b128 v[148:151], v2 offset:576
    v_mfma_f32_16x16x32_bf16 v[92:95], v[188:191], v[224:227], v[92:95]
    ds_read_b64 v[128:129], v1 offset:1600
    v_mfma_f32_16x16x32_bf16 v[80:83], v[192:195], v[208:211], v[80:83]
    ds_read_b64 v[130:131], v1 offset:1608
    v_mfma_f32_16x16x32_bf16 v[84:87], v[192:195], v[212:215], v[84:87]
    ds_read_b128 v[144:147], v2 offset:64
    buffer_load_dwordx4 a[200:203], v0, s[8:11], s86 offen offset:2048 sc1
    v_mfma_f32_16x16x32_bf16 v[88:91], v[192:195], v[216:219], v[88:91]
    ds_read_b64 v[132:133], v1 offset:1088
    s_add_u32 s86, s99, 172032
    v_mfma_f32_16x16x32_bf16 v[92:95], v[192:195], v[220:223], v[92:95]
    ds_read_b64 v[134:135], v1 offset:1096
    v_mfma_f32_16x16x32_bf16 v[84:87], v[196:199], v[208:211], v[84:87]
    ds_read_b64 v[136:137], v1 offset:576
    v_mfma_f32_16x16x32_bf16 v[88:91], v[196:199], v[212:215], v[88:91]
    ds_read_b64 v[138:139], v1 offset:584
    v_mfma_f32_16x16x32_bf16 v[92:95], v[196:199], v[216:219], v[92:95]
    ds_read_b64 v[140:141], v1 offset:64
    buffer_load_dwordx4 a[204:207], v0, s[8:11], s86 offen offset:0 sc1
    v_mfma_f32_16x16x32_bf16 v[88:91], v[200:203], v[208:211], v[88:91]
    ds_read_b64 v[142:143], v1 offset:72
    v_mfma_f32_16x16x32_bf16 v[92:95], v[200:203], v[212:215], v[92:95]
    v_mfma_f32_16x16x32_bf16 v[92:95], v[204:207], v[208:211], v[92:95]
    s_waitcnt lgkmcnt(12)
    v_mfma_f32_16x16x32_bf16 v[80:83], v[112:115], v[160:163], v[80:83]
    ds_read_b64 v[176:177], v1 offset:3584
    buffer_load_dwordx4 a[208:211], v0, s[8:11], s86 offen offset:1024 sc1
    v_mfma_f32_16x16x32_bf16 v[84:87], v[112:115], v[164:167], v[84:87]
    ds_read_b64 v[178:179], v1 offset:3592
    v_mfma_f32_16x16x32_bf16 v[88:91], v[112:115], v[168:171], v[88:91]
    ds_read_b128 v[224:227], v2 offset:2048
    v_mfma_f32_16x16x32_bf16 v[92:95], v[112:115], v[172:175], v[92:95]
    ds_read_b128 v[228:231], v2 offset:2560
    v_mfma_f32_16x16x32_bf16 v[80:83], v[116:119], v[156:159], v[80:83]
    ds_read_b128 v[232:235], v2 offset:3072
    v_mfma_f32_16x16x32_bf16 v[84:87], v[116:119], v[160:163], v[84:87]
    ds_read_b128 v[236:239], v2 offset:3584
    buffer_load_dwordx4 a[212:215], v0, s[8:11], s86 offen offset:2048 sc1
    v_mfma_f32_16x16x32_bf16 v[88:91], v[116:119], v[164:167], v[88:91]
    ds_read_b64 v[180:181], v1 offset:3072
    s_add_u32 s86, s99, 196608
    v_mfma_f32_16x16x32_bf16 v[92:95], v[116:119], v[168:171], v[92:95]
    ds_read_b64 v[182:183], v1 offset:3080
    v_mfma_f32_16x16x32_bf16 v[80:83], v[120:123], v[152:155], v[80:83]
    ds_read_b128 v[220:223], v2 offset:1536
    v_mfma_f32_16x16x32_bf16 v[84:87], v[120:123], v[156:159], v[84:87]
    ds_read_b64 v[184:185], v1 offset:2560
    buffer_load_dwordx4 a[216:219], v0, s[8:11], s86 offen offset:0 sc1
    v_mfma_f32_16x16x32_bf16 v[88:91], v[120:123], v[160:163], v[88:91]
    ds_read_b64 v[186:187], v1 offset:2568
    v_mfma_f32_16x16x32_bf16 v[92:95], v[120:123], v[164:167], v[92:95]
    ds_read_b128 v[216:219], v2 offset:1024
    s_waitcnt lgkmcnt(12)
    v_mfma_f32_16x16x32_bf16 v[80:83], v[124:127], v[148:151], v[80:83]
    ds_read_b64 v[188:189], v1 offset:2048
    v_mfma_f32_16x16x32_bf16 v[84:87], v[124:127], v[152:155], v[84:87]
    ds_read_b64 v[190:191], v1 offset:2056
    v_mfma_f32_16x16x32_bf16 v[88:91], v[124:127], v[156:159], v[88:91]
    ds_read_b128 v[212:215], v2 offset:512
    buffer_load_dwordx4 a[220:223], v0, s[8:11], s86 offen offset:1024 sc1
    v_mfma_f32_16x16x32_bf16 v[92:95], v[124:127], v[160:163], v[92:95]
    ds_read_b64 v[192:193], v1 offset:1536
    v_mfma_f32_16x16x32_bf16 v[80:83], v[128:131], v[144:147], v[80:83]
    ds_read_b64 v[194:195], v1 offset:1544
    v_mfma_f32_16x16x32_bf16 v[84:87], v[128:131], v[148:151], v[84:87]
    ds_read_b128 v[208:211], v2 offset:0
    v_mfma_f32_16x16x32_bf16 v[88:91], v[128:131], v[152:155], v[88:91]
    ds_read_b64 v[196:197], v1 offset:1024
    buffer_load_dwordx4 a[224:227], v0, s[8:11], s86 offen offset:2048 sc1
    v_mfma_f32_16x16x32_bf16 v[92:95], v[128:131], v[156:159], v[92:95]
    ds_read_b64 v[198:199], v1 offset:1032
    s_add_u32 s86, s99, 221184
    v_mfma_f32_16x16x32_bf16 v[84:87], v[132:135], v[144:147], v[84:87]
    ds_read_b64 v[200:201], v1 offset:512
    v_mfma_f32_16x16x32_bf16 v[88:91], v[132:135], v[148:151], v[88:91]
    ds_read_b64 v[202:203], v1 offset:520
    v_mfma_f32_16x16x32_bf16 v[92:95], v[132:135], v[152:155], v[92:95]
    ds_read_b64 v[204:205], v1 offset:0
    v_mfma_f32_16x16x32_bf16 v[88:91], v[136:139], v[144:147], v[88:91]
    ds_read_b64 v[206:207], v1 offset:8
    buffer_load_dwordx4 a[228:231], v0, s[8:11], s86 offen offset:0 sc1
    v_mfma_f32_16x16x32_bf16 v[92:95], v[136:139], v[148:151], v[92:95]
    v_mfma_f32_16x16x32_bf16 v[92:95], v[140:143], v[144:147], v[92:95]
    s_waitcnt lgkmcnt(12)
    v_mfma_f32_16x16x32_bf16 v[80:83], v[176:179], v[224:227], v[80:83]
    v_mfma_f32_16x16x32_bf16 v[84:87], v[176:179], v[228:231], v[84:87]
    buffer_load_dwordx4 a[232:235], v0, s[8:11], s86 offen offset:1024 sc1
    v_mfma_f32_16x16x32_bf16 v[88:91], v[176:179], v[232:235], v[88:91]
    v_mfma_f32_16x16x32_bf16 v[92:95], v[176:179], v[236:239], v[92:95]
    v_mfma_f32_16x16x32_bf16 v[80:83], v[180:183], v[220:223], v[80:83]
    v_mfma_f32_16x16x32_bf16 v[84:87], v[180:183], v[224:227], v[84:87]
    v_mfma_f32_16x16x32_bf16 v[88:91], v[180:183], v[228:231], v[88:91]
    buffer_load_dwordx4 a[236:239], v0, s[8:11], s86 offen offset:2048 sc1
    v_mfma_f32_16x16x32_bf16 v[92:95], v[180:183], v[232:235], v[92:95]
    v_mfma_f32_16x16x32_bf16 v[80:83], v[184:187], v[216:219], v[80:83]
    v_mfma_f32_16x16x32_bf16 v[84:87], v[184:187], v[220:223], v[84:87]
    v_mfma_f32_16x16x32_bf16 v[88:91], v[184:187], v[224:227], v[88:91]
    v_mfma_f32_16x16x32_bf16 v[92:95], v[184:187], v[228:231], v[92:95]
    s_waitcnt lgkmcnt(0)
    v_mfma_f32_16x16x32_bf16 v[80:83], v[188:191], v[212:215], v[80:83]
    v_mfma_f32_16x16x32_bf16 v[84:87], v[188:191], v[216:219], v[84:87]
    v_mfma_f32_16x16x32_bf16 v[88:91], v[188:191], v[220:223], v[88:91]
    v_mfma_f32_16x16x32_bf16 v[92:95], v[188:191], v[224:227], v[92:95]
    v_mfma_f32_16x16x32_bf16 v[80:83], v[192:195], v[208:211], v[80:83]
    v_mfma_f32_16x16x32_bf16 v[84:87], v[192:195], v[212:215], v[84:87]
    v_mfma_f32_16x16x32_bf16 v[88:91], v[192:195], v[216:219], v[88:91]
    v_mfma_f32_16x16x32_bf16 v[92:95], v[192:195], v[220:223], v[92:95]
    v_mfma_f32_16x16x32_bf16 v[84:87], v[196:199], v[208:211], v[84:87]
    v_mfma_f32_16x16x32_bf16 v[88:91], v[196:199], v[212:215], v[88:91]
    v_mfma_f32_16x16x32_bf16 v[92:95], v[196:199], v[216:219], v[92:95]
    v_mfma_f32_16x16x32_bf16 v[88:91], v[200:203], v[208:211], v[88:91]
    v_mfma_f32_16x16x32_bf16 v[92:95], v[200:203], v[212:215], v[92:95]
    v_mfma_f32_16x16x32_bf16 v[92:95], v[204:207], v[208:211], v[92:95]
    s_mul_i32 s91, s62, 2560
    s_add_u32 s91, s91, 28344320
    v_min_u32 v11, 624, v0
    v_lshlrev_b32 v11, 2, v11
    buffer_load_dword v11, v11, s[8:11], s91 offen sc1
    s_lshl_b32 s93, s65, 10
    s_add_u32 s93, s93, 28606464
    v_min_u32 v24, 752, v0
    buffer_load_dword v24, v24, s[8:11], s93 offen sc1
    ds_read_b64 v[176:177], v3 offset:2048
    ds_read_b64 v[178:179], v3 offset:2560
    ds_read_b64 v[180:181], v3 offset:3072
    ds_read_b64 v[182:183], v3 offset:3584
    ds_read_b128 v[48:51], v9 offset:4096
    ds_read_b128 v[96:99], v9 offset:12288
    ds_read_b128 v[52:55], v9 offset:5120
    ds_read_b128 v[100:103], v9 offset:13312
    ds_read_b128 v[56:59], v9 offset:6144
    ds_read_b128 v[104:107], v9 offset:14336
    ds_read_b128 v[60:63], v9 offset:7168
    ds_read_b128 v[108:111], v9 offset:15360
    s_waitcnt vmcnt(29)
    v_lshlrev_b32 v184, 16, v40
    v_and_b32 v185, s70, v40
    v_lshlrev_b32 v186, 16, v41
    v_and_b32 v187, s70, v41
    s_waitcnt vmcnt(28)
    v_lshlrev_b32 v188, 16, v42
    v_and_b32 v189, s70, v42
    v_lshlrev_b32 v190, 16, v43
    v_and_b32 v191, s70, v43
    s_waitcnt vmcnt(27)
    v_lshlrev_b32 v192, 16, v44
    v_and_b32 v193, s70, v44
    v_lshlrev_b32 v194, 16, v45
    v_and_b32 v195, s70, v45
    s_waitcnt vmcnt(26)
    v_lshlrev_b32 v196, 16, v46
    v_and_b32 v197, s70, v46
    v_lshlrev_b32 v198, 16, v47
    v_and_b32 v199, s70, v47
    s_waitcnt lgkmcnt(11)
    v_dot2_f32_bf16 v80, v176, s95, v80
    v_dot2_f32_bf16 v81, v176, s71, v81
    v_dot2_f32_bf16 v82, v177, s95, v82
    v_dot2_f32_bf16 v83, v177, s71, v83
    s_waitcnt lgkmcnt(10)
    v_dot2_f32_bf16 v84, v178, s95, v84
    v_dot2_f32_bf16 v85, v178, s71, v85
    v_dot2_f32_bf16 v86, v179, s95, v86
    v_dot2_f32_bf16 v87, v179, s71, v87
    s_waitcnt lgkmcnt(9)
    v_dot2_f32_bf16 v88, v180, s95, v88
    v_dot2_f32_bf16 v89, v180, s71, v89
    v_dot2_f32_bf16 v90, v181, s95, v90
    v_dot2_f32_bf16 v91, v181, s71, v91
    s_waitcnt lgkmcnt(8)
    v_dot2_f32_bf16 v92, v182, s95, v92
    v_dot2_f32_bf16 v93, v182, s71, v93
    v_dot2_f32_bf16 v94, v183, s95, v94
    v_dot2_f32_bf16 v95, v183, s71, v95
    s_waitcnt lgkmcnt(6)
    v_pk_fma_f32 v[48:49], v[184:185], v[48:49], v[96:97]
    v_pk_fma_f32 v[50:51], v[186:187], v[50:51], v[98:99]
    s_waitcnt lgkmcnt(4)
    v_pk_fma_f32 v[52:53], v[188:189], v[52:53], v[100:101]
    v_pk_fma_f32 v[54:55], v[190:191], v[54:55], v[102:103]
    s_waitcnt lgkmcnt(2)
    v_pk_fma_f32 v[56:57], v[192:193], v[56:57], v[104:105]
    v_pk_fma_f32 v[58:59], v[194:195], v[58:59], v[106:107]
    s_waitcnt lgkmcnt(0)
    v_pk_fma_f32 v[60:61], v[196:197], v[60:61], v[108:109]
    v_pk_fma_f32 v[62:63], v[198:199], v[62:63], v[110:111]
    v_cvt_pk_bf16_f32 v176, v80, v81
    v_cvt_pk_bf16_f32 v177, v82, v83
    v_lshlrev_b32 v80, 16, v176
    v_and_b32 v81, s70, v176
    v_lshlrev_b32 v82, 16, v177
    v_and_b32 v83, s70, v177
    v_pk_fma_f32 v[184:185], v[48:49], v[80:81], v[184:185]
    v_pk_fma_f32 v[186:187], v[50:51], v[82:83], v[186:187]
    v_cvt_pk_bf16_f32 v40, v184, v185
    v_cvt_pk_bf16_f32 v41, v186, v187
    s_mov_b32 s90, 9175040
    buffer_store_dwordx2 v[40:41], v8, s[8:11], s90 offen sc1
    v_mov_b32 v16, v176
    v_mov_b32 v17, v177
    v_cvt_pk_bf16_f32 v178, v84, v85
    v_cvt_pk_bf16_f32 v179, v86, v87
    v_lshlrev_b32 v84, 16, v178
    v_and_b32 v85, s70, v178
    v_lshlrev_b32 v86, 16, v179
    v_and_b32 v87, s70, v179
    v_pk_fma_f32 v[188:189], v[52:53], v[84:85], v[188:189]
    v_pk_fma_f32 v[190:191], v[54:55], v[86:87], v[190:191]
    v_cvt_pk_bf16_f32 v42, v188, v189
    v_cvt_pk_bf16_f32 v43, v190, v191
    s_mov_b32 s90, 9502720
    buffer_store_dwordx2 v[42:43], v8, s[8:11], s90 offen sc1
    v_mov_b32 v18, v178
    v_mov_b32 v19, v179
    v_cvt_pk_bf16_f32 v180, v88, v89
    v_cvt_pk_bf16_f32 v181, v90, v91
    v_lshlrev_b32 v88, 16, v180
    v_and_b32 v89, s70, v180
    v_lshlrev_b32 v90, 16, v181
    v_and_b32 v91, s70, v181
    v_pk_fma_f32 v[192:193], v[56:57], v[88:89], v[192:193]
    v_pk_fma_f32 v[194:195], v[58:59], v[90:91], v[194:195]
    v_cvt_pk_bf16_f32 v44, v192, v193
    v_cvt_pk_bf16_f32 v45, v194, v195
    s_mov_b32 s90, 9830400
    buffer_store_dwordx2 v[44:45], v8, s[8:11], s90 offen sc1
    v_mov_b32 v20, v180
    v_mov_b32 v21, v181
    v_cvt_pk_bf16_f32 v182, v92, v93
    v_cvt_pk_bf16_f32 v183, v94, v95
    v_lshlrev_b32 v92, 16, v182
    v_and_b32 v93, s70, v182
    v_lshlrev_b32 v94, 16, v183
    v_and_b32 v95, s70, v183
    v_pk_fma_f32 v[196:197], v[60:61], v[92:93], v[196:197]
    v_pk_fma_f32 v[198:199], v[62:63], v[94:95], v[198:199]
    v_cvt_pk_bf16_f32 v46, v196, v197
    v_cvt_pk_bf16_f32 v47, v198, v199
    s_mov_b32 s90, 10158080
    buffer_store_dwordx2 v[46:47], v8, s[8:11], s90 offen sc1
    v_mov_b32 v22, v182
    v_mov_b32 v23, v183
    v_bfe_u32 v5, v0, 8, 1
    v_lshlrev_b32 v5, 5, v5
    v_xor_b32 v5, v5, v0
    s_mul_i32 s84, s62, 5120
    s_mul_i32 s73, s3, 81920
    s_add_u32 s73, s73, s84
    s_add_u32 s73, s73, 7864320
    s_mul_i32 s97, s62, 5120
    s_waitcnt vmcnt(5)
    v_cmp_ne_u32 vcc, s68, v11
    s_cbranch_vccz L_pd_13
L_pl_12:
    s_cmp_eq_u32 s72, 0
    s_cbranch_scc1 L_pd_13
    s_sub_u32 s72, s72, 1
    v_min_u32 v11, 624, v0
    v_lshlrev_b32 v11, 2, v11
    buffer_load_dword v11, v11, s[8:11], s91 offen sc1
    s_waitcnt vmcnt(0)
    v_cmp_ne_u32 vcc, s68, v11
    s_cbranch_vccnz L_pl_12
L_pd_13:
    s_waitcnt vmcnt(4)
    v_cmp_ne_u32 vcc, s68, v24
    s_cbranch_vccz L_pd_15
L_pl_14:
    s_cmp_eq_u32 s72, 0
    s_cbranch_scc1 L_pd_15
    s_sub_u32 s72, s72, 1
    v_min_u32 v24, 752, v0
    buffer_load_dword v24, v24, s[8:11], s93 offen sc1
    s_waitcnt vmcnt(0)
    v_cmp_ne_u32 vcc, s68, v24
    s_cbranch_vccnz L_pl_14
L_pd_15:
    s_waitcnt lgkmcnt(0)
    s_barrier
    s_add_u32 m0, s97, 0
    s_add_u32 s84, s73, 0
    buffer_load_dwordx4 v5, s[8:11], s84 offen offset:0 sc1 lds
    v_mfma_f32_16x16x32_bf16 v[28:31], a[48:51], v[12:15], v[28:31]
    v_mfma_f32_16x16x32_bf16 v[32:35], a[52:55], v[12:15], v[32:35]
    v_mfma_f32_16x16x32_bf16 v[36:39], a[56:59], v[12:15], v[36:39]
    buffer_load_dwordx4 v5, s[8:11], s84 offen offset:1024 sc1 lds
    v_mfma_f32_16x16x32_bf16 v[28:31], a[108:111], v[12:15], v[28:31]
    v_mfma_f32_16x16x32_bf16 v[32:35], a[112:115], v[12:15], v[32:35]
    v_mfma_f32_16x16x32_bf16 v[36:39], a[116:119], v[12:15], v[36:39]
    buffer_load_dwordx4 v5, s[8:11], s84 offen offset:2048 sc1 lds
    v_mfma_f32_16x16x32_bf16 v[28:31], a[120:123], v[12:15], v[28:31]
    v_mfma_f32_16x16x32_bf16 v[32:35], a[124:127], v[12:15], v[32:35]
    v_mfma_f32_16x16x32_bf16 v[36:39], a[128:131], v[12:15], v[36:39]
    buffer_load_dwordx4 v5, s[8:11], s84 offen offset:3072 sc1 lds
    v_mfma_f32_16x16x32_bf16 v[28:31], a[132:135], v[12:15], v[28:31]
    v_mfma_f32_16x16x32_bf16 v[32:35], a[136:139], v[12:15], v[32:35]
    v_mfma_f32_16x16x32_bf16 v[36:39], a[140:143], v[12:15], v[36:39]
    s_add_u32 m0, s97, 4096
    s_add_u32 s84, s73, 4096
    buffer_load_dwordx4 v5, s[8:11], s84 offen sc1 lds
    v_mfma_f32_16x16x32_bf16 v[28:31], a[144:147], v[12:15], v[28:31]
    v_mfma_f32_16x16x32_bf16 v[32:35], a[148:151], v[12:15], v[32:35]
    v_mfma_f32_16x16x32_bf16 v[36:39], a[152:155], v[12:15], v[36:39]
    s_add_u32 m0, s97, 20480
    s_add_u32 s84, s73, 20480
    buffer_load_dwordx4 v5, s[8:11], s84 offen offset:0 sc1 lds
    v_mfma_f32_16x16x32_bf16 v[28:31], a[156:159], v[12:15], v[28:31]
    v_mfma_f32_16x16x32_bf16 v[32:35], a[160:163], v[12:15], v[32:35]
    v_mfma_f32_16x16x32_bf16 v[36:39], a[164:167], v[12:15], v[36:39]
    buffer_load_dwordx4 v5, s[8:11], s84 offen offset:1024 sc1 lds
    v_mfma_f32_16x16x32_bf16 v[28:31], a[168:171], v[12:15], v[28:31]
    v_mfma_f32_16x16x32_bf16 v[32:35], a[172:175], v[12:15], v[32:35]
    v_mfma_f32_16x16x32_bf16 v[36:39], a[176:179], v[12:15], v[36:39]
    buffer_load_dwordx4 v5, s[8:11], s84 offen offset:2048 sc1 lds
    v_mfma_f32_16x16x32_bf16 v[28:31], a[180:183], v[12:15], v[28:31]
    v_mfma_f32_16x16x32_bf16 v[32:35], a[184:187], v[12:15], v[32:35]
    v_mfma_f32_16x16x32_bf16 v[36:39], a[188:191], v[12:15], v[36:39]
    buffer_load_dwordx4 v5, s[8:11], s84 offen offset:3072 sc1 lds
    v_mfma_f32_16x16x32_bf16 v[28:31], a[192:195], v[12:15], v[28:31]
    v_mfma_f32_16x16x32_bf16 v[32:35], a[196:199], v[12:15], v[32:35]
    v_mfma_f32_16x16x32_bf16 v[36:39], a[200:203], v[12:15], v[36:39]
    s_add_u32 m0, s97, 24576
    s_add_u32 s84, s73, 24576
    buffer_load_dwordx4 v5, s[8:11], s84 offen sc1 lds
    v_mfma_f32_16x16x32_bf16 v[28:31], a[204:207], v[12:15], v[28:31]
    v_mfma_f32_16x16x32_bf16 v[32:35], a[208:211], v[12:15], v[32:35]
    v_mfma_f32_16x16x32_bf16 v[36:39], a[212:215], v[12:15], v[36:39]
    s_mov_b32 s90, 11796480
    buffer_store_dwordx2 v[16:17], v6, s[8:11], s90 offen sc1
    v_mfma_f32_16x16x32_bf16 v[28:31], a[216:219], v[12:15], v[28:31]
    v_mfma_f32_16x16x32_bf16 v[32:35], a[220:223], v[12:15], v[32:35]
    v_mfma_f32_16x16x32_bf16 v[36:39], a[224:227], v[12:15], v[36:39]
    s_mov_b32 s90, 12124160
    buffer_store_dwordx2 v[18:19], v6, s[8:11], s90 offen sc1
    v_mfma_f32_16x16x32_bf16 v[28:31], a[228:231], v[12:15], v[28:31]
    v_mfma_f32_16x16x32_bf16 v[32:35], a[232:235], v[12:15], v[32:35]
    v_mfma_f32_16x16x32_bf16 v[36:39], a[236:239], v[12:15], v[36:39]
    s_mov_b32 s90, 12451840
    buffer_store_dwordx2 v[20:21], v6, s[8:11], s90 offen sc1
    s_mov_b32 s90, 12779520
    buffer_store_dwordx2 v[22:23], v6, s[8:11], s90 offen sc1
L_gemm:
    s_lshr_b32 s84, s62, 1
    v_lshrrev_b32 v13, 6, v0
    v_lshlrev_b32 v13, 6, v13
    v_bfe_u32 v11, v0, 4, 2
    v_lshl_add_u32 v13, v11, 3, v13
    v_bfe_u32 v11, v0, 8, 1
    v_xor_b32 v11, s84, v11
    v_lshl_add_u32 v1, v11, 5, v13
    v_xor_b32 v3, 32, v1
    s_mul_i32 s85, s69, 2048
    s_sub_u32 s86, 2048, s85
    v_add_u32 v2, s86, v1
    v_add_u32 v1, s85, v1
    v_add_u32 v4, s86, v3
    v_add_u32 v3, s85, v3
    v_and_b32 v13, 0xf0, v0
    s_lshl_b32 s85, s84, 8
    s_add_u32 s85, s85, 71680
    v_add_u32 v7, s85, v13
    s_lshl_b32 s86, s69, 3
    v_add_u32 v6, s86, v7
    v_lshrrev_b32 v13, 1, v0
    v_add_u32 v13, 72704, v13
    v_bfe_u32 v11, v0, 6, 2
    v_lshrrev_b32 v14, 8, v0
    v_cmp_eq_u32 vcc, v11, v14
    s_nop 1
    v_cndmask_b32 v6, v13, v6, vcc
    v_lshrrev_b32 v13, 9, v0
    v_xor_b32 v13, s84, v13
    s_mov_b32 s85, 98304
    v_mul_lo_u32 v8, v13, s85
    v_and_b32 v13, 0x1f0, v0
    s_mul_i32 s85, s1, 3072
    s_lshl_b32 s86, s62, 9
    s_add_u32 s85, s85, s86
    v_add3_u32 v8, v8, v13, s85
    s_mul_i32 s74, s3, 196608
    s_add_u32 s74, s74, 15728640
    s_lshl_b32 s75, s3, 14
    s_add_u32 s75, s75, 35651584
    v_mov_b32 v12, 0x3f803f80
    v_mov_b32 v13, 0x3f803f80
    v_mov_b32 v14, 0x3f803f80
    v_mov_b32 v15, 0x3f803f80
    s_mov_b32 s76, 0x22222222
    s_mov_b32 s77, 0x22222222
    s_mov_b32 s78, 0x44444444
    s_mov_b32 s79, 0x44444444
    s_mov_b32 s80, 0x88888888
    s_mov_b32 s81, 0x88888888
    s_mul_i32 s96, s62, 20480
    s_add_u32 s96, s96, 81920
    v_add_u32 v9, s96, v0
    s_mul_i32 s95, s65, 245760
    s_mul_i32 s85, s62, 61440
    s_add_u32 s95, s95, s85
    s_add_u32 s95, s95, 33554432
    s_waitcnt vmcnt(9) lgkmcnt(0)
    s_barrier
    s_bfe_u32 s85, s2, 0x20003
    s_lshr_b32 s86, s2, 5
    s_lshl_b32 s86, s86, 1
    s_cmp_eq_u32 s85, 2
    s_cselect_b32 s86, s86, 8
    s_cmp_eq_u32 s85, 3
    s_cselect_b32 s86, 0, s86
    s_cmp_lt_u32 s86, 8
    s_cselect_b32 s98, -1, s67
    v_lshrrev_b32 v10, 8, v0
    v_lshlrev_b32 v10, 4, v10
    s_mul_i32 s88, s62, 192
    s_add_u32 s88, s88, 73728
    v_add_u32 v10, s88, v10
    ds_write_b128 v10, v[28:31] offset:0
    ds_write_b128 v10, v[32:35] offset:64
    ds_write_b128 v10, v[36:39] offset:128
    ds_read_b64_tr_b16 v[40:41], v1 offset:0
    ds_read_b64_tr_b16 v[42:43], v1 offset:1024
    ds_read_b64_tr_b16 v[44:45], v3 offset:0
    ds_read_b64_tr_b16 v[46:47], v3 offset:1024
    ds_read_b64_tr_b16 v[48:49], v1 offset:4096
    ds_read_b64_tr_b16 v[50:51], v1 offset:5120
    ds_read_b64_tr_b16 v[52:53], v3 offset:4096
    ds_read_b64_tr_b16 v[54:55], v3 offset:5120
    s_lshl_b32 s85, s98, 6
    s_add_u32 s85, s85, 28360704
    s_cmp_eq_u32 s98, -1
    s_cselect_b32 s85, 36175872, s85
    v_mov_b32 v11, s68
    s_add_u32 s85, s85, s83
    s_mov_b64 exec, 1
    buffer_store_dword v11, v0, s[8:11], s85 offen sc1
    s_mov_b64 exec, -1
    s_waitcnt lgkmcnt(4)
    v_mfma_f32_16x16x32_bf16 v[64:67], a[0:3], v[40:43], 0
    ds_read_b64_tr_b16 v[56:57], v1 offset:8192
    ds_read_b64_tr_b16 v[58:59], v1 offset:9216
    v_mfma_f32_16x16x32_bf16 v[76:79], a[0:3], v[44:47], 0
    ds_read_b64_tr_b16 v[60:61], v3 offset:8192
    ds_read_b64_tr_b16 v[62:63], v3 offset:9216
    v_mfma_f32_16x16x32_bf16 v[80:83], a[4:7], v[44:47], 0
    s_add_u32 m0, s97, 40960
    s_add_u32 s84, s73, 40960
    buffer_load_dwordx4 v5, s[8:11], s84 offen offset:0 sc1 lds
    v_mfma_f32_16x16x32_bf16 v[68:71], a[4:7], v[40:43], 0
    v_mfma_f32_16x16x32_bf16 v[72:75], a[8:11], v[40:43], 0
    v_mfma_f32_16x16x32_bf16 v[84:87], a[8:11], v[44:47], 0
    v_mfma_f32_16x16x32_bf16 v[16:19], v[12:15], v[40:43], 0
    buffer_load_dwordx4 v5, s[8:11], s84 offen offset:1024 sc1 lds
    v_mfma_f32_16x16x32_bf16 v[20:23], v[40:43], v[40:43], 0
    s_waitcnt lgkmcnt(4)
    v_mfma_f32_16x16x32_bf16 v[64:67], a[12:15], v[48:51], v[64:67]
    ds_read_b64_tr_b16 v[40:41], v1 offset:12288
    ds_read_b64_tr_b16 v[42:43], v1 offset:13312
    v_mfma_f32_16x16x32_bf16 v[76:79], a[12:15], v[52:55], v[76:79]
    ds_read_b64_tr_b16 v[44:45], v3 offset:12288
    ds_read_b64_tr_b16 v[46:47], v3 offset:13312
    v_mfma_f32_16x16x32_bf16 v[80:83], a[16:19], v[52:55], v[80:83]
    v_mfma_f32_16x16x32_bf16 v[68:71], a[16:19], v[48:51], v[68:71]
    buffer_load_dwordx4 v5, s[8:11], s84 offen offset:2048 sc1 lds
    v_mfma_f32_16x16x32_bf16 v[72:75], a[20:23], v[48:51], v[72:75]
    v_mfma_f32_16x16x32_bf16 v[84:87], a[20:23], v[52:55], v[84:87]
    v_mfma_f32_16x16x32_bf16 v[16:19], v[12:15], v[48:51], v[16:19]
    v_mfma_f32_16x16x32_bf16 v[20:23], v[48:51], v[48:51], v[20:23]
    buffer_load_dwordx4 v5, s[8:11], s84 offen offset:3072 sc1 lds
    s_waitcnt lgkmcnt(4)
    v_mfma_f32_16x16x32_bf16 v[64:67], a[24:27], v[56:59], v[64:67]
    ds_read_b64_tr_b16 v[48:49], v1 offset:16384
    ds_read_b64_tr_b16 v[50:51], v1 offset:17408
    v_mfma_f32_16x16x32_bf16 v[76:79], a[24:27], v[60:63], v[76:79]
    ds_read_b64_tr_b16 v[52:53], v3 offset:16384
    ds_read_b64_tr_b16 v[54:55], v3 offset:17408
    v_mfma_f32_16x16x32_bf16 v[80:83], a[28:31], v[60:63], v[80:83]
    s_add_u32 m0, s97, 45056
    s_add_u32 s84, s73, 45056
    v_mfma_f32_16x16x32_bf16 v[68:71], a[28:31], v[56:59], v[68:71]
    v_mfma_f32_16x16x32_bf16 v[72:75], a[32:35], v[56:59], v[72:75]
    buffer_load_dwordx4 v5, s[8:11], s84 offen sc1 lds
    s_add_u32 s86, s95, 0
    v_mfma_f32_16x16x32_bf16 v[84:87], a[32:35], v[60:63], v[84:87]
    v_mfma_f32_16x16x32_bf16 v[16:19], v[12:15], v[56:59], v[16:19]
    v_mfma_f32_16x16x32_bf16 v[20:23], v[56:59], v[56:59], v[20:23]
    s_waitcnt lgkmcnt(4)
    v_mfma_f32_16x16x32_bf16 v[64:67], a[36:39], v[40:43], v[64:67]
    ds_read_b64_tr_b16 v[56:57], v2 offset:0
    ds_read_b64_tr_b16 v[58:59], v2 offset:1024
    v_mfma_f32_16x16x32_bf16 v[76:79], a[36:39], v[44:47], v[76:79]
    ds_read_b64_tr_b16 v[60:61], v4 offset:0
    ds_read_b64_tr_b16 v[62:63], v4 offset:1024
    v_mfma_f32_16x16x32_bf16 v[80:83], a[40:43], v[44:47], v[80:83]
    buffer_load_dwordx4 v[112:115], v0, s[8:11], s86 offen offset:0 sc1
    v_mfma_f32_16x16x32_bf16 v[68:71], a[40:43], v[40:43], v[68:71]
    v_mfma_f32_16x16x32_bf16 v[72:75], a[44:47], v[40:43], v[72:75]
    v_mfma_f32_16x16x32_bf16 v[84:87], a[44:47], v[44:47], v[84:87]
    v_mfma_f32_16x16x32_bf16 v[16:19], v[12:15], v[40:43], v[16:19]
    buffer_load_dwordx4 v[116:119], v0, s[8:11], s86 offen offset:1024 sc1
    v_mfma_f32_16x16x32_bf16 v[20:23], v[40:43], v[40:43], v[20:23]
    s_waitcnt lgkmcnt(4)
    v_mfma_f32_16x16x32_bf16 v[64:67], a[48:51], v[48:51], v[64:67]
    ds_read_b64_tr_b16 v[40:41], v2 offset:4096
    ds_read_b64_tr_b16 v[42:43], v2 offset:5120
    v_mfma_f32_16x16x32_bf16 v[76:79], a[48:51], v[52:55], v[76:79]
    ds_read_b64_tr_b16 v[44:45], v4 offset:4096
    ds_read_b64_tr_b16 v[46:47], v4 offset:5120
    v_mfma_f32_16x16x32_bf16 v[80:83], a[52:55], v[52:55], v[80:83]
    v_mfma_f32_16x16x32_bf16 v[68:71], a[52:55], v[48:51], v[68:71]
    buffer_load_dwordx4 v[120:123], v0, s[8:11], s86 offen offset:2048 sc1
    v_mfma_f32_16x16x32_bf16 v[72:75], a[56:59], v[48:51], v[72:75]
    v_mfma_f32_16x16x32_bf16 v[84:87], a[56:59], v[52:55], v[84:87]
    v_mfma_f32_16x16x32_bf16 v[16:19], v[12:15], v[48:51], v[16:19]
    v_mfma_f32_16x16x32_bf16 v[20:23], v[48:51], v[48:51], v[20:23]
    buffer_load_dwordx4 v[124:127], v0, s[8:11], s86 offen offset:3072 sc1
    s_waitcnt lgkmcnt(4)
    v_mfma_f32_16x16x32_bf16 v[64:67], a[60:63], v[56:59], v[64:67]
    ds_read_b64_tr_b16 v[48:49], v2 offset:8192
    ds_read_b64_tr_b16 v[50:51], v2 offset:9216
    v_mfma_f32_16x16x32_bf16 v[76:79], a[60:63], v[60:63], v[76:79]
    ds_read_b64_tr_b16 v[52:53], v4 offset:8192
    ds_read_b64_tr_b16 v[54:55], v4 offset:9216
    v_mfma_f32_16x16x32_bf16 v[80:83], a[64:67], v[60:63], v[80:83]
    s_add_u32 s86, s86, 4096
    v_mfma_f32_16x16x32_bf16 v[68:71], a[64:67], v[56:59], v[68:71]
    v_mfma_f32_16x16x32_bf16 v[72:75], a[68:71], v[56:59], v[72:75]
    buffer_load_dwordx4 v[128:131], v0, s[8:11], s86 offen offset:0 sc1
    s_add_u32 s86, s95, 5120
    v_mfma_f32_16x16x32_bf16 v[84:87], a[68:71], v[60:63], v[84:87]
    s_waitcnt lgkmcnt(4)
    v_mfma_f32_16x16x32_bf16 v[64:67], a[72:75], v[40:43], v[64:67]
    ds_read_b64_tr_b16 v[56:57], v2 offset:12288
    ds_read_b64_tr_b16 v[58:59], v2 offset:13312
    v_mfma_f32_16x16x32_bf16 v[76:79], a[72:75], v[44:47], v[76:79]
    ds_read_b64_tr_b16 v[60:61], v4 offset:12288
    ds_read_b64_tr_b16 v[62:63], v4 offset:13312
    v_mfma_f32_16x16x32_bf16 v[80:83], a[76:79], v[44:47], v[80:83]
    buffer_load_dwordx4 v[132:135], v0, s[8:11], s86 offen offset:0 sc1
    v_mfma_f32_16x16x32_bf16 v[68:71], a[76:79], v[40:43], v[68:71]
    v_mfma_f32_16x16x32_bf16 v[72:75], a[80:83], v[40:43], v[72:75]
    v_mfma_f32_16x16x32_bf16 v[84:87], a[80:83], v[44:47], v[84:87]
    s_waitcnt lgkmcnt(4)
    v_mfma_f32_16x16x32_bf16 v[64:67], a[84:87], v[48:51], v[64:67]
    ds_read_b64_tr_b16 v[40:41], v2 offset:16384
    ds_read_b64_tr_b16 v[42:43], v2 offset:17408
    v_mfma_f32_16x16x32_bf16 v[76:79], a[84:87], v[52:55], v[76:79]
    ds_read_b64_tr_b16 v[44:45], v4 offset:16384
    ds_read_b64_tr_b16 v[46:47], v4 offset:17408
    v_mfma_f32_16x16x32_bf16 v[80:83], a[88:91], v[52:55], v[80:83]
    buffer_load_dwordx4 v[136:139], v0, s[8:11], s86 offen offset:1024 sc1
    v_mfma_f32_16x16x32_bf16 v[68:71], a[88:91], v[48:51], v[68:71]
    v_mfma_f32_16x16x32_bf16 v[72:75], a[92:95], v[48:51], v[72:75]
    v_mfma_f32_16x16x32_bf16 v[84:87], a[92:95], v[52:55], v[84:87]
    s_waitcnt lgkmcnt(4)
    v_mfma_f32_16x16x32_bf16 v[64:67], a[96:99], v[56:59], v[64:67]
    buffer_load_dwordx4 v[140:143], v0, s[8:11], s86 offen offset:2048 sc1
    v_mfma_f32_16x16x32_bf16 v[76:79], a[96:99], v[60:63], v[76:79]
    v_mfma_f32_16x16x32_bf16 v[80:83], a[100:103], v[60:63], v[80:83]
    s_waitcnt vmcnt(18) lgkmcnt(0)
    s_barrier
    v_mfma_f32_16x16x32_bf16 v[68:71], a[100:103], v[56:59], v[68:71]
    ds_read_b64_tr_b16 v[48:49], v1 offset:20480
    ds_read_b64_tr_b16 v[50:51], v1 offset:21504
    v_mfma_f32_16x16x32_bf16 v[72:75], a[104:107], v[56:59], v[72:75]
    ds_read_b64_tr_b16 v[52:53], v3 offset:20480
    ds_read_b64_tr_b16 v[54:55], v3 offset:21504
    v_mfma_f32_16x16x32_bf16 v[84:87], a[104:107], v[60:63], v[84:87]
    buffer_load_dwordx4 v[144:147], v0, s[8:11], s86 offen offset:3072 sc1
    v_mfma_f32_16x16x32_bf16 v[64:67], a[108:111], v[40:43], v[64:67]
    ds_read_b64_tr_b16 v[56:57], v1 offset:24576
    ds_read_b64_tr_b16 v[58:59], v1 offset:25600
    v_mfma_f32_16x16x32_bf16 v[76:79], a[108:111], v[44:47], v[76:79]
    ds_read_b64_tr_b16 v[60:61], v3 offset:24576
    ds_read_b64_tr_b16 v[62:63], v3 offset:25600
    v_mfma_f32_16x16x32_bf16 v[80:83], a[112:115], v[44:47], v[80:83]
    s_add_u32 s86, s86, 4096
    v_mfma_f32_16x16x32_bf16 v[68:71], a[112:115], v[40:43], v[68:71]
    buffer_load_dwordx4 v[148:151], v0, s[8:11], s86 offen offset:0 sc1
    v_mfma_f32_16x16x32_bf16 v[72:75], a[116:119], v[40:43], v[72:75]
    v_mfma_f32_16x16x32_bf16 v[84:87], a[116:119], v[44:47], v[84:87]
    s_add_u32 s86, s95, 10240
    s_waitcnt lgkmcnt(4)
    v_mfma_f32_16x16x32_bf16 v[64:67], a[120:123], v[48:51], v[64:67]
    ds_read_b64_tr_b16 v[40:41], v1 offset:28672
    ds_read_b64_tr_b16 v[42:43], v1 offset:29696
    v_mfma_f32_16x16x32_bf16 v[76:79], a[120:123], v[52:55], v[76:79]
    ds_read_b64_tr_b16 v[44:45], v3 offset:28672
    ds_read_b64_tr_b16 v[46:47], v3 offset:29696
    v_mfma_f32_16x16x32_bf16 v[80:83], a[124:127], v[52:55], v[80:83]
    s_add_u32 m0, s97, 0
    s_add_u32 s84, s73, 61440
    buffer_load_dwordx4 v5, s[8:11], s84 offen offset:0 sc1 lds
    v_mfma_f32_16x16x32_bf16 v[68:71], a[124:127], v[48:51], v[68:71]
    v_mfma_f32_16x16x32_bf16 v[72:75], a[128:131], v[48:51], v[72:75]
    v_mfma_f32_16x16x32_bf16 v[84:87], a[128:131], v[52:55], v[84:87]
    v_mfma_f32_16x16x32_bf16 v[16:19], v[12:15], v[48:51], v[16:19]
    buffer_load_dwordx4 v5, s[8:11], s84 offen offset:1024 sc1 lds
    v_mfma_f32_16x16x32_bf16 v[20:23], v[48:51], v[48:51], v[20:23]
    s_waitcnt lgkmcnt(4)
    v_mfma_f32_16x16x32_bf16 v[64:67], a[132:135], v[56:59], v[64:67]
    ds_read_b64_tr_b16 v[48:49], v1 offset:32768
    ds_read_b64_tr_b16 v[50:51], v1 offset:33792
    v_mfma_f32_16x16x32_bf16 v[76:79], a[132:135], v[60:63], v[76:79]
    ds_read_b64_tr_b16 v[52:53], v3 offset:32768
    ds_read_b64_tr_b16 v[54:55], v3 offset:33792
    v_mfma_f32_16x16x32_bf16 v[80:83], a[136:139], v[60:63], v[80:83]
    v_mfma_f32_16x16x32_bf16 v[68:71], a[136:139], v[56:59], v[68:71]
    buffer_load_dwordx4 v5, s[8:11], s84 offen offset:2048 sc1 lds
    v_mfma_f32_16x16x32_bf16 v[72:75], a[140:143], v[56:59], v[72:75]
    v_mfma_f32_16x16x32_bf16 v[84:87], a[140:143], v[60:63], v[84:87]
    v_mfma_f32_16x16x32_bf16 v[16:19], v[12:15], v[56:59], v[16:19]
    v_mfma_f32_16x16x32_bf16 v[20:23], v[56:59], v[56:59], v[20:23]
    buffer_load_dwordx4 v5, s[8:11], s84 offen offset:3072 sc1 lds
    s_waitcnt lgkmcnt(4)
    v_mfma_f32_16x16x32_bf16 v[64:67], a[144:147], v[40:43], v[64:67]
    ds_read_b64_tr_b16 v[56:57], v1 offset:36864
    ds_read_b64_tr_b16 v[58:59], v1 offset:37888
    v_mfma_f32_16x16x32_bf16 v[76:79], a[144:147], v[44:47], v[76:79]
    ds_read_b64_tr_b16 v[60:61], v3 offset:36864
    ds_read_b64_tr_b16 v[62:63], v3 offset:37888
    v_mfma_f32_16x16x32_bf16 v[80:83], a[148:151], v[44:47], v[80:83]
    s_add_u32 m0, s97, 4096
    s_add_u32 s84, s73, 65536
    v_mfma_f32_16x16x32_bf16 v[68:71], a[148:151], v[40:43], v[68:71]
    v_mfma_f32_16x16x32_bf16 v[72:75], a[152:155], v[40:43], v[72:75]
    buffer_load_dwordx4 v5, s[8:11], s84 offen sc1 lds
    v_mfma_f32_16x16x32_bf16 v[84:87], a[152:155], v[44:47], v[84:87]
    v_mfma_f32_16x16x32_bf16 v[16:19], v[12:15], v[40:43], v[16:19]
    v_mfma_f32_16x16x32_bf16 v[20:23], v[40:43], v[40:43], v[20:23]
    s_waitcnt lgkmcnt(4)
    v_mfma_f32_16x16x32_bf16 v[64:67], a[156:159], v[48:51], v[64:67]
    ds_read_b64_tr_b16 v[40:41], v2 offset:20480
    ds_read_b64_tr_b16 v[42:43], v2 offset:21504
    v_mfma_f32_16x16x32_bf16 v[76:79], a[156:159], v[52:55], v[76:79]
    ds_read_b64_tr_b16 v[44:45], v4 offset:20480
    ds_read_b64_tr_b16 v[46:47], v4 offset:21504
    v_mfma_f32_16x16x32_bf16 v[80:83], a[160:163], v[52:55], v[80:83]
    buffer_load_dwordx4 v[152:155], v0, s[8:11], s86 offen offset:0 sc1
    v_mfma_f32_16x16x32_bf16 v[68:71], a[160:163], v[48:51], v[68:71]
    v_mfma_f32_16x16x32_bf16 v[72:75], a[164:167], v[48:51], v[72:75]
    v_mfma_f32_16x16x32_bf16 v[84:87], a[164:167], v[52:55], v[84:87]
    v_mfma_f32_16x16x32_bf16 v[16:19], v[12:15], v[48:51], v[16:19]
    buffer_load_dwordx4 v[156:159], v0, s[8:11], s86 offen offset:1024 sc1
    v_mfma_f32_16x16x32_bf16 v[20:23], v[48:51], v[48:51], v[20:23]
    s_waitcnt lgkmcnt(4)
    v_mfma_f32_16x16x32_bf16 v[64:67], a[168:171], v[56:59], v[64:67]
    ds_read_b64_tr_b16 v[48:49], v2 offset:24576
    ds_read_b64_tr_b16 v[50:51], v2 offset:25600
    v_mfma_f32_16x16x32_bf16 v[76:79], a[168:171], v[60:63], v[76:79]
    ds_read_b64_tr_b16 v[52:53], v4 offset:24576
    ds_read_b64_tr_b16 v[54:55], v4 offset:25600
    v_mfma_f32_16x16x32_bf16 v[80:83], a[172:175], v[60:63], v[80:83]
    v_mfma_f32_16x16x32_bf16 v[68:71], a[172:175], v[56:59], v[68:71]
    buffer_load_dwordx4 v[160:163], v0, s[8:11], s86 offen offset:2048 sc1
    v_mfma_f32_16x16x32_bf16 v[72:75], a[176:179], v[56:59], v[72:75]
    v_mfma_f32_16x16x32_bf16 v[84:87], a[176:179], v[60:63], v[84:87]
    v_mfma_f32_16x16x32_bf16 v[16:19], v[12:15], v[56:59], v[16:19]
    v_mfma_f32_16x16x32_bf16 v[20:23], v[56:59], v[56:59], v[20:23]
    buffer_load_dwordx4 v[164:167], v0, s[8:11], s86 offen offset:3072 sc1
    s_waitcnt lgkmcnt(4)
    v_mfma_f32_16x16x32_bf16 v[64:67], a[180:183], v[40:43], v[64:67]
    ds_read_b64_tr_b16 v[56:57], v2 offset:28672
    ds_read_b64_tr_b16 v[58:59], v2 offset:29696
    v_mfma_f32_16x16x32_bf16 v[76:79], a[180:183], v[44:47], v[76:79]
    ds_read_b64_tr_b16 v[60:61], v4 offset:28672
    ds_read_b64_tr_b16 v[62:63], v4 offset:29696
    v_mfma_f32_16x16x32_bf16 v[80:83], a[184:187], v[44:47], v[80:83]
    s_add_u32 s86, s86, 4096
    v_mfma_f32_16x16x32_bf16 v[68:71], a[184:187], v[40:43], v[68:71]
    v_mfma_f32_16x16x32_bf16 v[72:75], a[188:191], v[40:43], v[72:75]
    buffer_load_dwordx4 v[168:171], v0, s[8:11], s86 offen offset:0 sc1
    s_add_u32 s86, s95, 15360
    v_mfma_f32_16x16x32_bf16 v[84:87], a[188:191], v[44:47], v[84:87]
    s_waitcnt lgkmcnt(4)
    v_mfma_f32_16x16x32_bf16 v[64:67], a[192:195], v[48:51], v[64:67]
    ds_read_b64_tr_b16 v[40:41], v2 offset:32768
    ds_read_b64_tr_b16 v[42:43], v2 offset:33792
    v_mfma_f32_16x16x32_bf16 v[76:79], a[192:195], v[52:55], v[76:79]
    ds_read_b64_tr_b16 v[44:45], v4 offset:32768
    ds_read_b64_tr_b16 v[46:47], v4 offset:33792
    v_mfma_f32_16x16x32_bf16 v[80:83], a[196:199], v[52:55], v[80:83]
    buffer_load_dwordx4 v[172:175], v0, s[8:11], s86 offen offset:0 sc1
    v_cndmask_b32 v39, v20, v21, s[76:77]
    v_mfma_f32_16x16x32_bf16 v[68:71], a[196:199], v[48:51], v[68:71]
    v_cndmask_b32 v39, v39, v22, s[78:79]
    v_cndmask_b32 v39, v39, v23, s[80:81]
    v_mfma_f32_16x16x32_bf16 v[72:75], a[200:203], v[48:51], v[72:75]
    v_mov_b32 v38, v16
    ds_write_b64 v6, v[38:39] offset:0
    v_mfma_f32_16x16x32_bf16 v[84:87], a[200:203], v[52:55], v[84:87]
    s_waitcnt lgkmcnt(5)
    v_mfma_f32_16x16x32_bf16 v[64:67], a[204:207], v[56:59], v[64:67]
    ds_read_b64_tr_b16 v[48:49], v2 offset:36864
    ds_read_b64_tr_b16 v[50:51], v2 offset:37888
    v_mfma_f32_16x16x32_bf16 v[76:79], a[204:207], v[60:63], v[76:79]
    ds_read_b64_tr_b16 v[52:53], v4 offset:36864
    ds_read_b64_tr_b16 v[54:55], v4 offset:37888
    v_mfma_f32_16x16x32_bf16 v[80:83], a[208:211], v[60:63], v[80:83]
    buffer_load_dwordx4 v[176:179], v0, s[8:11], s86 offen offset:1024 sc1
    v_mfma_f32_16x16x32_bf16 v[68:71], a[208:211], v[56:59], v[68:71]
    v_mfma_f32_16x16x32_bf16 v[72:75], a[212:215], v[56:59], v[72:75]
    v_mfma_f32_16x16x32_bf16 v[84:87], a[212:215], v[60:63], v[84:87]
    s_waitcnt lgkmcnt(5)
    v_mfma_f32_16x16x32_bf16 v[64:67], a[216:219], v[40:43], v[64:67]
    buffer_load_dwordx4 v[180:183], v0, s[8:11], s86 offen offset:2048 sc1
    v_mfma_f32_16x16x32_bf16 v[76:79], a[216:219], v[44:47], v[76:79]
    v_mfma_f32_16x16x32_bf16 v[80:83], a[220:223], v[44:47], v[80:83]
    s_waitcnt vmcnt(23) lgkmcnt(0)
    s_barrier
    v_mfma_f32_16x16x32_bf16 v[68:71], a[220:223], v[40:43], v[68:71]
    ds_read_b64_tr_b16 v[56:57], v1 offset:40960
    ds_read_b64_tr_b16 v[58:59], v1 offset:41984
    v_mfma_f32_16x16x32_bf16 v[72:75], a[224:227], v[40:43], v[72:75]
    ds_read_b64_tr_b16 v[60:61], v3 offset:40960
    ds_read_b64_tr_b16 v[62:63], v3 offset:41984
    v_mfma_f32_16x16x32_bf16 v[84:87], a[224:227], v[44:47], v[84:87]
    buffer_load_dwordx4 v[184:187], v0, s[8:11], s86 offen offset:3072 sc1
    v_mfma_f32_16x16x32_bf16 v[64:67], a[228:231], v[48:51], v[64:67]
    ds_read_b64_tr_b16 v[40:41], v1 offset:45056
    ds_read_b64_tr_b16 v[42:43], v1 offset:46080
    v_mfma_f32_16x16x32_bf16 v[76:79], a[228:231], v[52:55], v[76:79]
    ds_read_b64_tr_b16 v[44:45], v3 offset:45056
    ds_read_b64_tr_b16 v[46:47], v3 offset:46080
    v_mfma_f32_16x16x32_bf16 v[80:83], a[232:235], v[52:55], v[80:83]
    s_add_u32 s86, s86, 4096
    s_lshl_b32 s85, s98, 6
    s_add_u32 s85, s85, 28622848
    v_mfma_f32_16x16x32_bf16 v[68:71], a[232:235], v[48:51], v[68:71]
    buffer_load_dwordx4 v[188:191], v0, s[8:11], s86 offen offset:0 sc1
    s_add_u32 s86, s95, 20480
    v_mfma_f32_16x16x32_bf16 v[72:75], a[236:239], v[48:51], v[72:75]
    s_cmp_eq_u32 s98, -1
    s_cselect_b32 s85, 36175872, s85
    v_mfma_f32_16x16x32_bf16 v[84:87], a[236:239], v[52:55], v[84:87]
    v_mov_b32 v11, s68
    s_add_u32 s85, s85, s83
    s_mov_b64 exec, 1
    buffer_store_dword v11, v0, s[8:11], s85 offen sc1
    s_mov_b64 exec, -1
    s_waitcnt lgkmcnt(4)
    v_mfma_f32_16x16x32_bf16 v[88:91], a[0:3], v[56:59], 0
    ds_read_b64_tr_b16 v[48:49], v1 offset:49152
    ds_read_b64_tr_b16 v[50:51], v1 offset:50176
    v_mfma_f32_16x16x32_bf16 v[100:103], a[0:3], v[60:63], 0
    ds_read_b64_tr_b16 v[52:53], v3 offset:49152
    ds_read_b64_tr_b16 v[54:55], v3 offset:50176
    v_mfma_f32_16x16x32_bf16 v[104:107], a[4:7], v[60:63], 0
    buffer_load_dwordx4 v[192:195], v0, s[8:11], s86 offen offset:0 sc1
    s_mul_i32 s91, s62, 2560
    s_add_u32 s91, s91, 28360704
    v_mfma_f32_16x16x32_bf16 v[92:95], a[4:7], v[56:59], 0
    v_min_u32 v11, 624, v0
    v_lshlrev_b32 v11, 2, v11
    v_mfma_f32_16x16x32_bf16 v[96:99], a[8:11], v[56:59], 0
    buffer_load_dword v11, v11, s[8:11], s91 offen sc1
    ds_read_b128 v[28:31], v7 offset:0
    v_mfma_f32_16x16x32_bf16 v[108:111], a[8:11], v[60:63], 0
    v_xor_b32 v36, 256, v7
    ds_read_b128 v[32:35], v36 offset:0
    v_mfma_f32_16x16x32_bf16 v[16:19], v[12:15], v[56:59], 0
    v_mfma_f32_16x16x32_bf16 v[20:23], v[56:59], v[56:59], 0
    buffer_load_dwordx4 v[196:199], v0, s[8:11], s86 offen offset:1024 sc1
    s_waitcnt lgkmcnt(6)
    v_mfma_f32_16x16x32_bf16 v[88:91], a[12:15], v[40:43], v[88:91]
    ds_read_b64_tr_b16 v[56:57], v1 offset:53248
    ds_read_b64_tr_b16 v[58:59], v1 offset:54272
    v_mfma_f32_16x16x32_bf16 v[100:103], a[12:15], v[44:47], v[100:103]
    ds_read_b64_tr_b16 v[60:61], v3 offset:53248
    ds_read_b64_tr_b16 v[62:63], v3 offset:54272
    v_mfma_f32_16x16x32_bf16 v[104:107], a[16:19], v[44:47], v[104:107]
    s_waitcnt lgkmcnt(5)
    v_add_f32 v28, v28, v30
    v_add_f32 v29, v29, v31
    v_mfma_f32_16x16x32_bf16 v[92:95], a[16:19], v[40:43], v[92:95]
    buffer_load_dwordx4 v[200:203], v0, s[8:11], s86 offen offset:2048 sc1
    s_waitcnt lgkmcnt(4)
    v_add_f32 v32, v32, v34
    v_mfma_f32_16x16x32_bf16 v[96:99], a[20:23], v[40:43], v[96:99]
    v_add_f32 v33, v33, v35
    v_mul_f32 v24, 0xbacccccd, v28
    v_mfma_f32_16x16x32_bf16 v[108:111], a[20:23], v[44:47], v[108:111]
    v_mov_b32 v26, 0x3727c5ac
    v_fmac_f32 v26, 0x3acccccd, v29
    v_mfma_f32_16x16x32_bf16 v[16:19], v[12:15], v[40:43], v[16:19]
    v_mul_f32 v25, 0xbacccccd, v32
    v_mov_b32 v27, 0x3727c5ac
    v_mfma_f32_16x16x32_bf16 v[20:23], v[40:43], v[40:43], v[20:23]
    v_fmac_f32 v27, 0x3acccccd, v33
    v_mfma_f32_16x16x32_bf16 v[88:91], a[24:27], v[48:51], v[88:91]
    ds_read_b64_tr_b16 v[40:41], v1 offset:57344
    ds_read_b64_tr_b16 v[42:43], v1 offset:58368
    v_mfma_f32_16x16x32_bf16 v[100:103], a[24:27], v[52:55], v[100:103]
    ds_read_b64_tr_b16 v[44:45], v3 offset:57344
    ds_read_b64_tr_b16 v[46:47], v3 offset:58368
    v_mfma_f32_16x16x32_bf16 v[104:107], a[28:31], v[52:55], v[104:107]
    buffer_load_dwordx4 v[204:207], v0, s[8:11], s86 offen offset:3072 sc1
    s_add_u32 s86, s86, 4096
    v_mfma_f32_16x16x32_bf16 v[92:95], a[28:31], v[48:51], v[92:95]
    ds_read_b128 v[28:31], v10 offset:0
    ds_read_b128 v[32:35], v10 offset:64
    v_mfma_f32_16x16x32_bf16 v[96:99], a[32:35], v[48:51], v[96:99]
    ds_read_b128 v[36:39], v10 offset:128
    v_fma_f32 v26, -v24, v24, v26
    v_mfma_f32_16x16x32_bf16 v[108:111], a[32:35], v[52:55], v[108:111]
    v_max_f32 v26, 0x3727c5ac, v26
    v_fma_f32 v27, -v25, v25, v27
    v_mfma_f32_16x16x32_bf16 v[16:19], v[12:15], v[48:51], v[16:19]
    buffer_load_dwordx4 v[208:211], v0, s[8:11], s86 offen offset:0 sc1
    v_max_f32 v27, 0x3727c5ac, v27
    v_mfma_f32_16x16x32_bf16 v[20:23], v[48:51], v[48:51], v[20:23]
    v_rcp_f32 v26, v26
    s_waitcnt lgkmcnt(7)
    v_mfma_f32_16x16x32_bf16 v[88:91], a[36:39], v[56:59], v[88:91]
    ds_read_b64_tr_b16 v[48:49], v2 offset:40960
    ds_read_b64_tr_b16 v[50:51], v2 offset:41984
    v_mfma_f32_16x16x32_bf16 v[100:103], a[36:39], v[60:63], v[100:103]
    ds_read_b64_tr_b16 v[52:53], v4 offset:40960
    ds_read_b64_tr_b16 v[54:55], v4 offset:41984
    v_mfma_f32_16x16x32_bf16 v[104:107], a[40:43], v[60:63], v[104:107]
    v_rcp_f32 v27, v27
    v_mfma_f32_16x16x32_bf16 v[92:95], a[40:43], v[56:59], v[92:95]
    v_mfma_f32_16x16x32_bf16 v[96:99], a[44:47], v[56:59], v[96:99]
    s_waitcnt lgkmcnt(6)
    v_fmac_f32 v64, v24, v28
    v_fmac_f32 v65, v24, v29
    v_mfma_f32_16x16x32_bf16 v[108:111], a[44:47], v[60:63], v[108:111]
    v_fmac_f32 v66, v24, v30
    v_fmac_f32 v67, v24, v31
    v_mfma_f32_16x16x32_bf16 v[16:19], v[12:15], v[56:59], v[16:19]
    s_add_u32 s86, s95, 25600
    buffer_load_dwordx4 v[212:215], v0, s[8:11], s86 offen offset:0 sc1
    v_mfma_f32_16x16x32_bf16 v[20:23], v[56:59], v[56:59], v[20:23]
    s_waitcnt lgkmcnt(5)
    v_fmac_f32 v68, v24, v32
    v_mfma_f32_16x16x32_bf16 v[88:91], a[48:51], v[40:43], v[88:91]
    ds_read_b64_tr_b16 v[56:57], v2 offset:45056
    ds_read_b64_tr_b16 v[58:59], v2 offset:46080
    v_mfma_f32_16x16x32_bf16 v[100:103], a[48:51], v[44:47], v[100:103]
    ds_read_b64_tr_b16 v[60:61], v4 offset:45056
    ds_read_b64_tr_b16 v[62:63], v4 offset:46080
    v_mfma_f32_16x16x32_bf16 v[104:107], a[52:55], v[44:47], v[104:107]
    buffer_load_dwordx4 v[216:219], v0, s[8:11], s86 offen offset:1024 sc1
    v_fmac_f32 v69, v24, v33
    v_mfma_f32_16x16x32_bf16 v[92:95], a[52:55], v[40:43], v[92:95]
    v_fmac_f32 v70, v24, v34
    v_fmac_f32 v71, v24, v35
    v_mfma_f32_16x16x32_bf16 v[96:99], a[56:59], v[40:43], v[96:99]
    s_waitcnt lgkmcnt(8)
    v_fmac_f32 v72, v24, v36
    v_fmac_f32 v73, v24, v37
    v_mfma_f32_16x16x32_bf16 v[108:111], a[56:59], v[44:47], v[108:111]
    v_fmac_f32 v74, v24, v38
    v_fmac_f32 v75, v24, v39
    v_mfma_f32_16x16x32_bf16 v[16:19], v[12:15], v[40:43], v[16:19]
    v_fmac_f32 v76, v25, v28
    v_fmac_f32 v77, v25, v29
    v_mfma_f32_16x16x32_bf16 v[20:23], v[40:43], v[40:43], v[20:23]
    buffer_load_dwordx4 v[220:223], v0, s[8:11], s86 offen offset:2048 sc1
    s_waitcnt lgkmcnt(4)
    v_mfma_f32_16x16x32_bf16 v[88:91], a[60:63], v[48:51], v[88:91]
    ds_read_b64_tr_b16 v[40:41], v2 offset:49152
    ds_read_b64_tr_b16 v[42:43], v2 offset:50176
    v_mfma_f32_16x16x32_bf16 v[100:103], a[60:63], v[52:55], v[100:103]
    ds_read_b64_tr_b16 v[44:45], v4 offset:49152
    ds_read_b64_tr_b16 v[46:47], v4 offset:50176
    v_mfma_f32_16x16x32_bf16 v[104:107], a[64:67], v[52:55], v[104:107]
    v_fmac_f32 v78, v25, v30
    v_fmac_f32 v79, v25, v31
    v_mfma_f32_16x16x32_bf16 v[92:95], a[64:67], v[48:51], v[92:95]
    buffer_load_dwordx4 v[224:227], v0, s[8:11], s86 offen offset:3072 sc1
    s_add_u32 s86, s86, 4096
    v_mfma_f32_16x16x32_bf16 v[96:99], a[68:71], v[48:51], v[96:99]
    v_fmac_f32 v80, v25, v32
    v_fmac_f32 v81, v25, v33
    v_mfma_f32_16x16x32_bf16 v[108:111], a[68:71], v[52:55], v[108:111]
    v_fmac_f32 v82, v25, v34
    s_waitcnt lgkmcnt(4)
    v_mfma_f32_16x16x32_bf16 v[88:91], a[72:75], v[56:59], v[88:91]
    ds_read_b64_tr_b16 v[48:49], v2 offset:53248
    ds_read_b64_tr_b16 v[50:51], v2 offset:54272
    v_mfma_f32_16x16x32_bf16 v[100:103], a[72:75], v[60:63], v[100:103]
    ds_read_b64_tr_b16 v[52:53], v4 offset:53248
    ds_read_b64_tr_b16 v[54:55], v4 offset:54272
    v_mfma_f32_16x16x32_bf16 v[104:107], a[76:79], v[60:63], v[104:107]
    buffer_load_dwordx4 v[228:231], v0, s[8:11], s86 offen offset:0 sc1
    v_fmac_f32 v83, v25, v35
    v_mfma_f32_16x16x32_bf16 v[92:95], a[76:79], v[56:59], v[92:95]
    v_fmac_f32 v84, v25, v36
    v_fmac_f32 v85, v25, v37
    v_mfma_f32_16x16x32_bf16 v[96:99], a[80:83], v[56:59], v[96:99]
    v_fmac_f32 v86, v25, v38
    v_fmac_f32 v87, v25, v39
    v_mfma_f32_16x16x32_bf16 v[108:111], a[80:83], v[60:63], v[108:111]
    v_permlane32_swap_b32 v72, v74
    s_waitcnt lgkmcnt(4)
    v_mfma_f32_16x16x32_bf16 v[88:91], a[84:87], v[40:43], v[88:91]
    ds_read_b64_tr_b16 v[56:57], v2 offset:57344
    ds_read_b64_tr_b16 v[58:59], v2 offset:58368
    v_mfma_f32_16x16x32_bf16 v[100:103], a[84:87], v[44:47], v[100:103]
    ds_read_b64_tr_b16 v[60:61], v4 offset:57344
    ds_read_b64_tr_b16 v[62:63], v4 offset:58368
    v_mfma_f32_16x16x32_bf16 v[104:107], a[88:91], v[44:47], v[104:107]
    v_permlane32_swap_b32 v73, v75
    v_mfma_f32_16x16x32_bf16 v[92:95], a[88:91], v[40:43], v[92:95]
    v_max_f32 v64, 0, v64
    v_mul_f32 v68, v26, v68
    v_mfma_f32_16x16x32_bf16 v[96:99], a[92:95], v[40:43], v[96:99]
    v_max_f32 v65, 0, v65
    v_mul_f32 v69, v26, v69
    v_mfma_f32_16x16x32_bf16 v[108:111], a[92:95], v[44:47], v[108:111]
    v_max_f32 v66, 0, v66
    s_waitcnt lgkmcnt(4)
    v_mfma_f32_16x16x32_bf16 v[88:91], a[96:99], v[48:51], v[88:91]
    v_mul_f32 v70, v26, v70
    v_max_f32 v67, 0, v67
    v_mfma_f32_16x16x32_bf16 v[100:103], a[96:99], v[52:55], v[100:103]
    v_mul_f32 v71, v26, v71
    v_max_f32 v72, 0, v72
    v_mfma_f32_16x16x32_bf16 v[104:107], a[100:103], v[52:55], v[104:107]
    v_mul_f32 v74, v26, v74
    s_waitcnt vmcnt(9)
    v_cmp_ne_u32 vcc, s68, v11
    s_cbranch_vccz L_pd_18
L_pl_17:
    s_cmp_eq_u32 s72, 0
    s_cbranch_scc1 L_pd_18
    s_sub_u32 s72, s72, 1
    v_min_u32 v11, 624, v0
    v_lshlrev_b32 v11, 2, v11
    buffer_load_dword v11, v11, s[8:11], s91 offen sc1
    s_waitcnt vmcnt(0)
    v_cmp_ne_u32 vcc, s68, v11
    s_cbranch_vccnz L_pl_17
L_pd_18:
    s_waitcnt lgkmcnt(0)
    s_barrier
    v_mfma_f32_16x16x32_bf16 v[92:95], a[100:103], v[48:51], v[92:95]
    ds_read_b64_tr_b16 v[40:41], v1 offset:0
    ds_read_b64_tr_b16 v[42:43], v1 offset:1024
    v_mfma_f32_16x16x32_bf16 v[96:99], a[104:107], v[48:51], v[96:99]
    ds_read_b64_tr_b16 v[44:45], v3 offset:0
    ds_read_b64_tr_b16 v[46:47], v3 offset:1024
    v_mfma_f32_16x16x32_bf16 v[108:111], a[104:107], v[52:55], v[108:111]
    v_max_f32 v73, 0, v73
    v_mfma_f32_16x16x32_bf16 v[88:91], a[108:111], v[56:59], v[88:91]
    ds_read_b64_tr_b16 v[48:49], v1 offset:4096
    ds_read_b64_tr_b16 v[50:51], v1 offset:5120
    v_mfma_f32_16x16x32_bf16 v[100:103], a[108:111], v[60:63], v[100:103]
    ds_read_b64_tr_b16 v[52:53], v3 offset:4096
    ds_read_b64_tr_b16 v[54:55], v3 offset:5120
    v_mfma_f32_16x16x32_bf16 v[104:107], a[112:115], v[60:63], v[104:107]
    s_add_u32 s86, s95, 30720
    buffer_load_dwordx4 v[232:235], v0, s[8:11], s86 offen offset:0 sc1
    v_mfma_f32_16x16x32_bf16 v[92:95], a[112:115], v[56:59], v[92:95]
    v_mul_f32 v75, v26, v75
    v_mul_f32 v64, v64, v68
    v_mfma_f32_16x16x32_bf16 v[96:99], a[116:119], v[56:59], v[96:99]
    v_mul_f32 v65, v65, v69
    v_mul_f32 v66, v66, v70
    v_mfma_f32_16x16x32_bf16 v[108:111], a[116:119], v[60:63], v[108:111]
    v_mul_f32 v67, v67, v71
    s_waitcnt lgkmcnt(4)
    v_mfma_f32_16x16x32_bf16 v[88:91], a[120:123], v[40:43], v[88:91]
    ds_read_b64_tr_b16 v[56:57], v1 offset:8192
    ds_read_b64_tr_b16 v[58:59], v1 offset:9216
    v_mfma_f32_16x16x32_bf16 v[100:103], a[120:123], v[44:47], v[100:103]
    ds_read_b64_tr_b16 v[60:61], v3 offset:8192
    ds_read_b64_tr_b16 v[62:63], v3 offset:9216
    v_mfma_f32_16x16x32_bf16 v[104:107], a[124:127], v[44:47], v[104:107]
    s_add_u32 m0, s97, 20480
    s_add_u32 s84, s73, 1310720
    buffer_load_dwordx4 v5, s[8:11], s84 offen offset:0 sc1 lds
    v_mfma_f32_16x16x32_bf16 v[92:95], a[124:127], v[40:43], v[92:95]
    v_mul_f32 v72, v72, v74
    v_mul_f32 v73, v73, v75
    v_mfma_f32_16x16x32_bf16 v[96:99], a[128:131], v[40:43], v[96:99]
    v_cvt_pk_bf16_f32 v28, v64, v65
    v_cvt_pk_bf16_f32 v29, v66, v67
    v_mfma_f32_16x16x32_bf16 v[108:111], a[128:131], v[44:47], v[108:111]
    v_cvt_pk_bf16_f32 v32, v72, v73
    v_permlane32_swap_b32 v84, v86
    v_mfma_f32_16x16x32_bf16 v[16:19], v[12:15], v[40:43], v[16:19]
    buffer_load_dwordx4 v5, s[8:11], s84 offen offset:1024 sc1 lds
    v_permlane32_swap_b32 v85, v87
    v_mfma_f32_16x16x32_bf16 v[20:23], v[40:43], v[40:43], v[20:23]
    v_max_f32 v76, 0, v76
    s_waitcnt lgkmcnt(4)
    v_mfma_f32_16x16x32_bf16 v[88:91], a[132:135], v[48:51], v[88:91]
    ds_read_b64_tr_b16 v[40:41], v1 offset:12288
    ds_read_b64_tr_b16 v[42:43], v1 offset:13312
    v_mfma_f32_16x16x32_bf16 v[100:103], a[132:135], v[52:55], v[100:103]
    ds_read_b64_tr_b16 v[44:45], v3 offset:12288
    ds_read_b64_tr_b16 v[46:47], v3 offset:13312
    v_mfma_f32_16x16x32_bf16 v[104:107], a[136:139], v[52:55], v[104:107]
    v_mul_f32 v80, v27, v80
    v_max_f32 v77, 0, v77
    v_mfma_f32_16x16x32_bf16 v[92:95], a[136:139], v[48:51], v[92:95]
    buffer_load_dwordx4 v5, s[8:11], s84 offen offset:2048 sc1 lds
    v_mul_f32 v81, v27, v81
    v_mfma_f32_16x16x32_bf16 v[96:99], a[140:143], v[48:51], v[96:99]
    v_max_f32 v78, 0, v78
    v_mul_f32 v82, v27, v82
    v_mfma_f32_16x16x32_bf16 v[108:111], a[140:143], v[52:55], v[108:111]
    v_max_f32 v79, 0, v79
    v_mul_f32 v83, v27, v83
    v_mfma_f32_16x16x32_bf16 v[16:19], v[12:15], v[48:51], v[16:19]
    v_max_f32 v84, 0, v84
    v_mul_f32 v86, v27, v86
    v_mfma_f32_16x16x32_bf16 v[20:23], v[48:51], v[48:51], v[20:23]
    buffer_load_dwordx4 v5, s[8:11], s84 offen offset:3072 sc1 lds
    s_waitcnt lgkmcnt(4)
    v_mfma_f32_16x16x32_bf16 v[88:91], a[144:147], v[56:59], v[88:91]
    ds_read_b64_tr_b16 v[48:49], v1 offset:16384
    ds_read_b64_tr_b16 v[50:51], v1 offset:17408
    v_mfma_f32_16x16x32_bf16 v[100:103], a[144:147], v[60:63], v[100:103]
    ds_read_b64_tr_b16 v[52:53], v3 offset:16384
    ds_read_b64_tr_b16 v[54:55], v3 offset:17408
    v_mfma_f32_16x16x32_bf16 v[104:107], a[148:151], v[60:63], v[104:107]
    s_add_u32 m0, s97, 24576
    s_add_u32 s84, s73, 1314816
    v_max_f32 v85, 0, v85
    v_mfma_f32_16x16x32_bf16 v[92:95], a[148:151], v[56:59], v[92:95]
    v_mul_f32 v87, v27, v87
    v_mul_f32 v76, v76, v80
    v_mfma_f32_16x16x32_bf16 v[96:99], a[152:155], v[56:59], v[96:99]
    buffer_load_dwordx4 v5, s[8:11], s84 offen sc1 lds
    s_add_u32 m0, s97, 40960
    s_add_u32 s84, s73, 1331200
    v_mfma_f32_16x16x32_bf16 v[108:111], a[152:155], v[60:63], v[108:111]
    v_mul_f32 v77, v77, v81
    v_mul_f32 v78, v78, v82
    v_mfma_f32_16x16x32_bf16 v[16:19], v[12:15], v[56:59], v[16:19]
    v_mul_f32 v79, v79, v83
    v_mul_f32 v84, v84, v86
    v_mfma_f32_16x16x32_bf16 v[20:23], v[56:59], v[56:59], v[20:23]
    v_mul_f32 v85, v85, v87
    s_waitcnt lgkmcnt(4)
    v_mfma_f32_16x16x32_bf16 v[88:91], a[156:159], v[40:43], v[88:91]
    ds_read_b64_tr_b16 v[56:57], v2 offset:0
    ds_read_b64_tr_b16 v[58:59], v2 offset:1024
    v_mfma_f32_16x16x32_bf16 v[100:103], a[156:159], v[44:47], v[100:103]
    ds_read_b64_tr_b16 v[60:61], v4 offset:0
    ds_read_b64_tr_b16 v[62:63], v4 offset:1024
    v_mfma_f32_16x16x32_bf16 v[104:107], a[160:163], v[44:47], v[104:107]
    buffer_load_dwordx4 v5, s[8:11], s84 offen offset:0 sc1 lds
    v_cvt_pk_bf16_f32 v30, v76, v77
    v_mfma_f32_16x16x32_bf16 v[92:95], a[160:163], v[40:43], v[92:95]
    v_cvt_pk_bf16_f32 v31, v78, v79
    v_cvt_pk_bf16_f32 v33, v84, v85
    v_mfma_f32_16x16x32_bf16 v[96:99], a[164:167], v[40:43], v[96:99]
    v_bfe_u32 v34, v0, 8, 1
    v_mfma_f32_16x16x32_bf16 v[108:111], a[164:167], v[44:47], v[108:111]
    s_mov_b32 s88, -248
    v_mad_i32_i24 v34, v34, s88, v8
    v_mfma_f32_16x16x32_bf16 v[16:19], v[12:15], v[40:43], v[16:19]
    buffer_load_dwordx4 v5, s[8:11], s84 offen offset:1024 sc1 lds
    v_permlane32_swap_b32 v28, v30
    v_mfma_f32_16x16x32_bf16 v[20:23], v[40:43], v[40:43], v[20:23]
    v_permlane32_swap_b32 v29, v31
    s_waitcnt lgkmcnt(4)
    v_mfma_f32_16x16x32_bf16 v[88:91], a[168:171], v[48:51], v[88:91]
    ds_read_b64_tr_b16 v[40:41], v2 offset:4096
    ds_read_b64_tr_b16 v[42:43], v2 offset:5120
    v_mfma_f32_16x16x32_bf16 v[100:103], a[168:171], v[52:55], v[100:103]
    ds_read_b64_tr_b16 v[44:45], v4 offset:4096
    ds_read_b64_tr_b16 v[46:47], v4 offset:5120
    v_mfma_f32_16x16x32_bf16 v[104:107], a[172:175], v[52:55], v[104:107]
    v_permlane32_swap_b32 v32, v33
    v_mfma_f32_16x16x32_bf16 v[92:95], a[172:175], v[48:51], v[92:95]
    buffer_load_dwordx4 v5, s[8:11], s84 offen offset:2048 sc1 lds
    s_add_u32 s88, s74, 0
    s_lshl_b32 s87, s62, 8
    v_mfma_f32_16x16x32_bf16 v[96:99], a[176:179], v[48:51], v[96:99]
    v_mfma_f32_16x16x32_bf16 v[108:111], a[176:179], v[52:55], v[108:111]
    v_mfma_f32_16x16x32_bf16 v[16:19], v[12:15], v[48:51], v[16:19]
    v_mfma_f32_16x16x32_bf16 v[20:23], v[48:51], v[48:51], v[20:23]
    buffer_store_dwordx4 v[28:31], v8, s[8:11], s88 offen sc1
    s_waitcnt lgkmcnt(4)
    v_mfma_f32_16x16x32_bf16 v[88:91], a[180:183], v[56:59], v[88:91]
    ds_read_b64_tr_b16 v[48:49], v2 offset:8192
    ds_read_b64_tr_b16 v[50:51], v2 offset:9216
    v_mfma_f32_16x16x32_bf16 v[100:103], a[180:183], v[60:63], v[100:103]
    ds_read_b64_tr_b16 v[52:53], v4 offset:8192
    ds_read_b64_tr_b16 v[54:55], v4 offset:9216
    v_mfma_f32_16x16x32_bf16 v[104:107], a[184:187], v[60:63], v[104:107]
    s_add_u32 s88, s88, 2048
    s_sub_u32 s88, s88, s87
    v_mfma_f32_16x16x32_bf16 v[92:95], a[184:187], v[56:59], v[92:95]
    v_mfma_f32_16x16x32_bf16 v[96:99], a[188:191], v[56:59], v[96:99]
    v_mfma_f32_16x16x32_bf16 v[108:111], a[188:191], v[60:63], v[108:111]
    s_waitcnt lgkmcnt(4)
    v_mfma_f32_16x16x32_bf16 v[88:91], a[192:195], v[40:43], v[88:91]
    ds_read_b64_tr_b16 v[56:57], v2 offset:12288
    ds_read_b64_tr_b16 v[58:59], v2 offset:13312
    v_mfma_f32_16x16x32_bf16 v[100:103], a[192:195], v[44:47], v[100:103]
    ds_read_b64_tr_b16 v[60:61], v4 offset:12288
    ds_read_b64_tr_b16 v[62:63], v4 offset:13312
    v_mfma_f32_16x16x32_bf16 v[104:107], a[196:199], v[44:47], v[104:107]
    v_cndmask_b32 v39, v20, v21, s[76:77]
    v_cndmask_b32 v39, v39, v22, s[78:79]
    v_mfma_f32_16x16x32_bf16 v[92:95], a[196:199], v[40:43], v[92:95]
    buffer_load_dwordx4 v5, s[8:11], s84 offen offset:3072 sc1 lds
    s_add_u32 m0, s97, 45056
    s_add_u32 s84, s73, 1335296
    v_mfma_f32_16x16x32_bf16 v[96:99], a[200:203], v[40:43], v[96:99]
    v_cndmask_b32 v39, v39, v23, s[80:81]
    v_mov_b32 v38, v16
    v_mfma_f32_16x16x32_bf16 v[108:111], a[200:203], v[44:47], v[108:111]
    ds_write_b64 v6, v[38:39] offset:512
    s_waitcnt lgkmcnt(5)
    v_mfma_f32_16x16x32_bf16 v[88:91], a[204:207], v[48:51], v[88:91]
    ds_read_b64_tr_b16 v[40:41], v2 offset:16384
    ds_read_b64_tr_b16 v[42:43], v2 offset:17408
    v_mfma_f32_16x16x32_bf16 v[100:103], a[204:207], v[52:55], v[100:103]
    ds_read_b64_tr_b16 v[44:45], v4 offset:16384
    ds_read_b64_tr_b16 v[46:47], v4 offset:17408
    v_mfma_f32_16x16x32_bf16 v[104:107], a[208:211], v[52:55], v[104:107]
    buffer_store_dwordx2 v[32:33], v34, s[8:11], s88 offen sc1
    v_mfma_f32_16x16x32_bf16 v[92:95], a[208:211], v[48:51], v[92:95]
    v_mfma_f32_16x16x32_bf16 v[96:99], a[212:215], v[48:51], v[96:99]
    v_mfma_f32_16x16x32_bf16 v[108:111], a[212:215], v[52:55], v[108:111]
    s_waitcnt lgkmcnt(5)
    v_mfma_f32_16x16x32_bf16 v[88:91], a[216:219], v[56:59], v[88:91]
    v_mfma_f32_16x16x32_bf16 v[100:103], a[216:219], v[60:63], v[100:103]
    buffer_load_dwordx4 v5, s[8:11], s84 offen sc1 lds
    v_mfma_f32_16x16x32_bf16 v[104:107], a[220:223], v[60:63], v[104:107]
    s_waitcnt vmcnt(7) lgkmcnt(0)
    s_barrier
    v_mfma_f32_16x16x32_bf16 v[92:95], a[220:223], v[56:59], v[92:95]
    ds_read_b64_tr_b16 v[48:49], v1 offset:20480
    ds_read_b64_tr_b16 v[50:51], v1 offset:21504
    v_mfma_f32_16x16x32_bf16 v[96:99], a[224:227], v[56:59], v[96:99]
    ds_read_b64_tr_b16 v[52:53], v3 offset:20480
    ds_read_b64_tr_b16 v[54:55], v3 offset:21504
    v_mfma_f32_16x16x32_bf16 v[108:111], a[224:227], v[60:63], v[108:111]
    buffer_load_dwordx4 v[236:239], v0, s[8:11], s86 offen offset:1024 sc1
    v_mfma_f32_16x16x32_bf16 v[88:91], a[228:231], v[40:43], v[88:91]
    ds_read_b64_tr_b16 v[56:57], v1 offset:24576
    ds_read_b64_tr_b16 v[58:59], v1 offset:25600
    v_mfma_f32_16x16x32_bf16 v[100:103], a[228:231], v[44:47], v[100:103]
    ds_read_b64_tr_b16 v[60:61], v3 offset:24576
    ds_read_b64_tr_b16 v[62:63], v3 offset:25600
    v_mfma_f32_16x16x32_bf16 v[104:107], a[232:235], v[44:47], v[104:107]
    v_mfma_f32_16x16x32_bf16 v[92:95], a[232:235], v[40:43], v[92:95]
    v_mfma_f32_16x16x32_bf16 v[96:99], a[236:239], v[40:43], v[96:99]
    buffer_load_dwordx4 v[240:243], v0, s[8:11], s86 offen offset:2048 sc1
    v_mfma_f32_16x16x32_bf16 v[108:111], a[236:239], v[44:47], v[108:111]
    s_waitcnt lgkmcnt(4)
    v_mfma_f32_16x16x32_bf16 v[64:67], a[0:3], v[48:51], 0
    ds_read_b64_tr_b16 v[40:41], v1 offset:28672
    ds_read_b64_tr_b16 v[42:43], v1 offset:29696
    v_mfma_f32_16x16x32_bf16 v[76:79], a[0:3], v[52:55], 0
    ds_read_b64_tr_b16 v[44:45], v3 offset:28672
    ds_read_b64_tr_b16 v[46:47], v3 offset:29696
    v_mfma_f32_16x16x32_bf16 v[80:83], a[4:7], v[52:55], 0
    s_add_u32 m0, s97, 0
    s_add_u32 s84, s73, 1351680
    buffer_load_dwordx4 v5, s[8:11], s84 offen offset:0 sc1 lds
    v_mfma_f32_16x16x32_bf16 v[68:71], a[4:7], v[48:51], 0
    ds_read_b128 v[28:31], v7 offset:512
    v_xor_b32 v36, 256, v7
    v_mfma_f32_16x16x32_bf16 v[72:75], a[8:11], v[48:51], 0
    ds_read_b128 v[32:35], v36 offset:512
    v_mfma_f32_16x16x32_bf16 v[84:87], a[8:11], v[52:55], 0
    v_mfma_f32_16x16x32_bf16 v[16:19], v[12:15], v[48:51], 0
    v_mfma_f32_16x16x32_bf16 v[20:23], v[48:51], v[48:51], 0
    buffer_load_dwordx4 v5, s[8:11], s84 offen offset:1024 sc1 lds
    s_waitcnt lgkmcnt(6)
    v_mfma_f32_16x16x32_bf16 v[64:67], a[12:15], v[56:59], v[64:67]
    ds_read_b64_tr_b16 v[48:49], v1 offset:32768
    ds_read_b64_tr_b16 v[50:51], v1 offset:33792
    v_mfma_f32_16x16x32_bf16 v[76:79], a[12:15], v[60:63], v[76:79]
    ds_read_b64_tr_b16 v[52:53], v3 offset:32768
    ds_read_b64_tr_b16 v[54:55], v3 offset:33792
    v_mfma_f32_16x16x32_bf16 v[80:83], a[16:19], v[60:63], v[80:83]
    s_waitcnt lgkmcnt(5)
    v_add_f32 v28, v28, v30
    v_add_f32 v29, v29, v31
    v_mfma_f32_16x16x32_bf16 v[68:71], a[16:19], v[56:59], v[68:71]
    buffer_load_dwordx4 v5, s[8:11], s84 offen offset:2048 sc1 lds
    s_waitcnt lgkmcnt(4)
    v_add_f32 v32, v32, v34
    v_mfma_f32_16x16x32_bf16 v[72:75], a[20:23], v[56:59], v[72:75]
    v_add_f32 v33, v33, v35
    v_mul_f32 v24, 0xbacccccd, v28
    v_mfma_f32_16x16x32_bf16 v[84:87], a[20:23], v[60:63], v[84:87]
    v_mov_b32 v26, 0x3727c5ac
    v_fmac_f32 v26, 0x3acccccd, v29
    v_mfma_f32_16x16x32_bf16 v[16:19], v[12:15], v[56:59], v[16:19]
    v_mul_f32 v25, 0xbacccccd, v32
    v_mov_b32 v27, 0x3727c5ac
    v_mfma_f32_16x16x32_bf16 v[20:23], v[56:59], v[56:59], v[20:23]
    v_fmac_f32 v27, 0x3acccccd, v33
    v_mfma_f32_16x16x32_bf16 v[64:67], a[24:27], v[40:43], v[64:67]
    ds_read_b64_tr_b16 v[56:57], v1 offset:36864
    ds_read_b64_tr_b16 v[58:59], v1 offset:37888
    v_mfma_f32_16x16x32_bf16 v[76:79], a[24:27], v[44:47], v[76:79]
    ds_read_b64_tr_b16 v[60:61], v3 offset:36864
    ds_read_b64_tr_b16 v[62:63], v3 offset:37888
    v_mfma_f32_16x16x32_bf16 v[80:83], a[28:31], v[44:47], v[80:83]
    buffer_load_dwordx4 v5, s[8:11], s84 offen offset:3072 sc1 lds
    s_add_u32 m0, s97, 4096
    s_add_u32 s84, s73, 1355776
    v_mfma_f32_16x16x32_bf16 v[68:71], a[28:31], v[40:43], v[68:71]
    s_mul_i32 s91, s62, 2560
    s_add_u32 s91, s91, 28622848
    v_min_u32 v11, 624, v0
    v_mfma_f32_16x16x32_bf16 v[72:75], a[32:35], v[40:43], v[72:75]
    v_lshlrev_b32 v11, 2, v11
    buffer_load_dword v11, v11, s[8:11], s91 offen sc1
    v_mfma_f32_16x16x32_bf16 v[84:87], a[32:35], v[44:47], v[84:87]
    ds_read_b128 v[28:31], v10 offset:0
    ds_read_b128 v[32:35], v10 offset:64
    v_mfma_f32_16x16x32_bf16 v[16:19], v[12:15], v[40:43], v[16:19]
    ds_read_b128 v[36:39], v10 offset:128
    v_fma_f32 v26, -v24, v24, v26
    v_mfma_f32_16x16x32_bf16 v[20:23], v[40:43], v[40:43], v[20:23]
    buffer_load_dwordx4 v5, s[8:11], s84 offen sc1 lds
    s_waitcnt lgkmcnt(7)
    v_mfma_f32_16x16x32_bf16 v[64:67], a[36:39], v[48:51], v[64:67]
    ds_read_b64_tr_b16 v[40:41], v2 offset:20480
    ds_read_b64_tr_b16 v[42:43], v2 offset:21504
    v_mfma_f32_16x16x32_bf16 v[76:79], a[36:39], v[52:55], v[76:79]
    ds_read_b64_tr_b16 v[44:45], v4 offset:20480
    ds_read_b64_tr_b16 v[46:47], v4 offset:21504
    v_mfma_f32_16x16x32_bf16 v[80:83], a[40:43], v[52:55], v[80:83]
    v_max_f32 v26, 0x3727c5ac, v26
    v_fma_f32 v27, -v25, v25, v27
    v_mfma_f32_16x16x32_bf16 v[68:71], a[40:43], v[48:51], v[68:71]
    buffer_load_dwordx4 v[244:247], v0, s[8:11], s86 offen offset:3072 sc1
    s_add_u32 s86, s86, 4096
    v_mfma_f32_16x16x32_bf16 v[72:75], a[44:47], v[48:51], v[72:75]
    v_max_f32 v27, 0x3727c5ac, v27
    v_rcp_f32 v26, v26
    v_mfma_f32_16x16x32_bf16 v[84:87], a[44:47], v[52:55], v[84:87]
    v_rcp_f32 v27, v27
    v_mfma_f32_16x16x32_bf16 v[16:19], v[12:15], v[48:51], v[16:19]
    v_mfma_f32_16x16x32_bf16 v[20:23], v[48:51], v[48:51], v[20:23]
    s_waitcnt lgkmcnt(6)
    v_fmac_f32 v88, v24, v28
    v_mfma_f32_16x16x32_bf16 v[64:67], a[48:51], v[56:59], v[64:67]
    ds_read_b64_tr_b16 v[48:49], v2 offset:24576
    ds_read_b64_tr_b16 v[50:51], v2 offset:25600
    v_mfma_f32_16x16x32_bf16 v[76:79], a[48:51], v[60:63], v[76:79]
    ds_read_b64_tr_b16 v[52:53], v4 offset:24576
    ds_read_b64_tr_b16 v[54:55], v4 offset:25600
    v_mfma_f32_16x16x32_bf16 v[80:83], a[52:55], v[60:63], v[80:83]
    buffer_load_dwordx4 v[248:251], v0, s[8:11], s86 offen offset:0 sc1
    s_add_u32 s86, s95, 35840
    v_mfma_f32_16x16x32_bf16 v[68:71], a[52:55], v[56:59], v[68:71]
    v_fmac_f32 v89, v24, v29
    v_fmac_f32 v90, v24, v30
    v_mfma_f32_16x16x32_bf16 v[72:75], a[56:59], v[56:59], v[72:75]
    v_fmac_f32 v91, v24, v31
    s_waitcnt lgkmcnt(9)
    v_fmac_f32 v92, v24, v32
    v_mfma_f32_16x16x32_bf16 v[84:87], a[56:59], v[60:63], v[84:87]
    v_fmac_f32 v93, v24, v33
    v_fmac_f32 v94, v24, v34
    v_mfma_f32_16x16x32_bf16 v[16:19], v[12:15], v[56:59], v[16:19]
    buffer_load_dwordx4 a[240:243], v0, s[8:11], s86 offen offset:0 sc1
    v_fmac_f32 v95, v24, v35
    v_mfma_f32_16x16x32_bf16 v[20:23], v[56:59], v[56:59], v[20:23]
    s_waitcnt lgkmcnt(8)
    v_fmac_f32 v96, v24, v36
    s_waitcnt lgkmcnt(4)
    v_mfma_f32_16x16x32_bf16 v[64:67], a[60:63], v[40:43], v[64:67]
    ds_read_b64_tr_b16 v[56:57], v2 offset:28672
    ds_read_b64_tr_b16 v[58:59], v2 offset:29696
    v_mfma_f32_16x16x32_bf16 v[76:79], a[60:63], v[44:47], v[76:79]
    ds_read_b64_tr_b16 v[60:61], v4 offset:28672
    ds_read_b64_tr_b16 v[62:63], v4 offset:29696
    v_mfma_f32_16x16x32_bf16 v[80:83], a[64:67], v[44:47], v[80:83]
    v_fmac_f32 v97, v24, v37
    v_fmac_f32 v98, v24, v38
    v_mfma_f32_16x16x32_bf16 v[68:71], a[64:67], v[40:43], v[68:71]
    buffer_load_dwordx4 a[244:247], v0, s[8:11], s86 offen offset:1024 sc1
    v_fmac_f32 v99, v24, v39
    v_mfma_f32_16x16x32_bf16 v[72:75], a[68:71], v[40:43], v[72:75]
    v_fmac_f32 v100, v25, v28
    v_fmac_f32 v101, v25, v29
    v_mfma_f32_16x16x32_bf16 v[84:87], a[68:71], v[44:47], v[84:87]
    v_fmac_f32 v102, v25, v30
    s_waitcnt lgkmcnt(4)
    v_mfma_f32_16x16x32_bf16 v[64:67], a[72:75], v[48:51], v[64:67]
    ds_read_b64_tr_b16 v[40:41], v2 offset:32768
    ds_read_b64_tr_b16 v[42:43], v2 offset:33792
    v_mfma_f32_16x16x32_bf16 v[76:79], a[72:75], v[52:55], v[76:79]
    ds_read_b64_tr_b16 v[44:45], v4 offset:32768
    ds_read_b64_tr_b16 v[46:47], v4 offset:33792
    v_mfma_f32_16x16x32_bf16 v[80:83], a[76:79], v[52:55], v[80:83]
    buffer_load_dwordx4 a[248:251], v0, s[8:11], s86 offen offset:2048 sc1
    v_fmac_f32 v103, v25, v31
    v_mfma_f32_16x16x32_bf16 v[68:71], a[76:79], v[48:51], v[68:71]
    v_fmac_f32 v104, v25, v32
    v_fmac_f32 v105, v25, v33
    v_mfma_f32_16x16x32_bf16 v[72:75], a[80:83], v[48:51], v[72:75]
    v_fmac_f32 v106, v25, v34
    v_fmac_f32 v107, v25, v35
    v_mfma_f32_16x16x32_bf16 v[84:87], a[80:83], v[52:55], v[84:87]
    v_fmac_f32 v108, v25, v36
    s_waitcnt lgkmcnt(4)
    v_mfma_f32_16x16x32_bf16 v[64:67], a[84:87], v[56:59], v[64:67]
    ds_read_b64_tr_b16 v[48:49], v2 offset:36864
    ds_read_b64_tr_b16 v[50:51], v2 offset:37888
    v_mfma_f32_16x16x32_bf16 v[76:79], a[84:87], v[60:63], v[76:79]
    ds_read_b64_tr_b16 v[52:53], v4 offset:36864
    ds_read_b64_tr_b16 v[54:55], v4 offset:37888
    v_mfma_f32_16x16x32_bf16 v[80:83], a[88:91], v[60:63], v[80:83]
    buffer_load_dwordx4 a[252:255], v0, s[8:11], s86 offen offset:3072 sc1
    s_add_u32 s86, s86, 4096
    v_mfma_f32_16x16x32_bf16 v[68:71], a[88:91], v[56:59], v[68:71]
    v_fmac_f32 v109, v25, v37
    v_fmac_f32 v110, v25, v38
    v_mfma_f32_16x16x32_bf16 v[72:75], a[92:95], v[56:59], v[72:75]
    v_fmac_f32 v111, v25, v39
    s_lshl_b32 s85, s1, 2
    s_add_u32 s85, s85, s62
    v_mfma_f32_16x16x32_bf16 v[84:87], a[92:95], v[60:63], v[84:87]
    s_lshl_b32 s85, s85, 6
    s_add_u32 s85, s85, s75
    s_waitcnt lgkmcnt(4)
    v_mfma_f32_16x16x32_bf16 v[64:67], a[96:99], v[40:43], v[64:67]
    buffer_load_dwordx4 v[252:255], v0, s[8:11], s86 offen offset:0 sc1
    s_add_u32 m0, s96, 0
    s_add_u32 s86, s95, 40960
    v_mfma_f32_16x16x32_bf16 v[76:79], a[96:99], v[44:47], v[76:79]
    v_mov_b32 v37, s68
    s_add_u32 s85, s85, 0
    v_mfma_f32_16x16x32_bf16 v[80:83], a[100:103], v[44:47], v[80:83]
    s_waitcnt vmcnt(16)
    s_waitcnt vmcnt(15) lgkmcnt(0)
    s_barrier
    v_mfma_f32_16x16x32_bf16 v[68:71], a[100:103], v[40:43], v[68:71]
    ds_read_b64_tr_b16 v[56:57], v1 offset:40960
    ds_read_b64_tr_b16 v[58:59], v1 offset:41984
    v_mfma_f32_16x16x32_bf16 v[72:75], a[104:107], v[40:43], v[72:75]
    ds_read_b64_tr_b16 v[60:61], v3 offset:40960
    ds_read_b64_tr_b16 v[62:63], v3 offset:41984
    v_mfma_f32_16x16x32_bf16 v[84:87], a[104:107], v[44:47], v[84:87]
    v_mfma_f32_16x16x32_bf16 v[64:67], a[108:111], v[48:51], v[64:67]
    ds_read_b64_tr_b16 v[40:41], v1 offset:45056
    ds_read_b64_tr_b16 v[42:43], v1 offset:46080
    v_mfma_f32_16x16x32_bf16 v[76:79], a[108:111], v[52:55], v[76:79]
    ds_read_b64_tr_b16 v[44:45], v3 offset:45056
    ds_read_b64_tr_b16 v[46:47], v3 offset:46080
    v_mfma_f32_16x16x32_bf16 v[80:83], a[112:115], v[52:55], v[80:83]
    s_mov_b64 exec, 15
    buffer_store_dword v37, v0, s[8:11], s85 offen sc1
    s_mov_b64 exec, -1
    v_mfma_f32_16x16x32_bf16 v[68:71], a[112:115], v[48:51], v[68:71]
    buffer_load_dwordx4 v0, s[8:11], s86 offen offset:0 sc1 lds
    v_permlane32_swap_b32 v96, v98
    v_mfma_f32_16x16x32_bf16 v[72:75], a[116:119], v[48:51], v[72:75]
    v_permlane32_swap_b32 v97, v99
    v_mfma_f32_16x16x32_bf16 v[84:87], a[116:119], v[52:55], v[84:87]
    v_max_f32 v88, 0, v88
    s_waitcnt lgkmcnt(4)
    v_mfma_f32_16x16x32_bf16 v[64:67], a[120:123], v[56:59], v[64:67]
    ds_read_b64_tr_b16 v[48:49], v1 offset:49152
    ds_read_b64_tr_b16 v[50:51], v1 offset:50176
    v_mfma_f32_16x16x32_bf16 v[76:79], a[120:123], v[60:63], v[76:79]
    ds_read_b64_tr_b16 v[52:53], v3 offset:49152
    ds_read_b64_tr_b16 v[54:55], v3 offset:50176
    v_mfma_f32_16x16x32_bf16 v[80:83], a[124:127], v[60:63], v[80:83]
    buffer_load_dwordx4 v0, s[8:11], s86 offen offset:1024 sc1 lds
    v_mul_f32 v92, v26, v92
    v_mfma_f32_16x16x32_bf16 v[68:71], a[124:127], v[56:59], v[68:71]
    v_max_f32 v89, 0, v89
    v_mul_f32 v93, v26, v93
    v_mfma_f32_16x16x32_bf16 v[72:75], a[128:131], v[56:59], v[72:75]
    v_max_f32 v90, 0, v90
    v_mul_f32 v94, v26, v94
    v_mfma_f32_16x16x32_bf16 v[84:87], a[128:131], v[60:63], v[84:87]
    v_max_f32 v91, 0, v91
    v_mul_f32 v95, v26, v95
    v_mfma_f32_16x16x32_bf16 v[16:19], v[12:15], v[56:59], v[16:19]
    buffer_load_dwordx4 v0, s[8:11], s86 offen offset:2048 sc1 lds
    v_max_f32 v96, 0, v96
    v_mfma_f32_16x16x32_bf16 v[20:23], v[56:59], v[56:59], v[20:23]
    v_mul_f32 v98, v26, v98
    s_waitcnt lgkmcnt(4)
    v_mfma_f32_16x16x32_bf16 v[64:67], a[132:135], v[40:43], v[64:67]
    ds_read_b64_tr_b16 v[56:57], v1 offset:53248
    ds_read_b64_tr_b16 v[58:59], v1 offset:54272
    v_mfma_f32_16x16x32_bf16 v[76:79], a[132:135], v[44:47], v[76:79]
    ds_read_b64_tr_b16 v[60:61], v3 offset:53248
    ds_read_b64_tr_b16 v[62:63], v3 offset:54272
    v_mfma_f32_16x16x32_bf16 v[80:83], a[136:139], v[44:47], v[80:83]
    v_max_f32 v97, 0, v97
    v_mul_f32 v99, v26, v99
    v_mfma_f32_16x16x32_bf16 v[68:71], a[136:139], v[40:43], v[68:71]
    buffer_load_dwordx4 v0, s[8:11], s86 offen offset:3072 sc1 lds
    s_add_u32 m0, s97, 20480
    s_add_u32 s84, s73, 1372160
    v_mfma_f32_16x16x32_bf16 v[72:75], a[140:143], v[40:43], v[72:75]
    v_mul_f32 v88, v88, v92
    v_mul_f32 v89, v89, v93
    v_mfma_f32_16x16x32_bf16 v[84:87], a[140:143], v[44:47], v[84:87]
    v_mul_f32 v90, v90, v94
    v_mul_f32 v91, v91, v95
    v_mfma_f32_16x16x32_bf16 v[16:19], v[12:15], v[40:43], v[16:19]
    v_mul_f32 v96, v96, v98
    v_mul_f32 v97, v97, v99
    v_mfma_f32_16x16x32_bf16 v[20:23], v[40:43], v[40:43], v[20:23]
    buffer_load_dwordx4 v5, s[8:11], s84 offen offset:0 sc1 lds
    s_waitcnt lgkmcnt(4)
    v_mfma_f32_16x16x32_bf16 v[64:67], a[144:147], v[48:51], v[64:67]
    ds_read_b64_tr_b16 v[40:41], v1 offset:57344
    ds_read_b64_tr_b16 v[42:43], v1 offset:58368
    v_mfma_f32_16x16x32_bf16 v[76:79], a[144:147], v[52:55], v[76:79]
    ds_read_b64_tr_b16 v[44:45], v3 offset:57344
    ds_read_b64_tr_b16 v[46:47], v3 offset:58368
    v_mfma_f32_16x16x32_bf16 v[80:83], a[148:151], v[52:55], v[80:83]
    v_cvt_pk_bf16_f32 v28, v88, v89
    v_cvt_pk_bf16_f32 v29, v90, v91
    v_mfma_f32_16x16x32_bf16 v[68:71], a[148:151], v[48:51], v[68:71]
    v_cvt_pk_bf16_f32 v32, v96, v97
    v_permlane32_swap_b32 v108, v110
    v_mfma_f32_16x16x32_bf16 v[72:75], a[152:155], v[48:51], v[72:75]
    buffer_load_dwordx4 v5, s[8:11], s84 offen offset:1024 sc1 lds
    v_permlane32_swap_b32 v109, v111
    v_mfma_f32_16x16x32_bf16 v[84:87], a[152:155], v[52:55], v[84:87]
    v_max_f32 v100, 0, v100
    v_mul_f32 v104, v27, v104
    v_mfma_f32_16x16x32_bf16 v[16:19], v[12:15], v[48:51], v[16:19]
    v_max_f32 v101, 0, v101
    v_mul_f32 v105, v27, v105
    v_mfma_f32_16x16x32_bf16 v[20:23], v[48:51], v[48:51], v[20:23]
    v_max_f32 v102, 0, v102
    s_waitcnt lgkmcnt(4)
    v_mfma_f32_16x16x32_bf16 v[64:67], a[156:159], v[56:59], v[64:67]
    ds_read_b64_tr_b16 v[48:49], v2 offset:40960
    ds_read_b64_tr_b16 v[50:51], v2 offset:41984
    v_mfma_f32_16x16x32_bf16 v[76:79], a[156:159], v[60:63], v[76:79]
    ds_read_b64_tr_b16 v[52:53], v4 offset:40960
    ds_read_b64_tr_b16 v[54:55], v4 offset:41984
    v_mfma_f32_16x16x32_bf16 v[80:83], a[160:163], v[60:63], v[80:83]
    buffer_load_dwordx4 v5, s[8:11], s84 offen offset:2048 sc1 lds
    v_mul_f32 v106, v27, v106
    v_mfma_f32_16x16x32_bf16 v[68:71], a[160:163], v[56:59], v[68:71]
    v_max_f32 v103, 0, v103
    v_mul_f32 v107, v27, v107
    v_mfma_f32_16x16x32_bf16 v[72:75], a[164:167], v[56:59], v[72:75]
    v_max_f32 v108, 0, v108
    v_mul_f32 v110, v27, v110
    v_mfma_f32_16x16x32_bf16 v[84:87], a[164:167], v[60:63], v[84:87]
    v_max_f32 v109, 0, v109
    v_mul_f32 v111, v27, v111
    v_mfma_f32_16x16x32_bf16 v[16:19], v[12:15], v[56:59], v[16:19]
    buffer_load_dwordx4 v5, s[8:11], s84 offen offset:3072 sc1 lds
    s_add_u32 m0, s97, 24576
    s_add_u32 s84, s73, 1376256
    v_mfma_f32_16x16x32_bf16 v[20:23], v[56:59], v[56:59], v[20:23]
    v_mul_f32 v100, v100, v104
    s_waitcnt lgkmcnt(4)
    v_mfma_f32_16x16x32_bf16 v[64:67], a[168:171], v[40:43], v[64:67]
    ds_read_b64_tr_b16 v[56:57], v2 offset:45056
    ds_read_b64_tr_b16 v[58:59], v2 offset:46080
    v_mfma_f32_16x16x32_bf16 v[76:79], a[168:171], v[44:47], v[76:79]
    ds_read_b64_tr_b16 v[60:61], v4 offset:45056
    ds_read_b64_tr_b16 v[62:63], v4 offset:46080
    v_mfma_f32_16x16x32_bf16 v[80:83], a[172:175], v[44:47], v[80:83]
    v_mul_f32 v101, v101, v105
    v_mul_f32 v102, v102, v106
    v_mfma_f32_16x16x32_bf16 v[68:71], a[172:175], v[40:43], v[68:71]
    buffer_load_dwordx4 v5, s[8:11], s84 offen sc1 lds
    s_add_u32 m0, s96, 4096
    s_add_u32 s86, s95, 45056
    v_mfma_f32_16x16x32_bf16 v[72:75], a[176:179], v[40:43], v[72:75]
    v_mul_f32 v103, v103, v107
    v_mul_f32 v108, v108, v110
    v_mfma_f32_16x16x32_bf16 v[84:87], a[176:179], v[44:47], v[84:87]
    v_mul_f32 v109, v109, v111
    v_cvt_pk_bf16_f32 v30, v100, v101
    v_mfma_f32_16x16x32_bf16 v[16:19], v[12:15], v[40:43], v[16:19]
    v_cvt_pk_bf16_f32 v31, v102, v103
    v_cvt_pk_bf16_f32 v33, v108, v109
    v_mfma_f32_16x16x32_bf16 v[20:23], v[40:43], v[40:43], v[20:23]
    buffer_load_dwordx4 v0, s[8:11], s86 offen sc1 lds
    s_waitcnt lgkmcnt(4)
    v_mfma_f32_16x16x32_bf16 v[64:67], a[180:183], v[48:51], v[64:67]
    ds_read_b64_tr_b16 v[40:41], v2 offset:49152
    ds_read_b64_tr_b16 v[42:43], v2 offset:50176
    v_mfma_f32_16x16x32_bf16 v[76:79], a[180:183], v[52:55], v[76:79]
    ds_read_b64_tr_b16 v[44:45], v4 offset:49152
    ds_read_b64_tr_b16 v[46:47], v4 offset:50176
    v_mfma_f32_16x16x32_bf16 v[80:83], a[184:187], v[52:55], v[80:83]
    s_add_u32 m0, s96, 5120
    s_add_u32 s86, s95, 46080
    v_bfe_u32 v34, v0, 8, 1
    v_mfma_f32_16x16x32_bf16 v[68:71], a[184:187], v[48:51], v[68:71]
    s_mov_b32 s88, -248
    v_mad_i32_i24 v34, v34, s88, v8
    v_mfma_f32_16x16x32_bf16 v[72:75], a[188:191], v[48:51], v[72:75]
    buffer_load_dwordx4 v0, s[8:11], s86 offen offset:0 sc1 lds
    v_permlane32_swap_b32 v28, v30
    v_mfma_f32_16x16x32_bf16 v[84:87], a[188:191], v[52:55], v[84:87]
    v_permlane32_swap_b32 v29, v31
    s_waitcnt lgkmcnt(4)
    s_waitcnt vmcnt(20)
    v_cmp_ne_u32 vcc, s68, v11
    s_cbranch_vccz L_pd_20
L_pl_19:
    s_cmp_eq_u32 s72, 0
    s_cbranch_scc1 L_pd_20
    s_sub_u32 s72, s72, 1
    v_min_u32 v11, 624, v0
    v_lshlrev_b32 v11, 2, v11
    buffer_load_dword v11, v11, s[8:11], s91 offen sc1
    s_waitcnt vmcnt(0)
    v_cmp_ne_u32 vcc, s68, v11
    s_cbranch_vccnz L_pl_19
L_pd_20:
    v_mfma_f32_16x16x32_bf16 v[64:67], a[192:195], v[56:59], v[64:67]
    ds_read_b64_tr_b16 v[48:49], v2 offset:53248
    ds_read_b64_tr_b16 v[50:51], v2 offset:54272
    v_mfma_f32_16x16x32_bf16 v[76:79], a[192:195], v[60:63], v[76:79]
    ds_read_b64_tr_b16 v[52:53], v4 offset:53248
    ds_read_b64_tr_b16 v[54:55], v4 offset:54272
    v_mfma_f32_16x16x32_bf16 v[80:83], a[196:199], v[60:63], v[80:83]
    buffer_load_dwordx4 v0, s[8:11], s86 offen offset:1024 sc1 lds
    v_cndmask_b32 v39, v20, v21, s[76:77]
    v_mfma_f32_16x16x32_bf16 v[68:71], a[196:199], v[56:59], v[68:71]
    v_cndmask_b32 v39, v39, v22, s[78:79]
    v_cndmask_b32 v39, v39, v23, s[80:81]
    v_mfma_f32_16x16x32_bf16 v[72:75], a[200:203], v[56:59], v[72:75]
    v_mov_b32 v38, v16
    ds_write_b64 v6, v[38:39] offset:0
    v_mfma_f32_16x16x32_bf16 v[84:87], a[200:203], v[60:63], v[84:87]
    v_permlane32_swap_b32 v32, v33
    s_waitcnt lgkmcnt(5)
    v_mfma_f32_16x16x32_bf16 v[64:67], a[204:207], v[40:43], v[64:67]
    ds_read_b64_tr_b16 v[56:57], v2 offset:57344
    ds_read_b64_tr_b16 v[58:59], v2 offset:58368
    v_mfma_f32_16x16x32_bf16 v[76:79], a[204:207], v[44:47], v[76:79]
    ds_read_b64_tr_b16 v[60:61], v4 offset:57344
    ds_read_b64_tr_b16 v[62:63], v4 offset:58368
    v_mfma_f32_16x16x32_bf16 v[80:83], a[208:211], v[44:47], v[80:83]
    buffer_load_dwordx4 v0, s[8:11], s86 offen offset:2048 sc1 lds
    s_add_u32 s88, s74, 49152
    s_lshl_b32 s87, s62, 8
    v_mfma_f32_16x16x32_bf16 v[68:71], a[208:211], v[40:43], v[68:71]
    v_mfma_f32_16x16x32_bf16 v[72:75], a[212:215], v[40:43], v[72:75]
    v_mfma_f32_16x16x32_bf16 v[84:87], a[212:215], v[44:47], v[84:87]
    s_waitcnt lgkmcnt(5)
    v_mfma_f32_16x16x32_bf16 v[64:67], a[216:219], v[48:51], v[64:67]
    buffer_store_dwordx4 v[28:31], v8, s[8:11], s88 offen sc1
    s_add_u32 s88, s88, 2048
    s_sub_u32 s88, s88, s87
    v_mfma_f32_16x16x32_bf16 v[76:79], a[216:219], v[52:55], v[76:79]
    v_mfma_f32_16x16x32_bf16 v[80:83], a[220:223], v[52:55], v[80:83]
    s_waitcnt vmcnt(22) lgkmcnt(0)
    s_barrier
    v_mfma_f32_16x16x32_bf16 v[68:71], a[220:223], v[48:51], v[68:71]
    ds_read_b64_tr_b16 v[40:41], v1 offset:0
    ds_read_b64_tr_b16 v[42:43], v1 offset:1024
    v_mfma_f32_16x16x32_bf16 v[72:75], a[224:227], v[48:51], v[72:75]
    ds_read_b64_tr_b16 v[44:45], v3 offset:0
    ds_read_b64_tr_b16 v[46:47], v3 offset:1024
    v_mfma_f32_16x16x32_bf16 v[84:87], a[224:227], v[52:55], v[84:87]
    v_mfma_f32_16x16x32_bf16 v[64:67], a[228:231], v[56:59], v[64:67]
    ds_read_b64_tr_b16 v[48:49], v1 offset:4096
    ds_read_b64_tr_b16 v[50:51], v1 offset:5120
    v_mfma_f32_16x16x32_bf16 v[76:79], a[228:231], v[60:63], v[76:79]
    ds_read_b64_tr_b16 v[52:53], v3 offset:4096
    ds_read_b64_tr_b16 v[54:55], v3 offset:5120
    v_mfma_f32_16x16x32_bf16 v[80:83], a[232:235], v[60:63], v[80:83]
    v_mfma_f32_16x16x32_bf16 v[68:71], a[232:235], v[56:59], v[68:71]
    v_mfma_f32_16x16x32_bf16 v[72:75], a[236:239], v[56:59], v[72:75]
    buffer_store_dwordx2 v[32:33], v34, s[8:11], s88 offen sc1
    v_mfma_f32_16x16x32_bf16 v[84:87], a[236:239], v[60:63], v[84:87]
    s_waitcnt lgkmcnt(4)
    v_mfma_f32_16x16x32_bf16 v[88:91], a[0:3], v[40:43], 0
    ds_read_b64_tr_b16 v[56:57], v1 offset:8192
    ds_read_b64_tr_b16 v[58:59], v1 offset:9216
    v_mfma_f32_16x16x32_bf16 v[100:103], a[0:3], v[44:47], 0
    ds_read_b64_tr_b16 v[60:61], v3 offset:8192
    ds_read_b64_tr_b16 v[62:63], v3 offset:9216
    v_mfma_f32_16x16x32_bf16 v[104:107], a[4:7], v[44:47], 0
    ds_read_b128 v[28:31], v7 offset:0
    v_xor_b32 v36, 256, v7
    v_mfma_f32_16x16x32_bf16 v[92:95], a[4:7], v[40:43], 0
    buffer_load_dwordx4 v0, s[8:11], s86 offen offset:3072 sc1 lds
    s_add_u32 m0, s96, 9216
    s_add_u32 s86, s95, 50176
    v_mfma_f32_16x16x32_bf16 v[96:99], a[8:11], v[40:43], 0
    ds_read_b128 v[32:35], v36 offset:0
    v_mfma_f32_16x16x32_bf16 v[108:111], a[8:11], v[44:47], 0
    v_mfma_f32_16x16x32_bf16 v[16:19], v[12:15], v[40:43], 0
    v_mfma_f32_16x16x32_bf16 v[20:23], v[40:43], v[40:43], 0
    buffer_load_dwordx4 v0, s[8:11], s86 offen sc1 lds
    s_waitcnt lgkmcnt(6)
    v_mfma_f32_16x16x32_bf16 v[88:91], a[12:15], v[48:51], v[88:91]
    ds_read_b64_tr_b16 v[40:41], v1 offset:12288
    ds_read_b64_tr_b16 v[42:43], v1 offset:13312
    v_mfma_f32_16x16x32_bf16 v[100:103], a[12:15], v[52:55], v[100:103]
    ds_read_b64_tr_b16 v[44:45], v3 offset:12288
    ds_read_b64_tr_b16 v[46:47], v3 offset:13312
    v_mfma_f32_16x16x32_bf16 v[104:107], a[16:19], v[52:55], v[104:107]
    s_add_u32 m0, s96, 10240
    s_add_u32 s86, s95, 51200
    s_waitcnt lgkmcnt(5)
    v_add_f32 v28, v28, v30
    v_mfma_f32_16x16x32_bf16 v[92:95], a[16:19], v[48:51], v[92:95]
    v_add_f32 v29, v29, v31
    s_waitcnt lgkmcnt(4)
    v_add_f32 v32, v32, v34
    v_mfma_f32_16x16x32_bf16 v[96:99], a[20:23], v[48:51], v[96:99]
    buffer_load_dwordx4 v0, s[8:11], s86 offen offset:0 sc1 lds
    v_add_f32 v33, v33, v35
    v_mfma_f32_16x16x32_bf16 v[108:111], a[20:23], v[52:55], v[108:111]
    v_mul_f32 v24, 0xbacccccd, v28
    v_mov_b32 v26, 0x3727c5ac
    v_mfma_f32_16x16x32_bf16 v[16:19], v[12:15], v[48:51], v[16:19]
    v_fmac_f32 v26, 0x3acccccd, v29
    v_mul_f32 v25, 0xbacccccd, v32
    v_mfma_f32_16x16x32_bf16 v[20:23], v[48:51], v[48:51], v[20:23]
    v_mov_b32 v27, 0x3727c5ac
    v_mfma_f32_16x16x32_bf16 v[88:91], a[24:27], v[56:59], v[88:91]
    ds_read_b64_tr_b16 v[48:49], v1 offset:16384
    ds_read_b64_tr_b16 v[50:51], v1 offset:17408
    v_mfma_f32_16x16x32_bf16 v[100:103], a[24:27], v[60:63], v[100:103]
    ds_read_b64_tr_b16 v[52:53], v3 offset:16384
    ds_read_b64_tr_b16 v[54:55], v3 offset:17408
    v_mfma_f32_16x16x32_bf16 v[104:107], a[28:31], v[60:63], v[104:107]
    buffer_load_dwordx4 v0, s[8:11], s86 offen offset:1024 sc1 lds
    v_fmac_f32 v27, 0x3acccccd, v33
    v_mfma_f32_16x16x32_bf16 v[92:95], a[28:31], v[56:59], v[92:95]
    ds_read_b128 v[28:31], v10 offset:0
    ds_read_b128 v[32:35], v10 offset:64
    v_mfma_f32_16x16x32_bf16 v[96:99], a[32:35], v[56:59], v[96:99]
    ds_read_b128 v[36:39], v10 offset:128
    v_fma_f32 v26, -v24, v24, v26
    v_mfma_f32_16x16x32_bf16 v[108:111], a[32:35], v[60:63], v[108:111]
    v_max_f32 v26, 0x3727c5ac, v26
    v_fma_f32 v27, -v25, v25, v27
    v_mfma_f32_16x16x32_bf16 v[16:19], v[12:15], v[56:59], v[16:19]
    buffer_load_dwordx4 v0, s[8:11], s86 offen offset:2048 sc1 lds
    v_max_f32 v27, 0x3727c5ac, v27
    v_mfma_f32_16x16x32_bf16 v[20:23], v[56:59], v[56:59], v[20:23]
    v_rcp_f32 v26, v26
    s_waitcnt lgkmcnt(7)
    v_mfma_f32_16x16x32_bf16 v[88:91], a[36:39], v[40:43], v[88:91]
    ds_read_b64_tr_b16 v[56:57], v2 offset:0
    ds_read_b64_tr_b16 v[58:59], v2 offset:1024
    v_mfma_f32_16x16x32_bf16 v[100:103], a[36:39], v[44:47], v[100:103]
    ds_read_b64_tr_b16 v[60:61], v4 offset:0
    ds_read_b64_tr_b16 v[62:63], v4 offset:1024
    v_mfma_f32_16x16x32_bf16 v[104:107], a[40:43], v[44:47], v[104:107]
    v_rcp_f32 v27, v27
    v_mfma_f32_16x16x32_bf16 v[92:95], a[40:43], v[40:43], v[92:95]
    buffer_load_dwordx4 v0, s[8:11], s86 offen offset:3072 sc1 lds
    s_add_u32 m0, s96, 14336
    s_add_u32 s86, s95, 55296
    v_mfma_f32_16x16x32_bf16 v[96:99], a[44:47], v[40:43], v[96:99]
    s_waitcnt lgkmcnt(6)
    v_fmac_f32 v64, v24, v28
    v_fmac_f32 v65, v24, v29
    v_mfma_f32_16x16x32_bf16 v[108:111], a[44:47], v[44:47], v[108:111]
    v_fmac_f32 v66, v24, v30
    v_fmac_f32 v67, v24, v31
    v_mfma_f32_16x16x32_bf16 v[16:19], v[12:15], v[40:43], v[16:19]
    s_waitcnt lgkmcnt(5)
    v_fmac_f32 v68, v24, v32
    v_fmac_f32 v69, v24, v33
    v_mfma_f32_16x16x32_bf16 v[20:23], v[40:43], v[40:43], v[20:23]
    buffer_load_dwordx4 v0, s[8:11], s86 offen sc1 lds
    v_mfma_f32_16x16x32_bf16 v[88:91], a[48:51], v[48:51], v[88:91]
    ds_read_b64_tr_b16 v[40:41], v2 offset:4096
    ds_read_b64_tr_b16 v[42:43], v2 offset:5120
    v_mfma_f32_16x16x32_bf16 v[100:103], a[48:51], v[52:55], v[100:103]
    ds_read_b64_tr_b16 v[44:45], v4 offset:4096
    ds_read_b64_tr_b16 v[46:47], v4 offset:5120
    v_mfma_f32_16x16x32_bf16 v[104:107], a[52:55], v[52:55], v[104:107]
    s_cmp_lt_u32 s62, 2
    s_cselect_b32 s89, 1, 0
    s_cselect_b32 s90, 32, 40960
    s_cselect_b32 s86, 2621440, 0
    v_mfma_f32_16x16x32_bf16 v[92:95], a[52:55], v[48:51], v[92:95]
    v_and_b32 v5, 0x3c0, v0
    v_lshlrev_b32 v5, s89, v5
    v_mfma_f32_16x16x32_bf16 v[96:99], a[56:59], v[48:51], v[96:99]
    v_and_or_b32 v5, v0, 16, v5
    v_fmac_f32 v70, v24, v34
    v_mfma_f32_16x16x32_bf16 v[108:111], a[56:59], v[52:55], v[108:111]
    s_mov_b32 exec_lo, 0xcccccccc
    s_mov_b32 exec_hi, 0xcccccccc
    v_add_u32 v5, s90, v5
    s_mov_b64 exec, -1
    v_mfma_f32_16x16x32_bf16 v[16:19], v[12:15], v[48:51], v[16:19]
    s_lshl_b32 s90, s66, 5
    s_mul_i32 s99, s65, 5120
    s_add_u32 s90, s90, s99
    s_lshl_b32 s90, s90, s89
    v_mfma_f32_16x16x32_bf16 v[20:23], v[48:51], v[48:51], v[20:23]
    s_add_u32 s86, s86, s90
    s_mul_i32 s90, s69, 1310720
    s_waitcnt lgkmcnt(4)
    v_mfma_f32_16x16x32_bf16 v[88:91], a[60:63], v[56:59], v[88:91]
    ds_read_b64_tr_b16 v[48:49], v2 offset:8192
    ds_read_b64_tr_b16 v[50:51], v2 offset:9216
    v_mfma_f32_16x16x32_bf16 v[100:103], a[60:63], v[60:63], v[100:103]
    ds_read_b64_tr_b16 v[52:53], v4 offset:8192
    ds_read_b64_tr_b16 v[54:55], v4 offset:9216
    v_mfma_f32_16x16x32_bf16 v[104:107], a[64:67], v[60:63], v[104:107]
    s_add_u32 s86, s86, s90
    s_mul_i32 s90, s63, 81920
    s_add_u32 s86, s86, s90
    s_add_u32 s86, s86, 7864320
    v_mfma_f32_16x16x32_bf16 v[92:95], a[64:67], v[56:59], v[92:95]
    s_lshl_b32 s89, 1024, s89
    s_add_u32 m0, s97, 40960
    s_nop 0
    buffer_load_dwordx4 v5, s[8:11], s86 offen sc1 lds
    v_mfma_f32_16x16x32_bf16 v[96:99], a[68:71], v[56:59], v[96:99]
    s_add_u32 m0, s97, 41984
    s_add_u32 s86, s86, s89
    s_lshl_b32 s91, s63, 4
    s_add_u32 s91, s91, s62
    v_mfma_f32_16x16x32_bf16 v[108:111], a[68:71], v[60:63], v[108:111]
    s_lshl_b32 s91, s91, 10
    s_add_u32 s91, s91, 35651584
    s_waitcnt lgkmcnt(4)
    v_mfma_f32_16x16x32_bf16 v[88:91], a[72:75], v[40:43], v[88:91]
    ds_read_b64_tr_b16 v[56:57], v2 offset:12288
    ds_read_b64_tr_b16 v[58:59], v2 offset:13312
    v_mfma_f32_16x16x32_bf16 v[100:103], a[72:75], v[44:47], v[100:103]
    ds_read_b64_tr_b16 v[60:61], v4 offset:12288
    ds_read_b64_tr_b16 v[62:63], v4 offset:13312
    v_mfma_f32_16x16x32_bf16 v[104:107], a[76:79], v[44:47], v[104:107]
    buffer_load_dword v11, v0, s[8:11], s91 offen sc1
    v_fmac_f32 v71, v24, v35
    v_mfma_f32_16x16x32_bf16 v[92:95], a[76:79], v[40:43], v[92:95]
    buffer_load_dwordx4 v5, s[8:11], s86 offen sc1 lds
    s_add_u32 m0, s97, 43008
    s_add_u32 s86, s86, s89
    v_mfma_f32_16x16x32_bf16 v[96:99], a[80:83], v[40:43], v[96:99]
    v_fmac_f32 v72, v24, v36
    v_fmac_f32 v73, v24, v37
    v_mfma_f32_16x16x32_bf16 v[108:111], a[80:83], v[44:47], v[108:111]
    v_fmac_f32 v74, v24, v38
    s_waitcnt lgkmcnt(4)
    v_mfma_f32_16x16x32_bf16 v[88:91], a[84:87], v[48:51], v[88:91]
    ds_read_b64_tr_b16 v[40:41], v2 offset:16384
    ds_read_b64_tr_b16 v[42:43], v2 offset:17408
    v_mfma_f32_16x16x32_bf16 v[100:103], a[84:87], v[52:55], v[100:103]
    ds_read_b64_tr_b16 v[44:45], v4 offset:16384
    ds_read_b64_tr_b16 v[46:47], v4 offset:17408
    v_mfma_f32_16x16x32_bf16 v[104:107], a[88:91], v[52:55], v[104:107]
    buffer_load_dwordx4 v5, s[8:11], s86 offen sc1 lds
    s_add_u32 m0, s97, 44032
    s_add_u32 s86, s86, s89
    v_mfma_f32_16x16x32_bf16 v[92:95], a[88:91], v[48:51], v[92:95]
    v_fmac_f32 v75, v24, v39
    v_fmac_f32 v76, v25, v28
    v_mfma_f32_16x16x32_bf16 v[96:99], a[92:95], v[48:51], v[96:99]
    v_fmac_f32 v77, v25, v29
    v_fmac_f32 v78, v25, v30
    v_mfma_f32_16x16x32_bf16 v[108:111], a[92:95], v[52:55], v[108:111]
    v_fmac_f32 v79, v25, v31
    s_waitcnt lgkmcnt(4)
    v_mfma_f32_16x16x32_bf16 v[88:91], a[96:99], v[56:59], v[88:91]
    buffer_load_dwordx4 v5, s[8:11], s86 offen sc1 lds
    s_add_u32 m0, s97, 45056
    s_add_u32 s86, s86, s89
    v_mfma_f32_16x16x32_bf16 v[100:103], a[96:99], v[60:63], v[100:103]
    v_fmac_f32 v80, v25, v32
    v_fmac_f32 v81, v25, v33
    v_mfma_f32_16x16x32_bf16 v[104:107], a[100:103], v[60:63], v[104:107]
    v_fmac_f32 v82, v25, v34
    buffer_load_dwordx4 v5, s[8:11], s86 offen sc1 lds
    s_waitcnt vmcnt(19) lgkmcnt(0)
    s_barrier
    v_mfma_f32_16x16x32_bf16 v[92:95], a[100:103], v[56:59], v[92:95]
    ds_read_b64_tr_b16 v[48:49], v1 offset:20480
    ds_read_b64_tr_b16 v[50:51], v1 offset:21504
    v_mfma_f32_16x16x32_bf16 v[96:99], a[104:107], v[56:59], v[96:99]
    ds_read_b64_tr_b16 v[52:53], v3 offset:20480
    ds_read_b64_tr_b16 v[54:55], v3 offset:21504
    v_mfma_f32_16x16x32_bf16 v[108:111], a[104:107], v[60:63], v[108:111]
    s_add_u32 m0, s96, 15360
    s_add_u32 s86, s95, 56320
    v_mfma_f32_16x16x32_bf16 v[88:91], a[108:111], v[40:43], v[88:91]
    ds_read_b64_tr_b16 v[56:57], v1 offset:24576
    ds_read_b64_tr_b16 v[58:59], v1 offset:25600
    v_mfma_f32_16x16x32_bf16 v[100:103], a[108:111], v[44:47], v[100:103]
    ds_read_b64_tr_b16 v[60:61], v3 offset:24576
    ds_read_b64_tr_b16 v[62:63], v3 offset:25600
    v_mfma_f32_16x16x32_bf16 v[104:107], a[112:115], v[44:47], v[104:107]
    buffer_load_dwordx4 v0, s[8:11], s86 offen offset:0 sc1 lds
    v_fmac_f32 v83, v25, v35
    v_mfma_f32_16x16x32_bf16 v[92:95], a[112:115], v[40:43], v[92:95]
    v_fmac_f32 v84, v25, v36
    v_fmac_f32 v85, v25, v37
    v_mfma_f32_16x16x32_bf16 v[96:99], a[116:119], v[40:43], v[96:99]
    v_fmac_f32 v86, v25, v38
    v_fmac_f32 v87, v25, v39
    v_mfma_f32_16x16x32_bf16 v[108:111], a[116:119], v[44:47], v[108:111]
    s_lshl_b32 s85, s1, 2
    s_add_u32 s85, s85, s62
    s_waitcnt lgkmcnt(4)
    v_mfma_f32_16x16x32_bf16 v[88:91], a[120:123], v[48:51], v[88:91]
    ds_read_b64_tr_b16 v[40:41], v1 offset:28672
    ds_read_b64_tr_b16 v[42:43], v1 offset:29696
    v_mfma_f32_16x16x32_bf16 v[100:103], a[120:123], v[52:55], v[100:103]
    ds_read_b64_tr_b16 v[44:45], v3 offset:28672
    ds_read_b64_tr_b16 v[46:47], v3 offset:29696
    v_mfma_f32_16x16x32_bf16 v[104:107], a[124:127], v[52:55], v[104:107]
    buffer_load_dwordx4 v0, s[8:11], s86 offen offset:1024 sc1 lds
    s_lshl_b32 s85, s85, 6
    s_add_u32 s85, s85, s75
    v_mfma_f32_16x16x32_bf16 v[92:95], a[124:127], v[48:51], v[92:95]
    v_mov_b32 v37, s68
    s_add_u32 s85, s85, 4096
    v_mfma_f32_16x16x32_bf16 v[96:99], a[128:131], v[48:51], v[96:99]
    s_waitcnt vmcnt(15)
    v_mfma_f32_16x16x32_bf16 v[108:111], a[128:131], v[52:55], v[108:111]
    s_mov_b64 exec, 15
    buffer_store_dword v37, v0, s[8:11], s85 offen sc1
    s_mov_b64 exec, -1
    v_mfma_f32_16x16x32_bf16 v[16:19], v[12:15], v[48:51], v[16:19]
    v_permlane32_swap_b32 v72, v74
    v_mfma_f32_16x16x32_bf16 v[20:23], v[48:51], v[48:51], v[20:23]
    v_permlane32_swap_b32 v73, v75
    s_waitcnt lgkmcnt(4)
    v_mfma_f32_16x16x32_bf16 v[88:91], a[132:135], v[56:59], v[88:91]
    ds_read_b64_tr_b16 v[48:49], v1 offset:32768
    ds_read_b64_tr_b16 v[50:51], v1 offset:33792
    v_mfma_f32_16x16x32_bf16 v[100:103], a[132:135], v[60:63], v[100:103]
    ds_read_b64_tr_b16 v[52:53], v3 offset:32768
    ds_read_b64_tr_b16 v[54:55], v3 offset:33792
    v_mfma_f32_16x16x32_bf16 v[104:107], a[136:139], v[60:63], v[104:107]
    buffer_load_dwordx4 v0, s[8:11], s86 offen offset:2048 sc1 lds
    v_max_f32 v64, 0, v64
    v_mfma_f32_16x16x32_bf16 v[92:95], a[136:139], v[56:59], v[92:95]
    v_mul_f32 v68, v26, v68
    v_max_f32 v65, 0, v65
    v_mfma_f32_16x16x32_bf16 v[96:99], a[140:143], v[56:59], v[96:99]
    v_mul_f32 v69, v26, v69
    v_max_f32 v66, 0, v66
    v_mfma_f32_16x16x32_bf16 v[108:111], a[140:143], v[60:63], v[108:111]
    v_mul_f32 v70, v26, v70
    v_max_f32 v67, 0, v67
    v_mfma_f32_16x16x32_bf16 v[16:19], v[12:15], v[56:59], v[16:19]
    buffer_load_dwordx4 v0, s[8:11], s86 offen offset:3072 sc1 lds
    s_add_u32 m0, s96, 19456
    s_add_u32 s86, s95, 60416
    v_mfma_f32_16x16x32_bf16 v[20:23], v[56:59], v[56:59], v[20:23]
    v_mul_f32 v71, v26, v71
    s_waitcnt lgkmcnt(4)
    v_mfma_f32_16x16x32_bf16 v[88:91], a[144:147], v[40:43], v[88:91]
    ds_read_b64_tr_b16 v[56:57], v1 offset:36864
    ds_read_b64_tr_b16 v[58:59], v1 offset:37888
    v_mfma_f32_16x16x32_bf16 v[100:103], a[144:147], v[44:47], v[100:103]
    ds_read_b64_tr_b16 v[60:61], v3 offset:36864
    ds_read_b64_tr_b16 v[62:63], v3 offset:37888
    v_mfma_f32_16x16x32_bf16 v[104:107], a[148:151], v[44:47], v[104:107]
    v_max_f32 v72, 0, v72
    v_mul_f32 v74, v26, v74
    v_mfma_f32_16x16x32_bf16 v[92:95], a[148:151], v[40:43], v[92:95]
    buffer_load_dwordx4 v0, s[8:11], s86 offen sc1 lds
    v_max_f32 v73, 0, v73
    v_mfma_f32_16x16x32_bf16 v[96:99], a[152:155], v[40:43], v[96:99]
    v_mul_f32 v75, v26, v75
    v_mul_f32 v64, v64, v68
    v_mfma_f32_16x16x32_bf16 v[108:111], a[152:155], v[44:47], v[108:111]
    v_mul_f32 v65, v65, v69
    v_mul_f32 v66, v66, v70
    v_mfma_f32_16x16x32_bf16 v[16:19], v[12:15], v[40:43], v[16:19]
    v_mul_f32 v67, v67, v71
    v_mul_f32 v72, v72, v74
    v_mfma_f32_16x16x32_bf16 v[20:23], v[40:43], v[40:43], v[20:23]
    v_mul_f32 v73, v73, v75
    s_waitcnt lgkmcnt(4)
    v_mfma_f32_16x16x32_bf16 v[88:91], a[156:159], v[48:51], v[88:91]
    ds_read_b64_tr_b16 v[40:41], v2 offset:20480
    ds_read_b64_tr_b16 v[42:43], v2 offset:21504
    v_mfma_f32_16x16x32_bf16 v[100:103], a[156:159], v[52:55], v[100:103]
    ds_read_b64_tr_b16 v[44:45], v4 offset:20480
    ds_read_b64_tr_b16 v[46:47], v4 offset:21504
    v_mfma_f32_16x16x32_bf16 v[104:107], a[160:163], v[52:55], v[104:107]
    v_cvt_pk_bf16_f32 v28, v64, v65
    v_cvt_pk_bf16_f32 v29, v66, v67
    v_mfma_f32_16x16x32_bf16 v[92:95], a[160:163], v[48:51], v[92:95]
    v_cvt_pk_bf16_f32 v32, v72, v73
    v_permlane32_swap_b32 v84, v86
    v_mfma_f32_16x16x32_bf16 v[96:99], a[164:167], v[48:51], v[96:99]
    v_permlane32_swap_b32 v85, v87
    v_mfma_f32_16x16x32_bf16 v[108:111], a[164:167], v[52:55], v[108:111]
    v_max_f32 v76, 0, v76
    v_mul_f32 v80, v27, v80
    v_mfma_f32_16x16x32_bf16 v[16:19], v[12:15], v[48:51], v[16:19]
    v_max_f32 v77, 0, v77
    v_mul_f32 v81, v27, v81
    v_mfma_f32_16x16x32_bf16 v[20:23], v[48:51], v[48:51], v[20:23]
    v_max_f32 v78, 0, v78
    s_waitcnt lgkmcnt(4)
    v_mfma_f32_16x16x32_bf16 v[88:91], a[168:171], v[56:59], v[88:91]
    ds_read_b64_tr_b16 v[48:49], v2 offset:24576
    ds_read_b64_tr_b16 v[50:51], v2 offset:25600
    v_mfma_f32_16x16x32_bf16 v[100:103], a[168:171], v[60:63], v[100:103]
    ds_read_b64_tr_b16 v[52:53], v4 offset:24576
    ds_read_b64_tr_b16 v[54:55], v4 offset:25600
    v_mfma_f32_16x16x32_bf16 v[104:107], a[172:175], v[60:63], v[104:107]
    v_mul_f32 v82, v27, v82
    v_max_f32 v79, 0, v79
    v_mfma_f32_16x16x32_bf16 v[92:95], a[172:175], v[56:59], v[92:95]
    v_mul_f32 v83, v27, v83
    v_max_f32 v84, 0, v84
    v_mfma_f32_16x16x32_bf16 v[96:99], a[176:179], v[56:59], v[96:99]
    v_mul_f32 v86, v27, v86
    v_max_f32 v85, 0, v85
    v_mfma_f32_16x16x32_bf16 v[108:111], a[176:179], v[60:63], v[108:111]
    v_mul_f32 v87, v27, v87
    v_mul_f32 v76, v76, v80
    v_mfma_f32_16x16x32_bf16 v[16:19], v[12:15], v[56:59], v[16:19]
    v_mul_f32 v77, v77, v81
    v_mul_f32 v78, v78, v82
    v_mfma_f32_16x16x32_bf16 v[20:23], v[56:59], v[56:59], v[20:23]
    v_mul_f32 v79, v79, v83
    s_waitcnt lgkmcnt(4)
    s_waitcnt vmcnt(10)
    v_cmp_ne_u32 vcc, s68, v11
    s_cbranch_vccz L_pd_22
L_pl_21:
    s_cmp_eq_u32 s72, 0
    s_cbranch_scc1 L_pd_22
    s_sub_u32 s72, s72, 1
    buffer_load_dword v11, v0, s[8:11], s91 offen sc1
    s_waitcnt vmcnt(0)
    v_cmp_ne_u32 vcc, s68, v11
    s_cbranch_vccnz L_pl_21
L_pd_22:
    v_mul_f32 v84, v84, v86
    v_mul_f32 v85, v85, v87
    v_cvt_pk_bf16_f32 v30, v76, v77
    v_cvt_pk_bf16_f32 v31, v78, v79
    v_cvt_pk_bf16_f32 v33, v84, v85
    v_bfe_u32 v34, v0, 8, 1
    s_mov_b32 s88, -248
    v_mad_i32_i24 v34, v34, s88, v8
    v_permlane32_swap_b32 v28, v30
    v_permlane32_swap_b32 v29, v31
    v_permlane32_swap_b32 v32, v33
    s_add_u32 s88, s74, 3145728
    s_lshl_b32 s87, s62, 8
    buffer_store_dwordx4 v[28:31], v8, s[8:11], s88 offen sc1
    s_add_u32 s88, s88, 2048
    s_sub_u32 s88, s88, s87
    buffer_store_dwordx2 v[32:33], v34, s[8:11], s88 offen sc1
    v_mfma_f32_16x16x32_bf16 v[88:91], a[180:183], v[40:43], v[88:91]
    ds_read_b64_tr_b16 v[56:57], v2 offset:28672
    ds_read_b64_tr_b16 v[58:59], v2 offset:29696
    v_mfma_f32_16x16x32_bf16 v[100:103], a[180:183], v[44:47], v[100:103]
    ds_read_b64_tr_b16 v[60:61], v4 offset:28672
    ds_read_b64_tr_b16 v[62:63], v4 offset:29696
    v_mfma_f32_16x16x32_bf16 v[104:107], a[184:187], v[44:47], v[104:107]
    s_mul_i32 s92, s66, 98304
    s_mul_i32 s93, s62, 12288
    s_add_u32 s92, s92, s93
    s_mul_i32 s93, s63, 196608
    v_mfma_f32_16x16x32_bf16 v[92:95], a[184:187], v[40:43], v[92:95]
    s_add_u32 s92, s92, s93
    s_add_u32 s92, s92, 15728640
    s_add_u32 s93, s92, 0
    v_mfma_f32_16x16x32_bf16 v[96:99], a[188:191], v[40:43], v[96:99]
    buffer_load_dwordx4 v[64:67], v0, s[8:11], s93 offen offset:0 sc1
    v_mfma_f32_16x16x32_bf16 v[108:111], a[188:191], v[44:47], v[108:111]
    s_waitcnt lgkmcnt(4)
    v_mfma_f32_16x16x32_bf16 v[88:91], a[192:195], v[48:51], v[88:91]
    ds_read_b64_tr_b16 v[40:41], v2 offset:32768
    ds_read_b64_tr_b16 v[42:43], v2 offset:33792
    v_mfma_f32_16x16x32_bf16 v[100:103], a[192:195], v[52:55], v[100:103]
    ds_read_b64_tr_b16 v[44:45], v4 offset:32768
    ds_read_b64_tr_b16 v[46:47], v4 offset:33792
    v_mfma_f32_16x16x32_bf16 v[104:107], a[196:199], v[52:55], v[104:107]
    v_cndmask_b32 v39, v20, v21, s[76:77]
    v_cndmask_b32 v39, v39, v22, s[78:79]
    v_mfma_f32_16x16x32_bf16 v[92:95], a[196:199], v[48:51], v[92:95]
    v_cndmask_b32 v39, v39, v23, s[80:81]
    v_mov_b32 v38, v16
    v_mfma_f32_16x16x32_bf16 v[96:99], a[200:203], v[48:51], v[96:99]
    ds_write_b64 v6, v[38:39] offset:512
    buffer_load_dwordx4 v[68:71], v0, s[8:11], s93 offen offset:1024 sc1
    v_mfma_f32_16x16x32_bf16 v[108:111], a[200:203], v[52:55], v[108:111]
    s_waitcnt lgkmcnt(5)
    v_mfma_f32_16x16x32_bf16 v[88:91], a[204:207], v[56:59], v[88:91]
    ds_read_b64_tr_b16 v[48:49], v2 offset:36864
    ds_read_b64_tr_b16 v[50:51], v2 offset:37888
    v_mfma_f32_16x16x32_bf16 v[100:103], a[204:207], v[60:63], v[100:103]
    ds_read_b64_tr_b16 v[52:53], v4 offset:36864
    ds_read_b64_tr_b16 v[54:55], v4 offset:37888
    v_mfma_f32_16x16x32_bf16 v[104:107], a[208:211], v[60:63], v[104:107]
    buffer_load_dwordx4 v[72:75], v0, s[8:11], s93 offen offset:2048 sc1
    v_mfma_f32_16x16x32_bf16 v[92:95], a[208:211], v[56:59], v[92:95]
    v_mfma_f32_16x16x32_bf16 v[96:99], a[212:215], v[56:59], v[96:99]
    v_mfma_f32_16x16x32_bf16 v[108:111], a[212:215], v[60:63], v[108:111]
    s_waitcnt lgkmcnt(5)
    v_mfma_f32_16x16x32_bf16 v[88:91], a[216:219], v[40:43], v[88:91]
    v_mfma_f32_16x16x32_bf16 v[100:103], a[216:219], v[44:47], v[100:103]
    buffer_load_dwordx4 v[76:79], v0, s[8:11], s93 offen offset:3072 sc1
    s_add_u32 s93, s92, 4096
    v_mfma_f32_16x16x32_bf16 v[104:107], a[220:223], v[44:47], v[104:107]
    s_waitcnt lgkmcnt(0)
    s_barrier
    v_mfma_f32_16x16x32_bf16 v[92:95], a[220:223], v[40:43], v[92:95]
    v_mfma_f32_16x16x32_bf16 v[96:99], a[224:227], v[40:43], v[96:99]
    v_mfma_f32_16x16x32_bf16 v[108:111], a[224:227], v[44:47], v[108:111]
    buffer_load_dwordx4 v[80:83], v0, s[8:11], s93 offen offset:0 sc1
    v_mfma_f32_16x16x32_bf16 v[88:91], a[228:231], v[48:51], v[88:91]
    v_mfma_f32_16x16x32_bf16 v[100:103], a[228:231], v[52:55], v[100:103]
    v_mfma_f32_16x16x32_bf16 v[104:107], a[232:235], v[52:55], v[104:107]
    v_mfma_f32_16x16x32_bf16 v[92:95], a[232:235], v[48:51], v[92:95]
    v_mfma_f32_16x16x32_bf16 v[96:99], a[236:239], v[48:51], v[96:99]
    buffer_load_dwordx4 v[84:87], v0, s[8:11], s93 offen offset:1024 sc1
    v_mfma_f32_16x16x32_bf16 v[108:111], a[236:239], v[52:55], v[108:111]
    ds_read_b128 v[28:31], v7 offset:512
    v_xor_b32 v36, 256, v7
    ds_read_b128 v[32:35], v36 offset:512
    s_waitcnt lgkmcnt(1)
    v_add_f32 v28, v28, v30
    v_add_f32 v29, v29, v31
    s_waitcnt lgkmcnt(0)
    v_add_f32 v32, v32, v34
    v_add_f32 v33, v33, v35
    s_lshl_b32 s91, s63, 4
    s_add_u32 s91, s91, s62
    s_lshl_b32 s91, s91, 10
    s_add_u32 s91, s91, 35655680
    buffer_load_dword v11, v0, s[8:11], s91 offen sc1
    v_mul_f32 v24, 0xbacccccd, v28
    v_mov_b32 v26, 0x3727c5ac
    v_fmac_f32 v26, 0x3acccccd, v29
    v_mul_f32 v25, 0xbacccccd, v32
    v_mov_b32 v27, 0x3727c5ac
    v_fmac_f32 v27, 0x3acccccd, v33
    ds_read_b128 v[28:31], v10 offset:0
    ds_read_b128 v[32:35], v10 offset:64
    buffer_load_dwordx4 v[40:43], v0, s[8:11], s93 offen offset:2048 sc1
    ds_read_b128 v[36:39], v10 offset:128
    v_fma_f32 v26, -v24, v24, v26
    v_max_f32 v26, 0x3727c5ac, v26
    v_fma_f32 v27, -v25, v25, v27
    v_max_f32 v27, 0x3727c5ac, v27
    v_rcp_f32 v26, v26
    v_rcp_f32 v27, v27
    buffer_load_dwordx4 v[44:47], v0, s[8:11], s93 offen offset:3072 sc1
    s_waitcnt lgkmcnt(2)
    v_pk_fma_f32 v[88:89], v[24:25], v[28:29], v[88:89] op_sel:[0,0,0] op_sel_hi:[0,1,1]
    v_pk_fma_f32 v[90:91], v[24:25], v[30:31], v[90:91] op_sel:[0,0,0] op_sel_hi:[0,1,1]
    s_waitcnt lgkmcnt(1)
    v_pk_fma_f32 v[92:93], v[24:25], v[32:33], v[92:93] op_sel:[0,0,0] op_sel_hi:[0,1,1]
    v_pk_fma_f32 v[94:95], v[24:25], v[34:35], v[94:95] op_sel:[0,0,0] op_sel_hi:[0,1,1]
    s_waitcnt lgkmcnt(0)
    v_pk_fma_f32 v[96:97], v[24:25], v[36:37], v[96:97] op_sel:[0,0,0] op_sel_hi:[0,1,1]
    v_pk_fma_f32 v[98:99], v[24:25], v[38:39], v[98:99] op_sel:[0,0,0] op_sel_hi:[0,1,1]
    v_pk_fma_f32 v[100:101], v[24:25], v[28:29], v[100:101] op_sel:[1,0,0] op_sel_hi:[1,1,1]
    v_pk_fma_f32 v[102:103], v[24:25], v[30:31], v[102:103] op_sel:[1,0,0] op_sel_hi:[1,1,1]
    s_add_u32 s93, s92, 8192
    buffer_load_dwordx4 v[48:51], v0, s[8:11], s93 offen offset:0 sc1
    v_pk_fma_f32 v[104:105], v[24:25], v[32:33], v[104:105] op_sel:[1,0,0] op_sel_hi:[1,1,1]
    v_pk_fma_f32 v[106:107], v[24:25], v[34:35], v[106:107] op_sel:[1,0,0] op_sel_hi:[1,1,1]
    v_pk_fma_f32 v[108:109], v[24:25], v[36:37], v[108:109] op_sel:[1,0,0] op_sel_hi:[1,1,1]
    v_pk_fma_f32 v[110:111], v[24:25], v[38:39], v[110:111] op_sel:[1,0,0] op_sel_hi:[1,1,1]
    s_lshl_b32 s85, s1, 2
    s_add_u32 s85, s85, s62
    s_lshl_b32 s85, s85, 6
    s_add_u32 s85, s85, s75
    v_mov_b32 v37, s68
    s_add_u32 s85, s85, 8192
    buffer_load_dwordx4 v[52:55], v0, s[8:11], s93 offen offset:1024 sc1
    s_waitcnt vmcnt(11)
    s_mov_b64 exec, 15
    buffer_store_dword v37, v0, s[8:11], s85 offen sc1
    s_mov_b64 exec, -1
    v_permlane32_swap_b32 v96, v98
    v_permlane32_swap_b32 v97, v99
    v_pk_mul_f32 v[92:93], v[26:27], v[92:93] op_sel:[0,0] op_sel_hi:[0,1]
    v_pk_mul_f32 v[94:95], v[26:27], v[94:95] op_sel:[0,0] op_sel_hi:[0,1]
    v_pk_mul_f32 v[98:99], v[26:27], v[98:99] op_sel:[0,0] op_sel_hi:[0,1]
    v_max_f32 v88, 0, v88
    buffer_load_dwordx4 v[56:59], v0, s[8:11], s93 offen offset:2048 sc1
    v_max_f32 v89, 0, v89
    v_max_f32 v90, 0, v90
    v_max_f32 v91, 0, v91
    v_max_f32 v96, 0, v96
    v_max_f32 v97, 0, v97
    v_pk_mul_f32 v[88:89], v[88:89], v[92:93]
    v_pk_mul_f32 v[90:91], v[90:91], v[94:95]
    v_pk_mul_f32 v[96:97], v[96:97], v[98:99]
    buffer_load_dwordx4 v[60:63], v0, s[8:11], s93 offen offset:3072 sc1
    v_cvt_pk_bf16_f32 v28, v88, v89
    v_cvt_pk_bf16_f32 v29, v90, v91
    v_cvt_pk_bf16_f32 v32, v96, v97
    v_permlane32_swap_b32 v108, v110
    v_permlane32_swap_b32 v109, v111
    v_pk_mul_f32 v[104:105], v[26:27], v[104:105] op_sel:[1,0] op_sel_hi:[1,1]
    v_pk_mul_f32 v[106:107], v[26:27], v[106:107] op_sel:[1,0] op_sel_hi:[1,1]
    v_pk_mul_f32 v[110:111], v[26:27], v[110:111] op_sel:[1,0] op_sel_hi:[1,1]
    v_max_f32 v100, 0, v100
    v_max_f32 v101, 0, v101
    v_max_f32 v102, 0, v102
    v_max_f32 v103, 0, v103
    v_max_f32 v108, 0, v108
    v_max_f32 v109, 0, v109
    v_pk_mul_f32 v[100:101], v[100:101], v[104:105]
    v_pk_mul_f32 v[102:103], v[102:103], v[106:107]
    v_pk_mul_f32 v[108:109], v[108:109], v[110:111]
    v_cvt_pk_bf16_f32 v30, v100, v101
    v_cvt_pk_bf16_f32 v31, v102, v103
    v_cvt_pk_bf16_f32 v33, v108, v109
    v_bfe_u32 v34, v0, 8, 1
    s_mov_b32 s88, -248
    v_mad_i32_i24 v34, v34, s88, v8
    v_permlane32_swap_b32 v28, v30
    v_permlane32_swap_b32 v29, v31
    v_permlane32_swap_b32 v32, v33
    s_add_u32 s88, s74, 3194880
    s_lshl_b32 s87, s62, 8
    buffer_store_dwordx4 v[28:31], v8, s[8:11], s88 offen sc1
    s_add_u32 s88, s88, 2048
    s_sub_u32 s88, s88, s87
    buffer_store_dwordx2 v[32:33], v34, s[8:11], s88 offen sc1
    s_waitcnt vmcnt(9)
    v_cmp_ne_u32 vcc, s68, v11
    s_cbranch_vccz L_pd_24
L_pl_23:
    s_cmp_eq_u32 s72, 0
    s_cbranch_scc1 L_pd_24
    s_sub_u32 s72, s72, 1
    buffer_load_dword v11, v0, s[8:11], s91 offen sc1
    s_waitcnt vmcnt(0)
    v_cmp_ne_u32 vcc, s68, v11
    s_cbranch_vccnz L_pl_23
L_pd_24:
L_g2_0:
    v_mfma_f32_16x16x32_bf16 v[12:15], v[112:115], v[64:67], 0
    v_lshrrev_b32 v1, 8, v0
    v_and_b32 v1, 1, v1
    v_mfma_f32_16x16x32_bf16 v[16:19], v[116:119], v[64:67], 0
    v_lshlrev_b32 v1, 7, v1
    v_xor_b32 v1, v1, v0
    v_mfma_f32_16x16x32_bf16 v[20:23], v[120:123], v[64:67], 0
    s_mul_i32 s87, s62, 10240
    v_add_u32 v1, s87, v1
    v_mfma_f32_16x16x32_bf16 v[24:27], v[124:127], v[64:67], 0
    s_lshr_b32 s87, s62, 1
    s_mul_i32 s87, s87, 5120
    v_bfe_u32 v8, v0, 7, 2
    v_mfma_f32_16x16x32_bf16 v[28:31], v[128:131], v[64:67], 0
    v_and_b32 v10, 1, v8
    v_mfma_f32_16x16x32_bf16 v[12:15], v[132:135], v[68:71], v[12:15]
    v_xor_b32 v10, s69, v10
    v_lshlrev_b32 v8, 8, v8
    v_mfma_f32_16x16x32_bf16 v[16:19], v[136:139], v[68:71], v[16:19]
    s_add_u32 s93, s92, 49152
    buffer_load_dwordx4 v[64:67], v0, s[8:11], s93 offen offset:0 sc1
    v_mfma_f32_16x16x32_bf16 v[20:23], v[140:143], v[68:71], v[20:23]
    v_lshl_add_u32 v8, v10, 7, v8
    v_and_b32 v10, 0x70, v0
    v_mfma_f32_16x16x32_bf16 v[24:27], v[144:147], v[68:71], v[24:27]
    v_add_u32 v8, v8, v10
    v_lshrrev_b32 v10, 9, v0
    v_mfma_f32_16x16x32_bf16 v[28:31], v[148:151], v[68:71], v[28:31]
    v_lshl_add_u32 v8, v10, 10, v8
    v_mfma_f32_16x16x32_bf16 v[12:15], v[152:155], v[72:75], v[12:15]
    v_add_u32 v8, s87, v8
    v_lshrrev_b32 v10, 8, v0
    v_mfma_f32_16x16x32_bf16 v[16:19], v[156:159], v[72:75], v[16:19]
    buffer_load_dwordx4 v[68:71], v0, s[8:11], s93 offen offset:1024 sc1
    v_lshlrev_b32 v10, 3, v10
    v_mfma_f32_16x16x32_bf16 v[20:23], v[160:163], v[72:75], v[20:23]
    v_bfe_u32 v2, v0, 5, 1
    v_lshl_add_u32 v10, v2, 2, v10
    v_mfma_f32_16x16x32_bf16 v[24:27], v[164:167], v[72:75], v[24:27]
    v_bfe_u32 v2, v0, 6, 2
    v_add_u32 v10, v10, v2
    v_mfma_f32_16x16x32_bf16 v[28:31], v[168:171], v[72:75], v[28:31]
    v_lshlrev_b32 v10, 6, v10
    v_mfma_f32_16x16x32_bf16 v[12:15], v[172:175], v[76:79], v[12:15]
    v_bfe_u32 v2, v0, 4, 1
    v_lshl_add_u32 v10, v2, 3, v10
    v_mfma_f32_16x16x32_bf16 v[16:19], v[176:179], v[76:79], v[16:19]
    buffer_load_dwordx4 v[72:75], v0, s[8:11], s93 offen offset:2048 sc1
    s_lshl_b32 s87, s62, 4
    s_add_u32 s87, s87, 40960
    v_mfma_f32_16x16x32_bf16 v[20:23], v[180:183], v[76:79], v[20:23]
    v_add_u32 v10, s87, v10
    s_lshl_b32 s94, s63, 14
    s_lshl_b32 s87, s66, 12
    v_mfma_f32_16x16x32_bf16 v[24:27], v[184:187], v[76:79], v[24:27]
    s_add_u32 s94, s94, s87
    s_lshl_b32 s87, s62, 10
    s_add_u32 s94, s94, s87
    s_add_u32 s94, s94, 28835840
    v_mfma_f32_16x16x32_bf16 v[28:31], v[188:191], v[76:79], v[28:31]
    s_mul_i32 s99, s63, 81920
    s_mul_i32 s87, s66, 40960
    v_mfma_f32_16x16x32_bf16 v[12:15], v[192:195], v[80:83], v[12:15]
    s_add_u32 s99, s99, s87
    s_lshr_b32 s87, s62, 1
    s_mul_i32 s87, s87, 20480
    s_add_u32 s99, s99, s87
    v_mfma_f32_16x16x32_bf16 v[16:19], v[196:199], v[80:83], v[16:19]
    buffer_load_dwordx4 v[76:79], v0, s[8:11], s93 offen offset:3072 sc1
    s_mul_i32 s87, s65, 2560
    s_add_u32 s99, s99, s87
    v_mfma_f32_16x16x32_bf16 v[20:23], v[200:203], v[80:83], v[20:23]
    s_lshl_b32 s87, s69, 6
    s_add_u32 s99, s99, s87
    v_mfma_f32_16x16x32_bf16 v[24:27], v[204:207], v[80:83], v[24:27]
    v_mfma_f32_16x16x32_bf16 v[28:31], v[208:211], v[80:83], v[28:31]
    v_mfma_f32_16x16x32_bf16 v[12:15], v[212:215], v[84:87], v[12:15]
    v_mfma_f32_16x16x32_bf16 v[16:19], v[216:219], v[84:87], v[16:19]
    s_add_u32 s93, s92, 53248
    buffer_load_dwordx4 v[80:83], v0, s[8:11], s93 offen offset:0 sc1
    v_mfma_f32_16x16x32_bf16 v[20:23], v[220:223], v[84:87], v[20:23]
    v_mfma_f32_16x16x32_bf16 v[24:27], v[224:227], v[84:87], v[24:27]
    v_mfma_f32_16x16x32_bf16 v[28:31], v[228:231], v[84:87], v[28:31]
    s_waitcnt vmcnt(13)
    v_mfma_f32_16x16x32_bf16 v[12:15], v[232:235], v[40:43], v[12:15]
    v_mfma_f32_16x16x32_bf16 v[16:19], v[236:239], v[40:43], v[16:19]
    buffer_load_dwordx4 v[84:87], v0, s[8:11], s93 offen offset:1024 sc1
    v_mfma_f32_16x16x32_bf16 v[20:23], v[240:243], v[40:43], v[20:23]
    v_mfma_f32_16x16x32_bf16 v[24:27], v[244:247], v[40:43], v[24:27]
    ds_read_b128 v[88:91], v9 offset:0
    v_mfma_f32_16x16x32_bf16 v[28:31], v[248:251], v[40:43], v[28:31]
    ds_read_b128 v[92:95], v9 offset:1024
    s_waitcnt vmcnt(13)
    v_mfma_f32_16x16x32_bf16 v[12:15], a[240:243], v[44:47], v[12:15]
    ds_read_b128 v[96:99], v9 offset:2048
    v_mfma_f32_16x16x32_bf16 v[16:19], a[244:247], v[44:47], v[16:19]
    ds_read_b128 v[100:103], v9 offset:3072
    buffer_load_dwordx4 v[40:43], v0, s[8:11], s93 offen offset:2048 sc1
    v_mfma_f32_16x16x32_bf16 v[20:23], a[248:251], v[44:47], v[20:23]
    ds_read_b128 v[104:107], v9 offset:4096
    v_mfma_f32_16x16x32_bf16 v[24:27], a[252:255], v[44:47], v[24:27]
    ds_read_b128 v[32:35], v9 offset:5120
    v_mfma_f32_16x16x32_bf16 v[28:31], v[252:255], v[44:47], v[28:31]
    ds_read_b128 v[36:39], v9 offset:6144
    s_waitcnt vmcnt(13)
    s_waitcnt lgkmcnt(5)
    v_mfma_f32_16x16x32_bf16 v[12:15], v[88:91], v[48:51], v[12:15]
    ds_read_b128 v[108:111], v9 offset:7168
    v_mfma_f32_16x16x32_bf16 v[16:19], v[92:95], v[48:51], v[16:19]
    ds_read_b128 v[88:91], v9 offset:8192
    buffer_load_dwordx4 v[44:47], v0, s[8:11], s93 offen offset:3072 sc1
    s_waitcnt lgkmcnt(5)
    v_mfma_f32_16x16x32_bf16 v[20:23], v[96:99], v[48:51], v[20:23]
    ds_read_b128 v[92:95], v9 offset:9216
    v_mfma_f32_16x16x32_bf16 v[24:27], v[100:103], v[48:51], v[24:27]
    ds_read_b128 v[96:99], v9 offset:10240
    s_waitcnt lgkmcnt(5)
    v_mfma_f32_16x16x32_bf16 v[28:31], v[104:107], v[48:51], v[28:31]
    ds_read_b128 v[100:103], v9 offset:11264
    s_waitcnt vmcnt(13)
    v_mfma_f32_16x16x32_bf16 v[12:15], v[32:35], v[52:55], v[12:15]
    ds_read_b128 v[104:107], v9 offset:12288
    s_waitcnt lgkmcnt(5)
    v_mfma_f32_16x16x32_bf16 v[16:19], v[36:39], v[52:55], v[16:19]
    ds_read_b128 v[32:35], v9 offset:13312
    s_add_u32 s93, s92, 57344
    buffer_load_dwordx4 v[48:51], v0, s[8:11], s93 offen offset:0 sc1
    v_mfma_f32_16x16x32_bf16 v[20:23], v[108:111], v[52:55], v[20:23]
    ds_read_b128 v[36:39], v9 offset:14336
    s_waitcnt lgkmcnt(5)
    v_mfma_f32_16x16x32_bf16 v[24:27], v[88:91], v[52:55], v[24:27]
    ds_read_b128 v[108:111], v9 offset:15360
    v_mfma_f32_16x16x32_bf16 v[28:31], v[92:95], v[52:55], v[28:31]
    ds_read_b128 v[88:91], v9 offset:16384
    s_waitcnt vmcnt(12)
    s_waitcnt lgkmcnt(5)
    v_mfma_f32_16x16x32_bf16 v[12:15], v[96:99], v[56:59], v[12:15]
    ds_read_b128 v[92:95], v9 offset:17408
    s_lshl_b32 s85, s1, 2
    s_add_u32 s85, s85, s62
    v_mfma_f32_16x16x32_bf16 v[16:19], v[100:103], v[56:59], v[16:19]
    ds_read_b128 v[96:99], v9 offset:18432
    buffer_load_dwordx4 v[52:55], v0, s[8:11], s93 offen offset:1024 sc1
    s_waitcnt lgkmcnt(5)
    v_mfma_f32_16x16x32_bf16 v[20:23], v[104:107], v[56:59], v[20:23]
    ds_read_b128 v[100:103], v9 offset:19456
    s_lshl_b32 s85, s85, 6
    s_add_u32 s85, s85, s75
    v_mfma_f32_16x16x32_bf16 v[24:27], v[32:35], v[56:59], v[24:27]
    s_waitcnt lgkmcnt(4)
    v_mfma_f32_16x16x32_bf16 v[28:31], v[36:39], v[56:59], v[28:31]
    s_waitcnt vmcnt(12)
    v_mfma_f32_16x16x32_bf16 v[12:15], v[108:111], v[60:63], v[12:15]
    s_waitcnt lgkmcnt(2)
    v_mfma_f32_16x16x32_bf16 v[16:19], v[88:91], v[60:63], v[16:19]
    buffer_load_dwordx4 v[56:59], v0, s[8:11], s93 offen offset:2048 sc1
    v_mfma_f32_16x16x32_bf16 v[20:23], v[92:95], v[60:63], v[20:23]
    s_waitcnt lgkmcnt(0)
    v_mfma_f32_16x16x32_bf16 v[24:27], v[96:99], v[60:63], v[24:27]
    v_mov_b32 v11, s68
    s_add_u32 s85, s85, 12288
    v_mfma_f32_16x16x32_bf16 v[28:31], v[100:103], v[60:63], v[28:31]
    s_waitcnt vmcnt(11)
    s_mov_b64 exec, 15
    buffer_store_dword v11, v0, s[8:11], s85 offen sc1
    s_mov_b64 exec, -1
    buffer_load_dwordx4 v[60:63], v0, s[8:11], s93 offen offset:3072 sc1
    s_barrier
    s_waitcnt vmcnt(12)
    v_mfma_f32_16x16x32_bf16 v[88:91], v[112:115], v[64:67], 0
    ds_write_b128 v1, v[12:15] offset:0
    ds_write_b128 v1, v[16:19] offset:1024
    v_mfma_f32_16x16x32_bf16 v[92:95], v[116:119], v[64:67], 0
    ds_write_b128 v1, v[20:23] offset:2048
    ds_write_b128 v1, v[24:27] offset:3072
    v_mfma_f32_16x16x32_bf16 v[96:99], v[120:123], v[64:67], 0
    ds_write_b128 v1, v[28:31] offset:4096
    v_mfma_f32_16x16x32_bf16 v[100:103], v[124:127], v[64:67], 0
    v_mfma_f32_16x16x32_bf16 v[104:107], v[128:131], v[64:67], 0
    s_waitcnt vmcnt(11)
    v_mfma_f32_16x16x32_bf16 v[88:91], v[132:135], v[68:71], v[88:91]
    v_mfma_f32_16x16x32_bf16 v[92:95], v[136:139], v[68:71], v[92:95]
    v_mfma_f32_16x16x32_bf16 v[96:99], v[140:143], v[68:71], v[96:99]
    v_mfma_f32_16x16x32_bf16 v[100:103], v[144:147], v[68:71], v[100:103]
    v_mfma_f32_16x16x32_bf16 v[104:107], v[148:151], v[68:71], v[104:107]
    s_waitcnt vmcnt(10)
    v_mfma_f32_16x16x32_bf16 v[88:91], v[152:155], v[72:75], v[88:91]
    v_mfma_f32_16x16x32_bf16 v[92:95], v[156:159], v[72:75], v[92:95]
    v_mfma_f32_16x16x32_bf16 v[96:99], v[160:163], v[72:75], v[96:99]
    v_mfma_f32_16x16x32_bf16 v[100:103], v[164:167], v[72:75], v[100:103]
    v_mfma_f32_16x16x32_bf16 v[104:107], v[168:171], v[72:75], v[104:107]
    s_waitcnt vmcnt(9)
    v_mfma_f32_16x16x32_bf16 v[88:91], v[172:175], v[76:79], v[88:91]
    s_lshl_b32 s91, s63, 4
    s_add_u32 s91, s91, s62
    s_lshl_b32 s91, s91, 10
    s_add_u32 s91, s91, 35659776
    v_mfma_f32_16x16x32_bf16 v[92:95], v[176:179], v[76:79], v[92:95]
    buffer_load_dword v11, v0, s[8:11], s91 offen sc1
    ds_read_b64_tr_b16 v[64:65], v10 offset:10240
    v_mfma_f32_16x16x32_bf16 v[96:99], v[180:183], v[76:79], v[96:99]
    ds_read_b64_tr_b16 v[68:69], v10 offset:12288
    ds_read_b64_tr_b16 v[72:73], v10 offset:14336
    v_mfma_f32_16x16x32_bf16 v[100:103], v[184:187], v[76:79], v[100:103]
    v_mfma_f32_16x16x32_bf16 v[104:107], v[188:191], v[76:79], v[104:107]
    s_waitcnt vmcnt(9)
    v_mfma_f32_16x16x32_bf16 v[88:91], v[192:195], v[80:83], v[88:91]
    v_mfma_f32_16x16x32_bf16 v[92:95], v[196:199], v[80:83], v[92:95]
    v_mfma_f32_16x16x32_bf16 v[96:99], v[200:203], v[80:83], v[96:99]
    s_waitcnt lgkmcnt(2)
    v_and_b32 v67, s70, v65
    v_lshlrev_b32 v66, 16, v65
    v_mfma_f32_16x16x32_bf16 v[100:103], v[204:207], v[80:83], v[100:103]
    v_and_b32 v65, s70, v64
    v_lshlrev_b32 v64, 16, v64
    v_mfma_f32_16x16x32_bf16 v[104:107], v[208:211], v[80:83], v[104:107]
    s_waitcnt lgkmcnt(1)
    v_and_b32 v71, s70, v69
    s_waitcnt vmcnt(8)
    v_mfma_f32_16x16x32_bf16 v[88:91], v[212:215], v[84:87], v[88:91]
    v_lshlrev_b32 v70, 16, v69
    v_and_b32 v69, s70, v68
    v_mfma_f32_16x16x32_bf16 v[92:95], v[216:219], v[84:87], v[92:95]
    v_lshlrev_b32 v68, 16, v68
    s_waitcnt lgkmcnt(0)
    v_and_b32 v75, s70, v73
    v_mfma_f32_16x16x32_bf16 v[96:99], v[220:223], v[84:87], v[96:99]
    v_lshlrev_b32 v74, 16, v73
    v_and_b32 v73, s70, v72
    v_mfma_f32_16x16x32_bf16 v[100:103], v[224:227], v[84:87], v[100:103]
    v_lshlrev_b32 v72, 16, v72
    v_mfma_f32_16x16x32_bf16 v[104:107], v[228:231], v[84:87], v[104:107]
    s_waitcnt vmcnt(7)
    v_mfma_f32_16x16x32_bf16 v[88:91], v[232:235], v[40:43], v[88:91]
    v_mfma_f32_16x16x32_bf16 v[92:95], v[236:239], v[40:43], v[92:95]
    v_mfma_f32_16x16x32_bf16 v[96:99], v[240:243], v[40:43], v[96:99]
    v_mfma_f32_16x16x32_bf16 v[100:103], v[244:247], v[40:43], v[100:103]
    ds_read_b128 v[12:15], v9 offset:0
    v_mfma_f32_16x16x32_bf16 v[104:107], v[248:251], v[40:43], v[104:107]
    ds_read_b128 v[16:19], v9 offset:1024
    s_waitcnt vmcnt(6)
    v_mfma_f32_16x16x32_bf16 v[88:91], a[240:243], v[44:47], v[88:91]
    ds_read_b128 v[20:23], v9 offset:2048
    v_mfma_f32_16x16x32_bf16 v[92:95], a[244:247], v[44:47], v[92:95]
    ds_read_b128 v[24:27], v9 offset:3072
    v_mfma_f32_16x16x32_bf16 v[96:99], a[248:251], v[44:47], v[96:99]
    ds_read_b128 v[28:31], v9 offset:4096
    v_mfma_f32_16x16x32_bf16 v[100:103], a[252:255], v[44:47], v[100:103]
    ds_read_b128 v[32:35], v9 offset:5120
    v_mfma_f32_16x16x32_bf16 v[104:107], v[252:255], v[44:47], v[104:107]
    ds_read_b128 v[36:39], v9 offset:10240
    s_waitcnt vmcnt(5)
    s_waitcnt lgkmcnt(5)
    v_mfma_f32_16x16x32_bf16 v[88:91], v[12:15], v[48:51], v[88:91]
    ds_read_b128 v[108:111], v9 offset:15360
    v_mfma_f32_16x16x32_bf16 v[92:95], v[16:19], v[48:51], v[92:95]
    ds_read_b128 v[12:15], v9 offset:6144
    s_waitcnt lgkmcnt(5)
    v_mfma_f32_16x16x32_bf16 v[96:99], v[20:23], v[48:51], v[96:99]
    ds_read_b128 v[16:19], v9 offset:11264
    v_mfma_f32_16x16x32_bf16 v[100:103], v[24:27], v[48:51], v[100:103]
    ds_read_b128 v[20:23], v9 offset:16384
    s_waitcnt lgkmcnt(5)
    v_mfma_f32_16x16x32_bf16 v[104:107], v[28:31], v[48:51], v[104:107]
    ds_read_b128 v[24:27], v9 offset:7168
    s_waitcnt vmcnt(1)
    v_mfma_f32_16x16x32_bf16 v[88:91], v[32:35], v[52:55], v[88:91]
    ds_read_b128 v[28:31], v9 offset:12288
    s_waitcnt lgkmcnt(5)
    v_mfma_f32_16x16x32_bf16 v[88:91], v[36:39], v[56:59], v[88:91]
    ds_read_b128 v[32:35], v9 offset:17408
    v_mfma_f32_16x16x32_bf16 v[88:91], v[108:111], v[60:63], v[88:91]
    ds_read_b128 v[36:39], v9 offset:8192
    s_waitcnt lgkmcnt(5)
    v_mfma_f32_16x16x32_bf16 v[92:95], v[12:15], v[52:55], v[92:95]
    ds_read_b128 v[108:111], v9 offset:13312
    v_mfma_f32_16x16x32_bf16 v[92:95], v[16:19], v[56:59], v[92:95]
    ds_read_b128 v[12:15], v9 offset:18432
    s_waitcnt lgkmcnt(5)
    v_mfma_f32_16x16x32_bf16 v[92:95], v[20:23], v[60:63], v[92:95]
    ds_read_b128 v[16:19], v9 offset:9216
    v_mfma_f32_16x16x32_bf16 v[96:99], v[24:27], v[52:55], v[96:99]
    ds_read_b128 v[20:23], v9 offset:14336
    ds_write_b128 v1, v[88:91] offset:5120
    s_waitcnt lgkmcnt(6)
    v_mfma_f32_16x16x32_bf16 v[96:99], v[28:31], v[56:59], v[96:99]
    ds_read_b128 v[24:27], v9 offset:19456
    v_mfma_f32_16x16x32_bf16 v[96:99], v[32:35], v[60:63], v[96:99]
    s_waitcnt lgkmcnt(5)
    v_mfma_f32_16x16x32_bf16 v[100:103], v[36:39], v[52:55], v[100:103]
    ds_write_b128 v1, v[92:95] offset:6144
    v_mfma_f32_16x16x32_bf16 v[100:103], v[108:111], v[56:59], v[100:103]
    s_waitcnt lgkmcnt(4)
    v_mfma_f32_16x16x32_bf16 v[100:103], v[12:15], v[60:63], v[100:103]
    v_mfma_f32_16x16x32_bf16 v[104:107], v[16:19], v[52:55], v[104:107]
    s_nop 0
    ds_write_b128 v1, v[96:99] offset:7168
    s_waitcnt lgkmcnt(2)
    v_mfma_f32_16x16x32_bf16 v[104:107], v[20:23], v[56:59], v[104:107]
    v_mfma_f32_16x16x32_bf16 v[104:107], v[24:27], v[60:63], v[104:107]
    s_waitcnt vmcnt(0)
    v_cmp_ne_u32 vcc, s68, v11
    s_cbranch_vccz L_pd_26
L_pl_25:
    s_cmp_eq_u32 s72, 0
    s_cbranch_scc1 L_pd_26
    s_sub_u32 s72, s72, 1
    buffer_load_dword v11, v0, s[8:11], s91 offen sc1
    s_waitcnt vmcnt(0)
    v_cmp_ne_u32 vcc, s68, v11
    s_cbranch_vccnz L_pl_25
L_pd_26:
    s_add_u32 s93, s92, 3145728
    buffer_load_dwordx4 v[76:79], v0, s[8:11], s93 offen offset:0 sc1
    ds_write_b128 v1, v[100:103] offset:8192
    buffer_load_dwordx4 v[80:83], v0, s[8:11], s93 offen offset:1024 sc1
    ds_write_b128 v1, v[104:107] offset:9216
    buffer_load_dwordx4 v[84:87], v0, s[8:11], s93 offen offset:2048 sc1
    s_waitcnt lgkmcnt(0)
    s_barrier
    ds_read_b128 v[12:15], v8 offset:0
    ds_read_b128 v[16:19], v8 offset:2048
    s_mov_b64 exec, 0xffffffff
    ds_read_b128 v[20:23], v8 offset:4096
    s_mov_b64 exec, -1
    ds_read_b128 v[88:91], v8 offset:10240
    ds_read_b128 v[92:95], v8 offset:12288
    s_mov_b64 exec, 0xffffffff
    ds_read_b128 v[96:99], v8 offset:14336
    s_mov_b64 exec, -1
    buffer_load_dwordx4 v[40:43], v0, s[8:11], s93 offen offset:3072 sc1
    ds_read_b128 v[100:103], v8 offset:20480
    ds_read_b128 v[104:107], v8 offset:22528
    s_mov_b64 exec, 0xffffffff
    ds_read_b128 v[108:111], v8 offset:24576
    s_mov_b64 exec, -1
    ds_read_b128 v[24:27], v8 offset:30720
    ds_read_b128 v[28:31], v8 offset:32768
    s_mov_b64 exec, 0xffffffff
    ds_read_b128 v[32:35], v8 offset:34816
    s_mov_b64 exec, -1
    s_add_u32 s93, s92, 3149824
    buffer_load_dwordx4 v[44:47], v0, s[8:11], s93 offen offset:0 sc1
    s_waitcnt lgkmcnt(11)
    v_pk_add_f32 v[12:13], v[12:13], v[64:65]
    v_pk_add_f32 v[14:15], v[14:15], v[66:67]
    s_waitcnt lgkmcnt(10)
    v_pk_add_f32 v[16:17], v[16:17], v[68:69]
    v_pk_add_f32 v[18:19], v[18:19], v[70:71]
    s_waitcnt lgkmcnt(9)
    v_pk_add_f32 v[20:21], v[20:21], v[72:73]
    v_pk_add_f32 v[22:23], v[22:23], v[74:75]
    s_waitcnt lgkmcnt(8)
    v_pk_add_f32 v[12:13], v[12:13], v[88:89]
    v_pk_add_f32 v[14:15], v[14:15], v[90:91]
    buffer_load_dwordx4 v[48:51], v0, s[8:11], s93 offen offset:1024 sc1
    s_waitcnt lgkmcnt(7)
    v_pk_add_f32 v[16:17], v[16:17], v[92:93]
    v_pk_add_f32 v[18:19], v[18:19], v[94:95]
    s_waitcnt lgkmcnt(6)
    v_pk_add_f32 v[20:21], v[20:21], v[96:97]
    v_pk_add_f32 v[22:23], v[22:23], v[98:99]
    s_waitcnt lgkmcnt(5)
    v_pk_add_f32 v[12:13], v[12:13], v[100:101]
    v_pk_add_f32 v[14:15], v[14:15], v[102:103]
    s_waitcnt lgkmcnt(4)
    v_pk_add_f32 v[16:17], v[16:17], v[104:105]
    v_pk_add_f32 v[18:19], v[18:19], v[106:107]
    buffer_load_dwordx4 v[52:55], v0, s[8:11], s93 offen offset:2048 sc1
    s_waitcnt lgkmcnt(3)
    v_pk_add_f32 v[20:21], v[20:21], v[108:109]
    v_pk_add_f32 v[22:23], v[22:23], v[110:111]
    s_waitcnt lgkmcnt(2)
    v_pk_add_f32 v[12:13], v[12:13], v[24:25]
    v_pk_add_f32 v[14:15], v[14:15], v[26:27]
    s_waitcnt lgkmcnt(1)
    v_pk_add_f32 v[16:17], v[16:17], v[28:29]
    v_pk_add_f32 v[18:19], v[18:19], v[30:31]
    s_waitcnt lgkmcnt(0)
    v_pk_add_f32 v[20:21], v[20:21], v[32:33]
    v_pk_add_f32 v[22:23], v[22:23], v[34:35]
    s_lshl_b32 s91, s63, 4
    s_add_u32 s91, s91, s62
    s_lshl_b32 s91, s91, 10
    s_add_u32 s91, s91, 35663872
    buffer_load_dword v11, v0, s[8:11], s91 offen sc1
    v_cvt_pk_bf16_f32 v2, v12, v13
    v_cvt_pk_bf16_f32 v3, v14, v15
    v_cvt_pk_bf16_f32 v4, v16, v17
    v_cvt_pk_bf16_f32 v5, v18, v19
    v_cvt_pk_bf16_f32 v6, v20, v21
    v_cvt_pk_bf16_f32 v7, v22, v23
    s_mov_b32 s85, 0x3f803f80
    v_dot2_f32_bf16 v24, v2, s85, 0
    buffer_load_dwordx4 v[56:59], v0, s[8:11], s93 offen offset:3072 sc1
    v_dot2_f32_bf16 v25, v2, v2, 0
    v_dot2_f32_bf16 v24, v3, s85, v24
    v_dot2_f32_bf16 v25, v3, v3, v25
    v_dot2_f32_bf16 v24, v4, s85, v24
    v_dot2_f32_bf16 v25, v4, v4, v25
    v_dot2_f32_bf16 v24, v5, s85, v24
    v_dot2_f32_bf16 v25, v5, v5, v25
    s_mov_b64 exec, 0xffffffff
    v_dot2_f32_bf16 v24, v6, s85, v24
    v_dot2_f32_bf16 v25, v6, v6, v25
    v_dot2_f32_bf16 v24, v7, s85, v24
    v_dot2_f32_bf16 v25, v7, v7, v25
    s_mov_b64 exec, -1
    s_add_u32 s93, s92, 3153920
    buffer_load_dwordx4 v[60:63], v0, s[8:11], s93 offen offset:0 sc1
    v_lshrrev_b32 v27, 1, v0
    v_and_b32 v28, 0x38, v27
    v_bfe_u32 v27, v0, 8, 1
    v_add_f32_dpp v24, v24, v24 row_ror:8 row_mask:0xf bank_mask:0xf
    v_add_f32_dpp v25, v25, v25 row_ror:8 row_mask:0xf bank_mask:0xf
    v_lshl_add_u32 v28, v27, 6, v28
    v_and_b32 v27, 0x280, v0
    v_permlane16_swap_b32 v24, v25
    buffer_load_dwordx4 v[64:67], v0, s[8:11], s93 offen offset:1024 sc1
    v_lshl_add_u32 v28, v27, 20, v28
    v_add_f32 v24, v24, v25
    v_mov_b32 v25, v24
    s_lshl_b32 s85, s65, 7
    s_add_u32 s85, s94, s85
    v_permlane32_swap_b32 v24, v25
    v_add_f32 v24, v24, v25
    v_mov_b32 v25, s68
    buffer_load_dwordx4 v[68:71], v0, s[8:11], s93 offen offset:2048 sc1
    buffer_store_dwordx2 v[24:25], v28, s[8:11], s85 offen sc1
    buffer_load_dwordx4 v[72:75], v0, s[8:11], s93 offen offset:3072 sc1
    s_waitcnt vmcnt(13)
    v_mfma_f32_16x16x32_bf16 v[12:15], v[112:115], v[76:79], 0
    v_mfma_f32_16x16x32_bf16 v[16:19], v[116:119], v[76:79], 0
    v_mfma_f32_16x16x32_bf16 v[20:23], v[120:123], v[76:79], 0
    v_mfma_f32_16x16x32_bf16 v[24:27], v[124:127], v[76:79], 0
    v_mfma_f32_16x16x32_bf16 v[28:31], v[128:131], v[76:79], 0
    s_waitcnt vmcnt(12)
    v_mfma_f32_16x16x32_bf16 v[12:15], v[132:135], v[80:83], v[12:15]
    v_mfma_f32_16x16x32_bf16 v[16:19], v[136:139], v[80:83], v[16:19]
    v_mfma_f32_16x16x32_bf16 v[20:23], v[140:143], v[80:83], v[20:23]
    v_mfma_f32_16x16x32_bf16 v[24:27], v[144:147], v[80:83], v[24:27]
    v_mfma_f32_16x16x32_bf16 v[28:31], v[148:151], v[80:83], v[28:31]
    s_waitcnt vmcnt(6)
    v_cmp_ne_u32 vcc, s68, v11
    s_cbranch_vccz L_pd_28
L_pl_27:
    s_cmp_eq_u32 s72, 0
    s_cbranch_scc1 L_pd_28
    s_sub_u32 s72, s72, 1
    buffer_load_dword v11, v0, s[8:11], s91 offen sc1
    s_waitcnt vmcnt(0)
    v_cmp_ne_u32 vcc, s68, v11
    s_cbranch_vccnz L_pl_27
L_pd_28:
    v_mfma_f32_16x16x32_bf16 v[12:15], v[152:155], v[84:87], v[12:15]
    v_mfma_f32_16x16x32_bf16 v[16:19], v[156:159], v[84:87], v[16:19]
    s_add_u32 s93, s92, 3194880
    buffer_load_dwordx4 v[76:79], v0, s[8:11], s93 offen offset:0 sc1
    v_mfma_f32_16x16x32_bf16 v[20:23], v[160:163], v[84:87], v[20:23]
    v_mfma_f32_16x16x32_bf16 v[24:27], v[164:167], v[84:87], v[24:27]
    v_mfma_f32_16x16x32_bf16 v[28:31], v[168:171], v[84:87], v[28:31]
    v_mfma_f32_16x16x32_bf16 v[12:15], v[172:175], v[40:43], v[12:15]
    v_mfma_f32_16x16x32_bf16 v[16:19], v[176:179], v[40:43], v[16:19]
    buffer_load_dwordx4 v[80:83], v0, s[8:11], s93 offen offset:1024 sc1
    v_mfma_f32_16x16x32_bf16 v[20:23], v[180:183], v[40:43], v[20:23]
    v_mfma_f32_16x16x32_bf16 v[24:27], v[184:187], v[40:43], v[24:27]
    v_mfma_f32_16x16x32_bf16 v[28:31], v[188:191], v[40:43], v[28:31]
    v_mfma_f32_16x16x32_bf16 v[12:15], v[192:195], v[44:47], v[12:15]
    v_mfma_f32_16x16x32_bf16 v[16:19], v[196:199], v[44:47], v[16:19]
    buffer_load_dwordx4 v[84:87], v0, s[8:11], s93 offen offset:2048 sc1
    v_mfma_f32_16x16x32_bf16 v[20:23], v[200:203], v[44:47], v[20:23]
    v_mfma_f32_16x16x32_bf16 v[24:27], v[204:207], v[44:47], v[24:27]
    v_mfma_f32_16x16x32_bf16 v[28:31], v[208:211], v[44:47], v[28:31]
    v_mfma_f32_16x16x32_bf16 v[12:15], v[212:215], v[48:51], v[12:15]
    v_mfma_f32_16x16x32_bf16 v[16:19], v[216:219], v[48:51], v[16:19]
    buffer_load_dwordx4 v[40:43], v0, s[8:11], s93 offen offset:3072 sc1
    v_mfma_f32_16x16x32_bf16 v[20:23], v[220:223], v[48:51], v[20:23]
    v_mfma_f32_16x16x32_bf16 v[24:27], v[224:227], v[48:51], v[24:27]
    v_mfma_f32_16x16x32_bf16 v[28:31], v[228:231], v[48:51], v[28:31]
    v_mfma_f32_16x16x32_bf16 v[12:15], v[232:235], v[52:55], v[12:15]
    v_mfma_f32_16x16x32_bf16 v[16:19], v[236:239], v[52:55], v[16:19]
    s_add_u32 s93, s92, 3198976
    buffer_load_dwordx4 v[44:47], v0, s[8:11], s93 offen offset:0 sc1
    v_mfma_f32_16x16x32_bf16 v[20:23], v[240:243], v[52:55], v[20:23]
    v_mfma_f32_16x16x32_bf16 v[24:27], v[244:247], v[52:55], v[24:27]
    ds_read_b128 v[88:91], v9 offset:0
    v_mfma_f32_16x16x32_bf16 v[28:31], v[248:251], v[52:55], v[28:31]
    ds_read_b128 v[92:95], v9 offset:1024
    s_waitcnt vmcnt(10)
    v_mfma_f32_16x16x32_bf16 v[12:15], a[240:243], v[56:59], v[12:15]
    ds_read_b128 v[96:99], v9 offset:2048
    v_mfma_f32_16x16x32_bf16 v[16:19], a[244:247], v[56:59], v[16:19]
    ds_read_b128 v[100:103], v9 offset:3072
    buffer_load_dwordx4 v[48:51], v0, s[8:11], s93 offen offset:1024 sc1
    v_mfma_f32_16x16x32_bf16 v[20:23], a[248:251], v[56:59], v[20:23]
    ds_read_b128 v[104:107], v9 offset:4096
    v_mfma_f32_16x16x32_bf16 v[24:27], a[252:255], v[56:59], v[24:27]
    ds_read_b128 v[32:35], v9 offset:5120
    v_mfma_f32_16x16x32_bf16 v[28:31], v[252:255], v[56:59], v[28:31]
    ds_read_b128 v[36:39], v9 offset:6144
    s_waitcnt vmcnt(10)
    s_waitcnt lgkmcnt(5)
    v_mfma_f32_16x16x32_bf16 v[12:15], v[88:91], v[60:63], v[12:15]
    ds_read_b128 v[108:111], v9 offset:7168
    v_mfma_f32_16x16x32_bf16 v[16:19], v[92:95], v[60:63], v[16:19]
    ds_read_b128 v[88:91], v9 offset:8192
    buffer_load_dwordx4 v[52:55], v0, s[8:11], s93 offen offset:2048 sc1
    s_waitcnt lgkmcnt(5)
    v_mfma_f32_16x16x32_bf16 v[20:23], v[96:99], v[60:63], v[20:23]
    ds_read_b128 v[92:95], v9 offset:9216
    v_mfma_f32_16x16x32_bf16 v[24:27], v[100:103], v[60:63], v[24:27]
    ds_read_b128 v[96:99], v9 offset:10240
    s_waitcnt lgkmcnt(5)
    v_mfma_f32_16x16x32_bf16 v[28:31], v[104:107], v[60:63], v[28:31]
    ds_read_b128 v[100:103], v9 offset:11264
    s_waitcnt vmcnt(10)
    v_mfma_f32_16x16x32_bf16 v[12:15], v[32:35], v[64:67], v[12:15]
    ds_read_b128 v[104:107], v9 offset:12288
    s_waitcnt lgkmcnt(5)
    v_mfma_f32_16x16x32_bf16 v[16:19], v[36:39], v[64:67], v[16:19]
    ds_read_b128 v[32:35], v9 offset:13312
    buffer_load_dwordx4 v[56:59], v0, s[8:11], s93 offen offset:3072 sc1
    v_mfma_f32_16x16x32_bf16 v[20:23], v[108:111], v[64:67], v[20:23]
    ds_read_b128 v[36:39], v9 offset:14336
    s_waitcnt lgkmcnt(5)
    v_mfma_f32_16x16x32_bf16 v[24:27], v[88:91], v[64:67], v[24:27]
    ds_read_b128 v[108:111], v9 offset:15360
    v_mfma_f32_16x16x32_bf16 v[28:31], v[92:95], v[64:67], v[28:31]
    ds_read_b128 v[88:91], v9 offset:16384
    s_waitcnt vmcnt(10)
    s_waitcnt lgkmcnt(5)
    v_mfma_f32_16x16x32_bf16 v[12:15], v[96:99], v[68:71], v[12:15]
    ds_read_b128 v[92:95], v9 offset:17408
    v_mfma_f32_16x16x32_bf16 v[16:19], v[100:103], v[68:71], v[16:19]
    ds_read_b128 v[96:99], v9 offset:18432
    s_add_u32 s93, s92, 3203072
    buffer_load_dwordx4 v[60:63], v0, s[8:11], s93 offen offset:0 sc1
    s_waitcnt lgkmcnt(5)
    v_mfma_f32_16x16x32_bf16 v[20:23], v[104:107], v[68:71], v[20:23]
    ds_read_b128 v[100:103], v9 offset:19456
    v_mfma_f32_16x16x32_bf16 v[24:27], v[32:35], v[68:71], v[24:27]
    s_waitcnt lgkmcnt(4)
    v_mfma_f32_16x16x32_bf16 v[28:31], v[36:39], v[68:71], v[28:31]
    s_waitcnt vmcnt(9)
    v_mfma_f32_16x16x32_bf16 v[12:15], v[108:111], v[72:75], v[12:15]
    s_waitcnt lgkmcnt(2)
    v_mfma_f32_16x16x32_bf16 v[16:19], v[88:91], v[72:75], v[16:19]
    buffer_load_dwordx4 v[64:67], v0, s[8:11], s93 offen offset:1024 sc1
    v_mfma_f32_16x16x32_bf16 v[20:23], v[92:95], v[72:75], v[20:23]
    s_waitcnt lgkmcnt(0)
    v_mfma_f32_16x16x32_bf16 v[24:27], v[96:99], v[72:75], v[24:27]
    v_mfma_f32_16x16x32_bf16 v[28:31], v[100:103], v[72:75], v[28:31]
    buffer_load_dwordx4 v[68:71], v0, s[8:11], s93 offen offset:2048 sc1
    buffer_load_dwordx4 v[72:75], v0, s[8:11], s93 offen offset:3072 sc1
    s_barrier
    s_waitcnt vmcnt(11)
    v_mfma_f32_16x16x32_bf16 v[88:91], v[112:115], v[76:79], 0
    ds_write_b128 v1, v[12:15] offset:0
    ds_write_b128 v1, v[16:19] offset:1024
    v_mfma_f32_16x16x32_bf16 v[92:95], v[116:119], v[76:79], 0
    ds_write_b128 v1, v[20:23] offset:2048
    ds_write_b128 v1, v[24:27] offset:3072
    v_mfma_f32_16x16x32_bf16 v[96:99], v[120:123], v[76:79], 0
    ds_write_b128 v1, v[28:31] offset:4096
    v_mfma_f32_16x16x32_bf16 v[100:103], v[124:127], v[76:79], 0
    v_mfma_f32_16x16x32_bf16 v[104:107], v[128:131], v[76:79], 0
    s_waitcnt vmcnt(10)
    v_mfma_f32_16x16x32_bf16 v[88:91], v[132:135], v[80:83], v[88:91]
    v_mfma_f32_16x16x32_bf16 v[92:95], v[136:139], v[80:83], v[92:95]
    v_mfma_f32_16x16x32_bf16 v[96:99], v[140:143], v[80:83], v[96:99]
    v_mfma_f32_16x16x32_bf16 v[100:103], v[144:147], v[80:83], v[100:103]
    v_mfma_f32_16x16x32_bf16 v[104:107], v[148:151], v[80:83], v[104:107]
    s_waitcnt vmcnt(9)
    v_mfma_f32_16x16x32_bf16 v[88:91], v[152:155], v[84:87], v[88:91]
    v_bfe_u32 v11, v0, 4, 3
    v_lshlrev_b32 v11, 3, v11
    v_mfma_f32_16x16x32_bf16 v[92:95], v[156:159], v[84:87], v[92:95]
    s_mov_b32 s87, 0x380
    v_and_or_b32 v11, v0, s87, v11
    s_add_u32 s90, s94, 0
    v_mfma_f32_16x16x32_bf16 v[96:99], v[160:163], v[84:87], v[96:99]
    buffer_load_dwordx2 v[108:109], v11, s[8:11], s90 offen sc1
    v_mfma_f32_16x16x32_bf16 v[100:103], v[164:167], v[84:87], v[100:103]
    v_mfma_f32_16x16x32_bf16 v[104:107], v[168:171], v[84:87], v[104:107]
    buffer_load_dwordx2 v[110:111], v11, s[8:11], s90 offen offset:64 sc1
    s_waitcnt vmcnt(10)
    v_mfma_f32_16x16x32_bf16 v[88:91], v[172:175], v[40:43], v[88:91]
    ds_read_b64_tr_b16 v[76:77], v10 offset:15360
    ds_read_b64_tr_b16 v[80:81], v10 offset:17408
    v_mfma_f32_16x16x32_bf16 v[92:95], v[176:179], v[40:43], v[92:95]
    ds_read_b64_tr_b16 v[84:85], v10 offset:19456
    v_mfma_f32_16x16x32_bf16 v[96:99], v[180:183], v[40:43], v[96:99]
    v_mfma_f32_16x16x32_bf16 v[100:103], v[184:187], v[40:43], v[100:103]
    v_mfma_f32_16x16x32_bf16 v[104:107], v[188:191], v[40:43], v[104:107]
    s_waitcnt vmcnt(9)
    v_mfma_f32_16x16x32_bf16 v[88:91], v[192:195], v[44:47], v[88:91]
    v_mfma_f32_16x16x32_bf16 v[92:95], v[196:199], v[44:47], v[92:95]
    s_waitcnt lgkmcnt(2)
    v_and_b32 v79, s70, v77
    v_lshlrev_b32 v78, 16, v77
    v_mfma_f32_16x16x32_bf16 v[96:99], v[200:203], v[44:47], v[96:99]
    v_and_b32 v77, s70, v76
    v_lshlrev_b32 v76, 16, v76
    v_mfma_f32_16x16x32_bf16 v[100:103], v[204:207], v[44:47], v[100:103]
    s_waitcnt lgkmcnt(1)
    v_and_b32 v83, s70, v81
    v_lshlrev_b32 v82, 16, v81
    v_mfma_f32_16x16x32_bf16 v[104:107], v[208:211], v[44:47], v[104:107]
    v_and_b32 v81, s70, v80
    s_waitcnt vmcnt(8)
    v_mfma_f32_16x16x32_bf16 v[88:91], v[212:215], v[48:51], v[88:91]
    v_lshlrev_b32 v80, 16, v80
    s_waitcnt lgkmcnt(0)
    v_and_b32 v87, s70, v85
    v_mfma_f32_16x16x32_bf16 v[92:95], v[216:219], v[48:51], v[92:95]
    v_lshlrev_b32 v86, 16, v85
    v_and_b32 v85, s70, v84
    v_mfma_f32_16x16x32_bf16 v[96:99], v[220:223], v[48:51], v[96:99]
    v_lshlrev_b32 v84, 16, v84
    v_mfma_f32_16x16x32_bf16 v[100:103], v[224:227], v[48:51], v[100:103]
    v_mfma_f32_16x16x32_bf16 v[104:107], v[228:231], v[48:51], v[104:107]
    s_waitcnt vmcnt(7)
    v_mfma_f32_16x16x32_bf16 v[88:91], v[232:235], v[52:55], v[88:91]
    v_lshlrev_b32 v40, 16, v2
    v_and_b32 v41, s70, v2
    v_mfma_f32_16x16x32_bf16 v[92:95], v[236:239], v[52:55], v[92:95]
    v_lshlrev_b32 v42, 16, v3
    v_and_b32 v43, s70, v3
    v_mfma_f32_16x16x32_bf16 v[96:99], v[240:243], v[52:55], v[96:99]
    v_lshlrev_b32 v44, 16, v4
    v_and_b32 v45, s70, v4
    v_mfma_f32_16x16x32_bf16 v[100:103], v[244:247], v[52:55], v[100:103]
    v_lshlrev_b32 v46, 16, v5
    v_and_b32 v47, s70, v5
    v_mfma_f32_16x16x32_bf16 v[104:107], v[248:251], v[52:55], v[104:107]
    ds_read_b128 v[12:15], v9 offset:0
    s_waitcnt vmcnt(6)
    v_mfma_f32_16x16x32_bf16 v[88:91], a[240:243], v[56:59], v[88:91]
    ds_read_b128 v[16:19], v9 offset:1024
    v_lshlrev_b32 v48, 16, v6
    v_mfma_f32_16x16x32_bf16 v[92:95], a[244:247], v[56:59], v[92:95]
    ds_read_b128 v[20:23], v9 offset:2048
    v_and_b32 v49, s70, v6
    v_mfma_f32_16x16x32_bf16 v[96:99], a[248:251], v[56:59], v[96:99]
    ds_read_b128 v[24:27], v9 offset:3072
    v_lshlrev_b32 v50, 16, v7
    v_mfma_f32_16x16x32_bf16 v[100:103], a[252:255], v[56:59], v[100:103]
    ds_read_b128 v[28:31], v9 offset:4096
    v_and_b32 v51, s70, v7
    v_mfma_f32_16x16x32_bf16 v[104:107], v[252:255], v[56:59], v[104:107]
    ds_read_b128 v[32:35], v9 offset:5120
    s_waitcnt vmcnt(5)
    s_waitcnt lgkmcnt(4)
    v_mfma_f32_16x16x32_bf16 v[88:91], v[12:15], v[60:63], v[88:91]
    ds_read_b128 v[36:39], v9 offset:10240
    v_bfe_u32 v52, v0, 4, 3
    v_mfma_f32_16x16x32_bf16 v[92:95], v[16:19], v[60:63], v[92:95]
    ds_read_b128 v[12:15], v9 offset:15360
    s_waitcnt lgkmcnt(4)
    v_mfma_f32_16x16x32_bf16 v[96:99], v[20:23], v[60:63], v[96:99]
    ds_read_b128 v[16:19], v9 offset:6144
    v_mul_u32_u24 v52, 160, v52
    v_mfma_f32_16x16x32_bf16 v[100:103], v[24:27], v[60:63], v[100:103]
    ds_read_b128 v[20:23], v9 offset:11264
    s_waitcnt lgkmcnt(4)
    v_mfma_f32_16x16x32_bf16 v[104:107], v[28:31], v[60:63], v[104:107]
    ds_read_b128 v[24:27], v9 offset:16384
    s_waitcnt vmcnt(2)
    v_mfma_f32_16x16x32_bf16 v[88:91], v[32:35], v[64:67], v[88:91]
    ds_read_b128 v[28:31], v9 offset:7168
    s_waitcnt lgkmcnt(4)
    v_mfma_f32_16x16x32_bf16 v[88:91], v[36:39], v[68:71], v[88:91]
    ds_read_b128 v[32:35], v9 offset:12288
    v_lshrrev_b32 v53, 7, v0
    v_mfma_f32_16x16x32_bf16 v[88:91], v[12:15], v[72:75], v[88:91]
    ds_read_b128 v[36:39], v9 offset:17408
    s_waitcnt lgkmcnt(4)
    v_mfma_f32_16x16x32_bf16 v[92:95], v[16:19], v[64:67], v[92:95]
    ds_read_b128 v[12:15], v9 offset:8192
    v_lshl_add_u32 v52, v53, 3, v52
    v_mfma_f32_16x16x32_bf16 v[92:95], v[20:23], v[68:71], v[92:95]
    ds_read_b128 v[16:19], v9 offset:13312
    s_waitcnt lgkmcnt(4)
    v_mfma_f32_16x16x32_bf16 v[92:95], v[24:27], v[72:75], v[92:95]
    ds_read_b128 v[20:23], v9 offset:18432
    s_mul_i32 s86, s62, 1280
    s_add_u32 s86, s86, 61440
    v_mfma_f32_16x16x32_bf16 v[96:99], v[28:31], v[64:67], v[96:99]
    ds_read_b128 v[24:27], v9 offset:9216
    ds_write_b128 v1, v[88:91] offset:5120
    s_waitcnt lgkmcnt(5)
    v_mfma_f32_16x16x32_bf16 v[96:99], v[32:35], v[68:71], v[96:99]
    ds_read_b128 v[28:31], v9 offset:14336
    v_add_u32 v52, s86, v52
    v_mfma_f32_16x16x32_bf16 v[96:99], v[36:39], v[72:75], v[96:99]
    ds_read_b128 v[32:35], v9 offset:19456
    s_waitcnt lgkmcnt(5)
    v_mfma_f32_16x16x32_bf16 v[100:103], v[12:15], v[64:67], v[100:103]
    ds_write_b128 v1, v[92:95] offset:6144
    v_mfma_f32_16x16x32_bf16 v[100:103], v[16:19], v[68:71], v[100:103]
    v_lshrrev_b32 v53, 1, v0
    s_waitcnt lgkmcnt(4)
    v_mfma_f32_16x16x32_bf16 v[100:103], v[20:23], v[72:75], v[100:103]
    v_mov_b32 v54, 0
    v_mov_b32 v55, 0
    v_mfma_f32_16x16x32_bf16 v[104:107], v[24:27], v[64:67], v[104:107]
    ds_write_b128 v1, v[96:99] offset:7168
    s_waitcnt lgkmcnt(2)
    v_mfma_f32_16x16x32_bf16 v[104:107], v[28:31], v[68:71], v[104:107]
    s_lshl_b32 s88, s63, 12
    s_lshl_b32 s86, s66, 11
    s_add_u32 s88, s88, s86
    s_lshl_b32 s86, s62, 9
    v_mfma_f32_16x16x32_bf16 v[104:107], v[32:35], v[72:75], v[104:107]
    s_add_u32 s88, s88, s86
    s_lshl_b32 s86, s65, 6
    s_add_u32 s88, s88, s86
    s_add_u32 s88, s88, 29229056
    s_add_u32 s87, s99, 13107200
    ds_read_b64_tr_b16 v[64:65], v10 offset:0
    ds_read_b64_tr_b16 v[68:69], v10 offset:2048
    ds_read_b64_tr_b16 v[72:73], v10 offset:4096
    s_waitcnt vmcnt(1)
    v_cmp_ne_u32 vcc, s68, v109
    s_waitcnt vmcnt(0)
    v_cmp_ne_u32 s[84:85], s68, v111
    s_nop 0
    s_or_b64 vcc, vcc, s[84:85]
    s_cbranch_vccz L_ed_30
L_el_29:
    s_cmp_eq_u32 s72, 0
    s_cbranch_scc1 L_ed_30
    s_sub_u32 s72, s72, 1
    buffer_load_dwordx2 v[108:109], v11, s[8:11], s90 offen sc1
    buffer_load_dwordx2 v[110:111], v11, s[8:11], s90 offen offset:64 sc1
    s_waitcnt vmcnt(0)
    v_cmp_ne_u32 vcc, s68, v109
    v_cmp_ne_u32 s[84:85], s68, v111
    s_nop 0
    s_or_b64 vcc, vcc, s[84:85]
    s_cbranch_vccnz L_el_29
L_ed_30:
    v_add_f32_dpp v108, v108, v108 row_ror:8 row_mask:0xf bank_mask:0xf
    v_add_f32_dpp v110, v110, v110 row_ror:8 row_mask:0xf bank_mask:0xf
    ds_write_b128 v1, v[100:103] offset:8192
    s_nop 0
    v_permlane16_swap_b32 v108, v110
    v_add_f32 v108, v108, v110
    v_mov_b32 v110, v108
    ds_write_b128 v1, v[104:107] offset:9216
    s_nop 0
    v_permlane32_swap_b32 v108, v110
    v_add_f32 v108, v108, v110
    v_mov_b32 v110, v108
    s_nop 1
    v_permlane16_swap_b32 v108, v110
    v_mul_f32 v108, 0xbacccccd, v108
    v_mov_b32 v109, 0x3727c5ac
    v_fmac_f32 v109, 0x3acccccd, v110
    v_fma_f32 v109, -v108, v108, v109
    v_max_f32 v109, 0x3727c5ac, v109
    v_rsq_f32 v110, v109
    s_waitcnt lgkmcnt(4)
    v_and_b32 v67, s70, v65
    v_lshlrev_b32 v66, 16, v65
    v_and_b32 v65, s70, v64
    v_lshlrev_b32 v64, 16, v64
    s_waitcnt lgkmcnt(3)
    v_and_b32 v71, s70, v69
    v_lshlrev_b32 v70, 16, v69
    v_and_b32 v69, s70, v68
    v_lshlrev_b32 v68, 16, v68
    s_waitcnt lgkmcnt(2)
    v_and_b32 v75, s70, v73
    v_lshlrev_b32 v74, 16, v73
    v_and_b32 v73, s70, v72
    v_lshlrev_b32 v72, 16, v72
    v_pk_add_f32 v[12:13], v[40:41], v[108:109] op_sel_hi:[1,0]
    v_pk_add_f32 v[14:15], v[42:43], v[108:109] op_sel_hi:[1,0]
    v_pk_add_f32 v[16:17], v[44:45], v[108:109] op_sel_hi:[1,0]
    v_pk_add_f32 v[18:19], v[46:47], v[108:109] op_sel_hi:[1,0]
    v_pk_add_f32 v[20:21], v[48:49], v[108:109] op_sel_hi:[1,0]
    v_pk_add_f32 v[22:23], v[50:51], v[108:109] op_sel_hi:[1,0]
    v_pk_mul_f32 v[64:65], v[64:65], v[110:111] op_sel_hi:[1,0]
    v_pk_mul_f32 v[66:67], v[66:67], v[110:111] op_sel_hi:[1,0]
    v_pk_mul_f32 v[68:69], v[68:69], v[110:111] op_sel_hi:[1,0]
    v_pk_mul_f32 v[70:71], v[70:71], v[110:111] op_sel_hi:[1,0]
    v_pk_mul_f32 v[72:73], v[72:73], v[110:111] op_sel_hi:[1,0]
    v_pk_mul_f32 v[74:75], v[74:75], v[110:111] op_sel_hi:[1,0]
    v_pk_fma_f32 v[40:41], v[12:13], v[64:65], v[40:41]
    v_pk_fma_f32 v[42:43], v[14:15], v[66:67], v[42:43]
    v_cvt_pk_bf16_f32 v24, v40, v41
    v_cvt_pk_bf16_f32 v25, v42, v43
    buffer_store_dwordx2 v[24:25], v11, s[8:11], s87 offen offset:0 sc1
    v_pk_fma_f32 v[44:45], v[16:17], v[68:69], v[44:45]
    v_pk_fma_f32 v[46:47], v[18:19], v[70:71], v[46:47]
    v_cvt_pk_bf16_f32 v26, v44, v45
    v_cvt_pk_bf16_f32 v27, v46, v47
    buffer_store_dwordx2 v[26:27], v11, s[8:11], s87 offen offset:1024 sc1
    v_pk_fma_f32 v[48:49], v[20:21], v[72:73], v[48:49]
    v_pk_fma_f32 v[50:51], v[22:23], v[74:75], v[50:51]
    v_cvt_pk_bf16_f32 v28, v48, v49
    v_cvt_pk_bf16_f32 v29, v50, v51
    s_mov_b64 exec, 0xffffffff
    buffer_store_dwordx2 v[28:29], v11, s[8:11], s87 offen offset:2048 sc1
    s_mov_b32 s85, 0x3f803f80
    ds_write_b64 v52, v[28:29] offset:128
    v_dot2_f32_bf16 v54, v28, s85, v54
    v_dot2_f32_bf16 v55, v28, v28, v55
    v_dot2_f32_bf16 v54, v29, s85, v54
    v_dot2_f32_bf16 v55, v29, v29, v55
    s_mov_b64 exec, -1
    v_dot2_f32_bf16 v54, v24, s85, v54
    v_dot2_f32_bf16 v55, v24, v24, v55
    v_dot2_f32_bf16 v54, v25, s85, v54
    v_dot2_f32_bf16 v55, v25, v25, v55
    v_dot2_f32_bf16 v54, v26, s85, v54
    v_dot2_f32_bf16 v55, v26, v26, v55
    v_dot2_f32_bf16 v54, v27, s85, v54
    v_dot2_f32_bf16 v55, v27, v27, v55
    ds_write_b64 v52, v[24:25] offset:0
    ds_write_b64 v52, v[26:27] offset:64
    v_add_f32_dpp v54, v54, v54 row_ror:8 row_mask:0xf bank_mask:0xf
    v_add_f32_dpp v55, v55, v55 row_ror:8 row_mask:0xf bank_mask:0xf
    s_nop 1
    v_permlane16_swap_b32 v54, v55
    v_add_f32 v54, v54, v55
    v_mov_b32 v55, v54
    s_nop 1
    v_permlane32_swap_b32 v54, v55
    v_add_f32 v54, v54, v55
    v_mov_b32 v55, v54
    s_nop 1
    v_permlane16_swap_b32 v54, v55
    s_mov_b64 exec, 0xff
    buffer_store_dwordx2 v[54:55], v53, s[8:11], s88 offen sc1
    s_mov_b64 exec, -1
    s_waitcnt lgkmcnt(0)
    s_barrier
    ds_read_b128 v[12:15], v8 offset:0
    ds_read_b128 v[16:19], v8 offset:2048
    s_mov_b64 exec, 0xffffffff
    ds_read_b128 v[20:23], v8 offset:4096
    s_mov_b64 exec, -1
    ds_read_b128 v[88:91], v8 offset:10240
    ds_read_b128 v[92:95], v8 offset:12288
    s_mov_b64 exec, 0xffffffff
    ds_read_b128 v[96:99], v8 offset:14336
    s_mov_b64 exec, -1
    ds_read_b128 v[100:103], v8 offset:20480
    ds_read_b128 v[104:107], v8 offset:22528
    s_mov_b64 exec, 0xffffffff
    ds_read_b128 v[108:111], v8 offset:24576
    s_mov_b64 exec, -1
    ds_read_b128 v[24:27], v8 offset:30720
    ds_read_b128 v[28:31], v8 offset:32768
    s_mov_b64 exec, 0xffffffff
    ds_read_b128 v[32:35], v8 offset:34816
    s_mov_b64 exec, -1
    s_waitcnt lgkmcnt(11)
    v_pk_add_f32 v[12:13], v[12:13], v[76:77]
    v_pk_add_f32 v[14:15], v[14:15], v[78:79]
    s_waitcnt lgkmcnt(10)
    v_pk_add_f32 v[16:17], v[16:17], v[80:81]
    v_pk_add_f32 v[18:19], v[18:19], v[82:83]
    s_waitcnt lgkmcnt(9)
    v_pk_add_f32 v[20:21], v[20:21], v[84:85]
    v_pk_add_f32 v[22:23], v[22:23], v[86:87]
    s_waitcnt lgkmcnt(8)
    v_pk_add_f32 v[12:13], v[12:13], v[88:89]
    v_pk_add_f32 v[14:15], v[14:15], v[90:91]
    s_waitcnt lgkmcnt(7)
    v_pk_add_f32 v[16:17], v[16:17], v[92:93]
    v_pk_add_f32 v[18:19], v[18:19], v[94:95]
    s_waitcnt lgkmcnt(6)
    v_pk_add_f32 v[20:21], v[20:21], v[96:97]
    v_pk_add_f32 v[22:23], v[22:23], v[98:99]
    s_waitcnt lgkmcnt(5)
    v_pk_add_f32 v[12:13], v[12:13], v[100:101]
    v_pk_add_f32 v[14:15], v[14:15], v[102:103]
    s_waitcnt lgkmcnt(4)
    v_pk_add_f32 v[16:17], v[16:17], v[104:105]
    v_pk_add_f32 v[18:19], v[18:19], v[106:107]
    s_waitcnt lgkmcnt(3)
    v_pk_add_f32 v[20:21], v[20:21], v[108:109]
    v_pk_add_f32 v[22:23], v[22:23], v[110:111]
    s_waitcnt lgkmcnt(2)
    v_pk_add_f32 v[12:13], v[12:13], v[24:25]
    v_pk_add_f32 v[14:15], v[14:15], v[26:27]
    s_waitcnt lgkmcnt(1)
    v_pk_add_f32 v[16:17], v[16:17], v[28:29]
    v_pk_add_f32 v[18:19], v[18:19], v[30:31]
    s_waitcnt lgkmcnt(0)
    v_pk_add_f32 v[20:21], v[20:21], v[32:33]
    v_pk_add_f32 v[22:23], v[22:23], v[34:35]
    v_cvt_pk_bf16_f32 v56, v12, v13
    v_cvt_pk_bf16_f32 v57, v14, v15
    v_cvt_pk_bf16_f32 v58, v16, v17
    v_cvt_pk_bf16_f32 v59, v18, v19
    v_cvt_pk_bf16_f32 v60, v20, v21
    v_cvt_pk_bf16_f32 v61, v22, v23
    s_mov_b32 s85, 0x3f803f80
    v_dot2_f32_bf16 v24, v56, s85, 0
    v_dot2_f32_bf16 v25, v56, v56, 0
    v_dot2_f32_bf16 v24, v57, s85, v24
    v_dot2_f32_bf16 v25, v57, v57, v25
    v_dot2_f32_bf16 v24, v58, s85, v24
    v_dot2_f32_bf16 v25, v58, v58, v25
    v_dot2_f32_bf16 v24, v59, s85, v24
    v_dot2_f32_bf16 v25, v59, v59, v25
    s_mov_b64 exec, 0xffffffff
    v_dot2_f32_bf16 v24, v60, s85, v24
    v_dot2_f32_bf16 v25, v60, v60, v25
    v_dot2_f32_bf16 v24, v61, s85, v24
    v_dot2_f32_bf16 v25, v61, v61, v25
    s_mov_b64 exec, -1
    v_lshrrev_b32 v27, 1, v0
    v_and_b32 v28, 0x38, v27
    v_bfe_u32 v27, v0, 8, 1
    v_add_f32_dpp v24, v24, v24 row_ror:8 row_mask:0xf bank_mask:0xf
    v_add_f32_dpp v25, v25, v25 row_ror:8 row_mask:0xf bank_mask:0xf
    v_lshl_add_u32 v28, v27, 6, v28
    v_and_b32 v27, 0x280, v0
    v_permlane16_swap_b32 v24, v25
    v_lshl_add_u32 v28, v27, 20, v28
    v_add_f32 v24, v24, v25
    v_mov_b32 v25, v24
    s_lshl_b32 s85, s65, 7
    s_add_u32 s85, s94, s85
    v_permlane32_swap_b32 v24, v25
    s_add_u32 s85, s85, 8192
    v_add_f32 v24, v24, v25
    v_mov_b32 v25, s68
    buffer_store_dwordx2 v[24:25], v28, s[8:11], s85 offen sc1
    s_waitcnt vmcnt(1)
    s_barrier
    s_lshl_b32 s85, s63, 11
    s_lshl_b32 s86, s64, 6
    s_add_u32 s85, s85, s86
    s_add_u32 s85, s85, 28508160
    v_mov_b32 v11, s68
    s_add_u32 s85, s85, s83
    s_mov_b64 exec, 15
    buffer_store_dword v11, v0, s[8:11], s85 offen sc1
    s_mov_b64 exec, -1
    s_lshl_b32 s91, s3, 11
    s_add_u32 s91, s91, 28508160
    v_bfe_u32 v8, v0, 4, 3
    v_lshlrev_b32 v8, 3, v8
    s_mov_b32 s87, 0x380
    v_and_or_b32 v8, v0, s87, v8
    s_add_u32 s90, s94, 8192
    s_getpc_b64 s[86:87]
L_pc_31:
    s_lshr_b32 s85, s2, 3
    s_lshl_b32 s85, s85, 2
    s_add_u32 s85, s85, s62
    s_mul_i32 s85, s85, 192
    v_lshl_add_u32 v12, v0, 2, s85
    v_min_u32 v12, L_exit-L_layer1-4, v12
    v_add_u32 v12, L_layer1-L_pc_31, v12
    v_ashrrev_i32 v13, 31, v12
    v_mov_b32 v14, s87
    v_add_co_u32 v12, vcc, s86, v12
    s_nop 1
    v_addc_co_u32 v13, vcc, v14, v13, vcc
    s_mov_b64 exec, 7
    global_load_dword v14, v[12:13], off
    s_mov_b64 exec, -1
    v_mov_b32 v5, v0
    s_lshr_b32 s84, s62, 1
    s_mul_i32 s84, s84, 40960
    s_mul_i32 s85, s69, 5120
    s_add_u32 s84, s84, s85
    s_mul_i32 s73, s3, 81920
    s_add_u32 s73, s73, s84
    s_add_u32 s73, s73, 13107200
    s_mul_i32 s97, s62, 5120
    s_lshr_b32 s84, s62, 1
    v_lshrrev_b32 v13, 1, v0
    s_mul_i32 s85, s84, 10240
    v_add_u32 v1, s85, v13
    s_sub_u32 s85, 10240, s85
    v_add_u32 v3, s85, v13
    s_mul_i32 s85, s69, 1024
    s_sub_u32 s86, 1024, s85
    v_add_u32 v2, s86, v1
    v_add_u32 v1, s85, v1
    v_add_u32 v4, s86, v3
    v_add_u32 v3, s85, v3
    v_bfe_u32 v13, v0, 4, 3
    v_lshlrev_b32 v13, 3, v13
    v_bfe_u32 v11, v0, 7, 1
    v_lshl_add_u32 v13, v11, 9, v13
    v_lshrrev_b32 v11, 8, v0
    v_lshl_add_u32 v13, v11, 7, v13
    s_lshl_b32 s85, s84, 11
    v_add_u32 v6, s85, v13
    v_xor_b32 v7, 2048, v6
    ds_read_b64_tr_b16 v[64:65], v10 offset:5120
    ds_read_b64_tr_b16 v[68:69], v10 offset:7168
    ds_read_b64_tr_b16 v[72:73], v10 offset:9216
    v_lshlrev_b32 v40, 16, v56
    v_and_b32 v41, s70, v56
    v_lshlrev_b32 v42, 16, v57
    v_and_b32 v43, s70, v57
    v_lshlrev_b32 v44, 16, v58
    v_and_b32 v45, s70, v58
    v_lshlrev_b32 v46, 16, v59
    v_and_b32 v47, s70, v59
    v_lshlrev_b32 v48, 16, v60
    v_and_b32 v49, s70, v60
    v_lshlrev_b32 v50, 16, v61
    v_and_b32 v51, s70, v61
    v_bfe_u32 v52, v0, 4, 3
    v_mul_u32_u24 v52, 160, v52
    v_lshrrev_b32 v53, 7, v0
    v_lshl_add_u32 v52, v53, 3, v52
    s_mul_i32 s86, s62, 1280
    s_add_u32 s86, s86, 66560
    v_add_u32 v52, s86, v52
    v_lshrrev_b32 v53, 1, v0
    v_mov_b32 v54, 0
    v_mov_b32 v55, 0
    s_lshl_b32 s88, s63, 12
    s_lshl_b32 s86, s66, 11
    s_add_u32 s88, s88, s86
    s_lshl_b32 s86, s62, 9
    s_add_u32 s88, s88, s86
    s_lshl_b32 s86, s65, 6
    s_add_u32 s88, s88, s86
    s_add_u32 s88, s88, 29294592
    s_add_u32 s87, s99, 14417920
    s_waitcnt lgkmcnt(2)
    v_and_b32 v67, s70, v65
    v_lshlrev_b32 v66, 16, v65
    v_and_b32 v65, s70, v64
    v_lshlrev_b32 v64, 16, v64
    s_waitcnt lgkmcnt(1)
    v_and_b32 v71, s70, v69
    v_lshlrev_b32 v70, 16, v69
    v_and_b32 v69, s70, v68
    v_lshlrev_b32 v68, 16, v68
    s_waitcnt lgkmcnt(0)
    v_and_b32 v75, s70, v73
    v_lshlrev_b32 v74, 16, v73
    v_and_b32 v73, s70, v72
    v_lshlrev_b32 v72, 16, v72
    s_cmp_lg_u32 s62, 0
    s_cbranch_scc1 L_f1_32
    buffer_load_dword v11, v0, s[8:11], s91 offen sc1
    s_waitcnt vmcnt(0)
    v_cmp_ne_u32 vcc, s68, v11
    s_cbranch_vccz L_pd_34
L_pl_33:
    s_cmp_eq_u32 s72, 0
    s_cbranch_scc1 L_pd_34
    s_sub_u32 s72, s72, 1
    buffer_load_dword v11, v0, s[8:11], s91 offen sc1
    s_waitcnt vmcnt(0)
    v_cmp_ne_u32 vcc, s68, v11
    s_cbranch_vccnz L_pl_33
L_pd_34:
L_f1_32:
    s_barrier
    buffer_load_dwordx2 v[108:109], v8, s[8:11], s90 offen sc1
    buffer_load_dwordx2 v[110:111], v8, s[8:11], s90 offen offset:64 sc1
    s_add_u32 m0, s97, 0
    s_add_u32 s84, s73, 0
    buffer_load_dwordx4 v5, s[8:11], s84 offen offset:0 sc1 lds
    buffer_load_dwordx4 v5, s[8:11], s84 offen offset:1024 sc1 lds
    s_waitcnt vmcnt(3)
    v_cmp_ne_u32 vcc, s68, v109
    s_waitcnt vmcnt(2)
    v_cmp_ne_u32 s[84:85], s68, v111
    s_nop 0
    s_or_b64 vcc, vcc, s[84:85]
    s_cbranch_vccz L_ed_36
L_el_35:
    s_cmp_eq_u32 s72, 0
    s_cbranch_scc1 L_ed_36
    s_sub_u32 s72, s72, 1
    buffer_load_dwordx2 v[108:109], v8, s[8:11], s90 offen sc1
    buffer_load_dwordx2 v[110:111], v8, s[8:11], s90 offen offset:64 sc1
    s_waitcnt vmcnt(0)
    v_cmp_ne_u32 vcc, s68, v109
    v_cmp_ne_u32 s[84:85], s68, v111
    s_nop 0
    s_or_b64 vcc, vcc, s[84:85]
    s_cbranch_vccnz L_el_35
L_ed_36:
    v_add_f32_dpp v108, v108, v108 row_ror:8 row_mask:0xf bank_mask:0xf
    v_add_f32_dpp v110, v110, v110 row_ror:8 row_mask:0xf bank_mask:0xf
    s_nop 1
    v_permlane16_swap_b32 v108, v110
    v_add_f32 v108, v108, v110
    s_add_u32 m0, s97, 0
    s_add_u32 s84, s73, 0
    buffer_load_dwordx4 v5, s[8:11], s84 offen offset:2048 sc1 lds
    v_mov_b32 v110, v108
    s_nop 1
    v_permlane32_swap_b32 v108, v110
    v_add_f32 v108, v108, v110
    v_mov_b32 v110, v108
    buffer_load_dwordx4 v5, s[8:11], s84 offen offset:3072 sc1 lds
    s_nop 1
    v_permlane16_swap_b32 v108, v110
    v_mul_f32 v108, 0xbacccccd, v108
    v_mov_b32 v109, 0x3727c5ac
    v_fmac_f32 v109, 0x3acccccd, v110
    s_add_u32 m0, s97, 4096
    s_add_u32 s84, s73, 4096
    buffer_load_dwordx4 v5, s[8:11], s84 offen sc1 lds
    v_fma_f32 v109, -v108, v108, v109
    v_max_f32 v109, 0x3727c5ac, v109
    v_rsq_f32 v110, v109
    v_pk_add_f32 v[12:13], v[40:41], v[108:109] op_sel_hi:[1,0]
    v_pk_add_f32 v[14:15], v[42:43], v[108:109] op_sel_hi:[1,0]
    s_add_u32 m0, s97, 20480
    s_add_u32 s84, s73, 10240
    buffer_load_dwordx4 v5, s[8:11], s84 offen offset:0 sc1 lds
    v_pk_add_f32 v[16:17], v[44:45], v[108:109] op_sel_hi:[1,0]
    v_pk_add_f32 v[18:19], v[46:47], v[108:109] op_sel_hi:[1,0]
    v_pk_add_f32 v[20:21], v[48:49], v[108:109] op_sel_hi:[1,0]
    v_pk_add_f32 v[22:23], v[50:51], v[108:109] op_sel_hi:[1,0]
    v_pk_mul_f32 v[64:65], v[64:65], v[110:111] op_sel_hi:[1,0]
    buffer_load_dwordx4 v5, s[8:11], s84 offen offset:1024 sc1 lds
    v_pk_mul_f32 v[66:67], v[66:67], v[110:111] op_sel_hi:[1,0]
    v_pk_mul_f32 v[68:69], v[68:69], v[110:111] op_sel_hi:[1,0]
    v_pk_mul_f32 v[70:71], v[70:71], v[110:111] op_sel_hi:[1,0]
    v_pk_mul_f32 v[72:73], v[72:73], v[110:111] op_sel_hi:[1,0]
    v_pk_mul_f32 v[74:75], v[74:75], v[110:111] op_sel_hi:[1,0]
    buffer_load_dwordx4 v5, s[8:11], s84 offen offset:2048 sc1 lds
    v_pk_fma_f32 v[40:41], v[12:13], v[64:65], v[40:41]
    v_pk_fma_f32 v[42:43], v[14:15], v[66:67], v[42:43]
    v_cvt_pk_bf16_f32 v24, v40, v41
    v_cvt_pk_bf16_f32 v25, v42, v43
    buffer_store_dwordx2 v[24:25], v8, s[8:11], s87 offen offset:0 sc1
    buffer_load_dwordx4 v5, s[8:11], s84 offen offset:3072 sc1 lds
    v_pk_fma_f32 v[44:45], v[16:17], v[68:69], v[44:45]
    v_pk_fma_f32 v[46:47], v[18:19], v[70:71], v[46:47]
    v_cvt_pk_bf16_f32 v26, v44, v45
    v_cvt_pk_bf16_f32 v27, v46, v47
    buffer_store_dwordx2 v[26:27], v8, s[8:11], s87 offen offset:1024 sc1
    s_add_u32 m0, s97, 24576
    s_add_u32 s84, s73, 14336
    buffer_load_dwordx4 v5, s[8:11], s84 offen sc1 lds
    v_pk_fma_f32 v[48:49], v[20:21], v[72:73], v[48:49]
    v_pk_fma_f32 v[50:51], v[22:23], v[74:75], v[50:51]
    v_cvt_pk_bf16_f32 v28, v48, v49
    v_cvt_pk_bf16_f32 v29, v50, v51
    s_mov_b64 exec, 0xffffffff
    buffer_store_dwordx2 v[28:29], v8, s[8:11], s87 offen offset:2048 sc1
    s_mov_b32 s85, 0x3f803f80
    ds_write_b64 v52, v[28:29] offset:128
    v_dot2_f32_bf16 v54, v28, s85, v54
    v_dot2_f32_bf16 v55, v28, v28, v55
    v_dot2_f32_bf16 v54, v29, s85, v54
    v_dot2_f32_bf16 v55, v29, v29, v55
    s_mov_b64 exec, -1
    v_dot2_f32_bf16 v54, v24, s85, v54
    v_dot2_f32_bf16 v55, v24, v24, v55
    v_dot2_f32_bf16 v54, v25, s85, v54
    v_dot2_f32_bf16 v55, v25, v25, v55
    v_dot2_f32_bf16 v54, v26, s85, v54
    v_dot2_f32_bf16 v55, v26, v26, v55
    v_dot2_f32_bf16 v54, v27, s85, v54
    v_dot2_f32_bf16 v55, v27, v27, v55
    ds_write_b64 v52, v[24:25] offset:0
    ds_write_b64 v52, v[26:27] offset:64
    v_add_f32_dpp v54, v54, v54 row_ror:8 row_mask:0xf bank_mask:0xf
    v_add_f32_dpp v55, v55, v55 row_ror:8 row_mask:0xf bank_mask:0xf
    s_nop 1
    v_permlane16_swap_b32 v54, v55
    v_add_f32 v54, v54, v55
    v_mov_b32 v55, v54
    s_nop 1
    v_permlane32_swap_b32 v54, v55
    v_add_f32 v54, v54, v55
    v_mov_b32 v55, v54
    s_nop 1
    v_permlane16_swap_b32 v54, v55
    s_mov_b64 exec, 0xff
    buffer_store_dwordx2 v[54:55], v53, s[8:11], s88 offen sc1
    s_mov_b64 exec, -1
L_layer1:
    s_lshr_b32 s84, s62, 1
    s_lshl_b32 s90, s3, 12
    s_add_u32 s90, s90, 29229056
    v_lshrrev_b32 v13, 9, v0
    v_xor_b32 v13, s84, v13
    s_mov_b32 s85, 98304
    v_mul_lo_u32 v8, v13, s85
    v_and_b32 v13, 0x1f0, v0
    s_mul_i32 s85, s1, 3072
    s_lshl_b32 s86, s62, 9
    s_add_u32 s85, s85, s86
    v_add3_u32 v8, v8, v13, s85
    s_mul_i32 s74, s3, 196608
    s_add_u32 s74, s74, 22020096
    s_lshl_b32 s75, s3, 14
    s_add_u32 s75, s75, 35913728
    v_lshrrev_b32 v10, 8, v0
    v_lshlrev_b32 v10, 4, v10
    s_mul_i32 s88, s62, 192
    s_add_u32 s88, s88, 73728
    v_add_u32 v10, s88, v10
    s_waitcnt vmcnt(9) lgkmcnt(0)
    s_barrier
    ds_read2st64_b64 v[40:43], v1 offset0:0 offset1:1
    ds_read2st64_b64 v[44:47], v3 offset0:0 offset1:1
    ds_read2st64_b64 v[48:51], v1 offset0:4 offset1:5
    ds_read2st64_b64 v[52:55], v3 offset0:4 offset1:5
    s_waitcnt lgkmcnt(2)
    v_mfma_f32_16x16x32_bf16 v[64:67], a[0:3], v[40:43], 0
    ds_read2st64_b64 v[56:59], v1 offset0:8 offset1:9
    ds_read2st64_b64 v[60:63], v3 offset0:8 offset1:9
    v_mfma_f32_16x16x32_bf16 v[76:79], a[0:3], v[44:47], 0
    s_add_u32 m0, s97, 40960
    s_add_u32 s84, s73, 20480
    buffer_load_dwordx4 v5, s[8:11], s84 offen offset:0 sc1 lds
    v_mfma_f32_16x16x32_bf16 v[80:83], a[4:7], v[44:47], 0
    v_mfma_f32_16x16x32_bf16 v[68:71], a[4:7], v[40:43], 0
    v_mfma_f32_16x16x32_bf16 v[72:75], a[8:11], v[40:43], 0
    v_mfma_f32_16x16x32_bf16 v[84:87], a[8:11], v[44:47], 0
    buffer_load_dwordx4 v5, s[8:11], s84 offen offset:1024 sc1 lds
    s_waitcnt lgkmcnt(2)
    v_mfma_f32_16x16x32_bf16 v[64:67], a[12:15], v[48:51], v[64:67]
    ds_read2st64_b64 v[40:43], v1 offset0:12 offset1:13
    ds_read2st64_b64 v[44:47], v3 offset0:12 offset1:13
    v_mfma_f32_16x16x32_bf16 v[76:79], a[12:15], v[52:55], v[76:79]
    v_mfma_f32_16x16x32_bf16 v[80:83], a[16:19], v[52:55], v[80:83]
    v_mfma_f32_16x16x32_bf16 v[68:71], a[16:19], v[48:51], v[68:71]
    v_mfma_f32_16x16x32_bf16 v[72:75], a[20:23], v[48:51], v[72:75]
    buffer_load_dwordx4 v5, s[8:11], s84 offen offset:2048 sc1 lds
    v_mfma_f32_16x16x32_bf16 v[84:87], a[20:23], v[52:55], v[84:87]
    s_waitcnt lgkmcnt(2)
    v_mfma_f32_16x16x32_bf16 v[64:67], a[24:27], v[56:59], v[64:67]
    ds_read2st64_b64 v[48:51], v1 offset0:16 offset1:17
    ds_read2st64_b64 v[52:55], v3 offset0:16 offset1:17
    v_mfma_f32_16x16x32_bf16 v[76:79], a[24:27], v[60:63], v[76:79]
    v_mfma_f32_16x16x32_bf16 v[80:83], a[28:31], v[60:63], v[80:83]
    buffer_load_dwordx4 v5, s[8:11], s84 offen offset:3072 sc1 lds
    s_add_u32 m0, s97, 45056
    s_add_u32 s84, s73, 24576
    v_mfma_f32_16x16x32_bf16 v[68:71], a[28:31], v[56:59], v[68:71]
    v_mfma_f32_16x16x32_bf16 v[72:75], a[32:35], v[56:59], v[72:75]
    v_mfma_f32_16x16x32_bf16 v[84:87], a[32:35], v[60:63], v[84:87]
    s_waitcnt lgkmcnt(2)
    v_mfma_f32_16x16x32_bf16 v[64:67], a[36:39], v[40:43], v[64:67]
    ds_read2st64_b64 v[56:59], v2 offset0:0 offset1:1
    ds_read2st64_b64 v[60:63], v4 offset0:0 offset1:1
    v_mfma_f32_16x16x32_bf16 v[76:79], a[36:39], v[44:47], v[76:79]
    buffer_load_dwordx4 v5, s[8:11], s84 offen sc1 lds
    s_add_u32 s89, s90, 0
    v_mfma_f32_16x16x32_bf16 v[80:83], a[40:43], v[44:47], v[80:83]
    v_mfma_f32_16x16x32_bf16 v[68:71], a[40:43], v[40:43], v[68:71]
    v_mfma_f32_16x16x32_bf16 v[72:75], a[44:47], v[40:43], v[72:75]
    v_mfma_f32_16x16x32_bf16 v[84:87], a[44:47], v[44:47], v[84:87]
    buffer_load_dwordx2 v[16:17], v6, s[8:11], s89 offen offset:0 sc1
    s_waitcnt lgkmcnt(2)
    v_mfma_f32_16x16x32_bf16 v[64:67], a[48:51], v[48:51], v[64:67]
    ds_read2st64_b64 v[40:43], v2 offset0:4 offset1:5
    ds_read2st64_b64 v[44:47], v4 offset0:4 offset1:5
    v_mfma_f32_16x16x32_bf16 v[76:79], a[48:51], v[52:55], v[76:79]
    v_mfma_f32_16x16x32_bf16 v[80:83], a[52:55], v[52:55], v[80:83]
    buffer_load_dwordx2 v[18:19], v6, s[8:11], s89 offen offset:64 sc1
    v_mfma_f32_16x16x32_bf16 v[68:71], a[52:55], v[48:51], v[68:71]
    v_mfma_f32_16x16x32_bf16 v[72:75], a[56:59], v[48:51], v[72:75]
    buffer_load_dwordx2 v[20:21], v7, s[8:11], s89 offen offset:0 sc1
    v_mfma_f32_16x16x32_bf16 v[84:87], a[56:59], v[52:55], v[84:87]
    s_waitcnt lgkmcnt(2)
    v_mfma_f32_16x16x32_bf16 v[64:67], a[60:63], v[56:59], v[64:67]
    ds_read2st64_b64 v[48:51], v2 offset0:8 offset1:9
    ds_read2st64_b64 v[52:55], v4 offset0:8 offset1:9
    v_mfma_f32_16x16x32_bf16 v[76:79], a[60:63], v[60:63], v[76:79]
    buffer_load_dwordx2 v[22:23], v7, s[8:11], s89 offen offset:64 sc1
    v_mfma_f32_16x16x32_bf16 v[80:83], a[64:67], v[60:63], v[80:83]
    v_mfma_f32_16x16x32_bf16 v[68:71], a[64:67], v[56:59], v[68:71]
    v_mfma_f32_16x16x32_bf16 v[72:75], a[68:71], v[56:59], v[72:75]
    v_mfma_f32_16x16x32_bf16 v[84:87], a[68:71], v[60:63], v[84:87]
    s_waitcnt lgkmcnt(2)
    v_mfma_f32_16x16x32_bf16 v[64:67], a[72:75], v[40:43], v[64:67]
    ds_read2st64_b64 v[56:59], v2 offset0:12 offset1:13
    ds_read2st64_b64 v[60:63], v4 offset0:12 offset1:13
    v_mfma_f32_16x16x32_bf16 v[76:79], a[72:75], v[44:47], v[76:79]
    v_mfma_f32_16x16x32_bf16 v[80:83], a[76:79], v[44:47], v[80:83]
    v_mfma_f32_16x16x32_bf16 v[68:71], a[76:79], v[40:43], v[68:71]
    v_mfma_f32_16x16x32_bf16 v[72:75], a[80:83], v[40:43], v[72:75]
    v_mfma_f32_16x16x32_bf16 v[84:87], a[80:83], v[44:47], v[84:87]
    s_waitcnt lgkmcnt(2)
    v_mfma_f32_16x16x32_bf16 v[64:67], a[84:87], v[48:51], v[64:67]
    ds_read2st64_b64 v[40:43], v2 offset0:16 offset1:17
    ds_read2st64_b64 v[44:47], v4 offset0:16 offset1:17
    v_mfma_f32_16x16x32_bf16 v[76:79], a[84:87], v[52:55], v[76:79]
    v_mfma_f32_16x16x32_bf16 v[80:83], a[88:91], v[52:55], v[80:83]
    v_mfma_f32_16x16x32_bf16 v[68:71], a[88:91], v[48:51], v[68:71]
    v_mfma_f32_16x16x32_bf16 v[72:75], a[92:95], v[48:51], v[72:75]
    v_mfma_f32_16x16x32_bf16 v[84:87], a[92:95], v[52:55], v[84:87]
    s_waitcnt lgkmcnt(2)
    v_mfma_f32_16x16x32_bf16 v[64:67], a[96:99], v[56:59], v[64:67]
    v_mfma_f32_16x16x32_bf16 v[76:79], a[96:99], v[60:63], v[76:79]
    v_mfma_f32_16x16x32_bf16 v[80:83], a[100:103], v[60:63], v[80:83]
    s_waitcnt vmcnt(9) lgkmcnt(0)
    s_barrier
    v_mfma_f32_16x16x32_bf16 v[68:71], a[100:103], v[56:59], v[68:71]
    ds_read2st64_b64 v[48:51], v1 offset0:40 offset1:41
    s_lshl_b32 s85, s63, 11
    s_lshl_b32 s86, s64, 6
    v_mfma_f32_16x16x32_bf16 v[72:75], a[104:107], v[56:59], v[72:75]
    ds_read2st64_b64 v[52:55], v3 offset0:40 offset1:41
    s_add_u32 s85, s85, s86
    s_add_u32 s85, s85, 28509184
    v_mfma_f32_16x16x32_bf16 v[84:87], a[104:107], v[60:63], v[84:87]
    v_mfma_f32_16x16x32_bf16 v[64:67], a[108:111], v[40:43], v[64:67]
    ds_read2st64_b64 v[56:59], v1 offset0:44 offset1:45
    ds_read2st64_b64 v[60:63], v3 offset0:44 offset1:45
    v_mfma_f32_16x16x32_bf16 v[76:79], a[108:111], v[44:47], v[76:79]
    v_mov_b32 v11, s68
    s_add_u32 s85, s85, s83
    v_mfma_f32_16x16x32_bf16 v[80:83], a[112:115], v[44:47], v[80:83]
    s_mov_b64 exec, 15
    buffer_store_dword v11, v0, s[8:11], s85 offen sc1
    s_mov_b64 exec, -1
    v_mfma_f32_16x16x32_bf16 v[68:71], a[112:115], v[40:43], v[68:71]
    v_mfma_f32_16x16x32_bf16 v[72:75], a[116:119], v[40:43], v[72:75]
    v_mfma_f32_16x16x32_bf16 v[84:87], a[116:119], v[44:47], v[84:87]
    s_waitcnt lgkmcnt(2)
    v_mfma_f32_16x16x32_bf16 v[64:67], a[120:123], v[48:51], v[64:67]
    ds_read2st64_b64 v[40:43], v1 offset0:48 offset1:49
    ds_read2st64_b64 v[44:47], v3 offset0:48 offset1:49
    v_mfma_f32_16x16x32_bf16 v[76:79], a[120:123], v[52:55], v[76:79]
    s_add_u32 m0, s97, 0
    s_add_u32 s84, s73, 30720
    buffer_load_dwordx4 v5, s[8:11], s84 offen offset:0 sc1 lds
    v_mfma_f32_16x16x32_bf16 v[80:83], a[124:127], v[52:55], v[80:83]
    v_mfma_f32_16x16x32_bf16 v[68:71], a[124:127], v[48:51], v[68:71]
    v_mfma_f32_16x16x32_bf16 v[72:75], a[128:131], v[48:51], v[72:75]
    v_mfma_f32_16x16x32_bf16 v[84:87], a[128:131], v[52:55], v[84:87]
    buffer_load_dwordx4 v5, s[8:11], s84 offen offset:1024 sc1 lds
    s_waitcnt lgkmcnt(2)
    v_mfma_f32_16x16x32_bf16 v[64:67], a[132:135], v[56:59], v[64:67]
    ds_read2st64_b64 v[48:51], v1 offset0:52 offset1:53
    ds_read2st64_b64 v[52:55], v3 offset0:52 offset1:53
    v_mfma_f32_16x16x32_bf16 v[76:79], a[132:135], v[60:63], v[76:79]
    v_mfma_f32_16x16x32_bf16 v[80:83], a[136:139], v[60:63], v[80:83]
    v_mfma_f32_16x16x32_bf16 v[68:71], a[136:139], v[56:59], v[68:71]
    v_mfma_f32_16x16x32_bf16 v[72:75], a[140:143], v[56:59], v[72:75]
    buffer_load_dwordx4 v5, s[8:11], s84 offen offset:2048 sc1 lds
    v_mfma_f32_16x16x32_bf16 v[84:87], a[140:143], v[60:63], v[84:87]
    s_waitcnt lgkmcnt(2)
    v_mfma_f32_16x16x32_bf16 v[64:67], a[144:147], v[40:43], v[64:67]
    ds_read2st64_b64 v[56:59], v1 offset0:56 offset1:57
    ds_read2st64_b64 v[60:63], v3 offset0:56 offset1:57
    v_mfma_f32_16x16x32_bf16 v[76:79], a[144:147], v[44:47], v[76:79]
    v_mfma_f32_16x16x32_bf16 v[80:83], a[148:151], v[44:47], v[80:83]
    buffer_load_dwordx4 v5, s[8:11], s84 offen offset:3072 sc1 lds
    s_add_u32 m0, s97, 4096
    s_add_u32 s84, s73, 34816
    v_mfma_f32_16x16x32_bf16 v[68:71], a[148:151], v[40:43], v[68:71]
    v_mfma_f32_16x16x32_bf16 v[72:75], a[152:155], v[40:43], v[72:75]
    v_mfma_f32_16x16x32_bf16 v[84:87], a[152:155], v[44:47], v[84:87]
    s_waitcnt lgkmcnt(2)
    v_mfma_f32_16x16x32_bf16 v[64:67], a[156:159], v[48:51], v[64:67]
    ds_read2st64_b64 v[40:43], v2 offset0:40 offset1:41
    ds_read2st64_b64 v[44:47], v4 offset0:40 offset1:41
    v_mfma_f32_16x16x32_bf16 v[76:79], a[156:159], v[52:55], v[76:79]
    buffer_load_dwordx4 v5, s[8:11], s84 offen sc1 lds
    v_mfma_f32_16x16x32_bf16 v[80:83], a[160:163], v[52:55], v[80:83]
    v_mfma_f32_16x16x32_bf16 v[68:71], a[160:163], v[48:51], v[68:71]
    v_mfma_f32_16x16x32_bf16 v[72:75], a[164:167], v[48:51], v[72:75]
    v_mfma_f32_16x16x32_bf16 v[84:87], a[164:167], v[52:55], v[84:87]
    s_waitcnt lgkmcnt(2)
    v_mfma_f32_16x16x32_bf16 v[64:67], a[168:171], v[56:59], v[64:67]
    ds_read2st64_b64 v[48:51], v2 offset0:44 offset1:45
    ds_read2st64_b64 v[52:55], v4 offset0:44 offset1:45
    v_mfma_f32_16x16x32_bf16 v[76:79], a[168:171], v[60:63], v[76:79]
    v_mfma_f32_16x16x32_bf16 v[80:83], a[172:175], v[60:63], v[80:83]
    v_mfma_f32_16x16x32_bf16 v[68:71], a[172:175], v[56:59], v[68:71]
    v_mfma_f32_16x16x32_bf16 v[72:75], a[176:179], v[56:59], v[72:75]
    v_mfma_f32_16x16x32_bf16 v[84:87], a[176:179], v[60:63], v[84:87]
    s_waitcnt lgkmcnt(2)
    v_mfma_f32_16x16x32_bf16 v[64:67], a[180:183], v[40:43], v[64:67]
    ds_read2st64_b64 v[56:59], v2 offset0:48 offset1:49
    ds_read2st64_b64 v[60:63], v4 offset0:48 offset1:49
    v_mfma_f32_16x16x32_bf16 v[76:79], a[180:183], v[44:47], v[76:79]
    v_mfma_f32_16x16x32_bf16 v[80:83], a[184:187], v[44:47], v[80:83]
    v_mfma_f32_16x16x32_bf16 v[68:71], a[184:187], v[40:43], v[68:71]
    v_mfma_f32_16x16x32_bf16 v[72:75], a[188:191], v[40:43], v[72:75]
    v_mfma_f32_16x16x32_bf16 v[84:87], a[188:191], v[44:47], v[84:87]
    s_waitcnt lgkmcnt(2)
    v_mfma_f32_16x16x32_bf16 v[64:67], a[192:195], v[48:51], v[64:67]
    ds_read2st64_b64 v[40:43], v2 offset0:52 offset1:53
    ds_read2st64_b64 v[44:47], v4 offset0:52 offset1:53
    v_mfma_f32_16x16x32_bf16 v[76:79], a[192:195], v[52:55], v[76:79]
    v_mfma_f32_16x16x32_bf16 v[80:83], a[196:199], v[52:55], v[80:83]
    v_mfma_f32_16x16x32_bf16 v[68:71], a[196:199], v[48:51], v[68:71]
    v_mfma_f32_16x16x32_bf16 v[72:75], a[200:203], v[48:51], v[72:75]
    v_mfma_f32_16x16x32_bf16 v[84:87], a[200:203], v[52:55], v[84:87]
    s_waitcnt lgkmcnt(2)
    v_mfma_f32_16x16x32_bf16 v[64:67], a[204:207], v[56:59], v[64:67]
    ds_read2st64_b64 v[48:51], v2 offset0:56 offset1:57
    ds_read2st64_b64 v[52:55], v4 offset0:56 offset1:57
    v_mfma_f32_16x16x32_bf16 v[76:79], a[204:207], v[60:63], v[76:79]
    v_mfma_f32_16x16x32_bf16 v[80:83], a[208:211], v[60:63], v[80:83]
    v_mfma_f32_16x16x32_bf16 v[68:71], a[208:211], v[56:59], v[68:71]
    v_mfma_f32_16x16x32_bf16 v[72:75], a[212:215], v[56:59], v[72:75]
    v_mfma_f32_16x16x32_bf16 v[84:87], a[212:215], v[60:63], v[84:87]
    s_waitcnt lgkmcnt(2)
    v_mfma_f32_16x16x32_bf16 v[64:67], a[216:219], v[40:43], v[64:67]
    v_mfma_f32_16x16x32_bf16 v[76:79], a[216:219], v[44:47], v[76:79]
    v_mfma_f32_16x16x32_bf16 v[80:83], a[220:223], v[44:47], v[80:83]
    s_waitcnt vmcnt(10) lgkmcnt(0)
    s_barrier
    v_mfma_f32_16x16x32_bf16 v[68:71], a[220:223], v[40:43], v[68:71]
    ds_read2st64_b64 v[56:59], v1 offset0:80 offset1:81
    v_mfma_f32_16x16x32_bf16 v[72:75], a[224:227], v[40:43], v[72:75]
    ds_read2st64_b64 v[60:63], v3 offset0:80 offset1:81
    v_mfma_f32_16x16x32_bf16 v[84:87], a[224:227], v[44:47], v[84:87]
    v_mfma_f32_16x16x32_bf16 v[64:67], a[228:231], v[48:51], v[64:67]
    ds_read2st64_b64 v[40:43], v1 offset0:84 offset1:85
    ds_read2st64_b64 v[44:47], v3 offset0:84 offset1:85
    v_mfma_f32_16x16x32_bf16 v[76:79], a[228:231], v[52:55], v[76:79]
    v_mfma_f32_16x16x32_bf16 v[80:83], a[232:235], v[52:55], v[80:83]
    v_mfma_f32_16x16x32_bf16 v[68:71], a[232:235], v[48:51], v[68:71]
    v_mfma_f32_16x16x32_bf16 v[72:75], a[236:239], v[48:51], v[72:75]
    v_mfma_f32_16x16x32_bf16 v[84:87], a[236:239], v[52:55], v[84:87]
    s_waitcnt lgkmcnt(2)
    v_mfma_f32_16x16x32_bf16 v[88:91], a[0:3], v[56:59], 0
    ds_read2st64_b64 v[48:51], v1 offset0:88 offset1:89
    ds_read2st64_b64 v[52:55], v3 offset0:88 offset1:89
    v_mfma_f32_16x16x32_bf16 v[100:103], a[0:3], v[60:63], 0
    ds_read_b128 v[28:31], v10 offset:0
    ds_read_b128 v[32:35], v10 offset:64
    v_mfma_f32_16x16x32_bf16 v[104:107], a[4:7], v[60:63], 0
    ds_read_b128 v[36:39], v10 offset:128
    s_waitcnt vmcnt(8)
    v_add_f32 v16, v16, v18
    v_mfma_f32_16x16x32_bf16 v[92:95], a[4:7], v[56:59], 0
    v_add_f32 v17, v17, v19
    s_waitcnt vmcnt(6)
    v_add_f32 v20, v20, v22
    v_mfma_f32_16x16x32_bf16 v[96:99], a[8:11], v[56:59], 0
    v_add_f32 v21, v21, v23
    v_permlane16_swap_b32 v16, v17
    v_mfma_f32_16x16x32_bf16 v[108:111], a[8:11], v[60:63], 0
    v_permlane16_swap_b32 v20, v21
    s_waitcnt lgkmcnt(5)
    v_mfma_f32_16x16x32_bf16 v[88:91], a[12:15], v[40:43], v[88:91]
    ds_read2st64_b64 v[56:59], v1 offset0:92 offset1:93
    ds_read2st64_b64 v[60:63], v3 offset0:92 offset1:93
    v_mfma_f32_16x16x32_bf16 v[100:103], a[12:15], v[44:47], v[100:103]
    s_lshl_b32 s91, s3, 11
    s_add_u32 s91, s91, 28509184
    buffer_load_dword v11, v0, s[8:11], s91 offen sc1
    v_mfma_f32_16x16x32_bf16 v[104:107], a[16:19], v[44:47], v[104:107]
    v_add_f32 v16, v16, v17
    v_mov_b32 v17, v16
    v_mfma_f32_16x16x32_bf16 v[92:95], a[16:19], v[40:43], v[92:95]
    v_add_f32 v20, v20, v21
    v_mov_b32 v21, v20
    v_mfma_f32_16x16x32_bf16 v[96:99], a[20:23], v[40:43], v[96:99]
    v_permlane32_swap_b32 v16, v17
    v_mfma_f32_16x16x32_bf16 v[108:111], a[20:23], v[44:47], v[108:111]
    v_permlane32_swap_b32 v20, v21
    s_waitcnt lgkmcnt(5)
    v_mfma_f32_16x16x32_bf16 v[88:91], a[24:27], v[48:51], v[88:91]
    ds_read2st64_b64 v[40:43], v1 offset0:96 offset1:97
    ds_read2st64_b64 v[44:47], v3 offset0:96 offset1:97
    v_mfma_f32_16x16x32_bf16 v[100:103], a[24:27], v[52:55], v[100:103]
    v_add_f32 v16, v16, v17
    v_mov_b32 v17, v16
    v_mfma_f32_16x16x32_bf16 v[104:107], a[28:31], v[52:55], v[104:107]
    v_add_f32 v20, v20, v21
    v_mov_b32 v21, v20
    v_mfma_f32_16x16x32_bf16 v[92:95], a[28:31], v[48:51], v[92:95]
    v_permlane16_swap_b32 v16, v17
    v_mfma_f32_16x16x32_bf16 v[96:99], a[32:35], v[48:51], v[96:99]
    v_permlane16_swap_b32 v20, v21
    v_mfma_f32_16x16x32_bf16 v[108:111], a[32:35], v[52:55], v[108:111]
    v_mul_f32 v24, 0xbacccccd, v16
    s_waitcnt lgkmcnt(2)
    v_mfma_f32_16x16x32_bf16 v[88:91], a[36:39], v[56:59], v[88:91]
    ds_read2st64_b64 v[48:51], v2 offset0:80 offset1:81
    ds_read2st64_b64 v[52:55], v4 offset0:80 offset1:81
    v_mfma_f32_16x16x32_bf16 v[100:103], a[36:39], v[60:63], v[100:103]
    v_mov_b32 v26, 0x3727c5ac
    v_fmac_f32 v26, 0x3acccccd, v17
    v_mfma_f32_16x16x32_bf16 v[104:107], a[40:43], v[60:63], v[104:107]
    v_mul_f32 v25, 0xbacccccd, v20
    v_mov_b32 v27, 0x3727c5ac
    v_mfma_f32_16x16x32_bf16 v[92:95], a[40:43], v[56:59], v[92:95]
    v_fmac_f32 v27, 0x3acccccd, v21
    s_add_u32 s89, s90, 1024
    v_mfma_f32_16x16x32_bf16 v[96:99], a[44:47], v[56:59], v[96:99]
    buffer_load_dwordx2 v[16:17], v6, s[8:11], s89 offen offset:0 sc1
    v_mfma_f32_16x16x32_bf16 v[108:111], a[44:47], v[60:63], v[108:111]
    s_waitcnt lgkmcnt(2)
    v_mfma_f32_16x16x32_bf16 v[88:91], a[48:51], v[40:43], v[88:91]
    ds_read2st64_b64 v[56:59], v2 offset0:84 offset1:85
    ds_read2st64_b64 v[60:63], v4 offset0:84 offset1:85
    v_mfma_f32_16x16x32_bf16 v[100:103], a[48:51], v[44:47], v[100:103]
    buffer_load_dwordx2 v[18:19], v6, s[8:11], s89 offen offset:64 sc1
    v_mfma_f32_16x16x32_bf16 v[104:107], a[52:55], v[44:47], v[104:107]
    v_mfma_f32_16x16x32_bf16 v[92:95], a[52:55], v[40:43], v[92:95]
    buffer_load_dwordx2 v[20:21], v7, s[8:11], s89 offen offset:0 sc1
    v_mfma_f32_16x16x32_bf16 v[96:99], a[56:59], v[40:43], v[96:99]
    v_mfma_f32_16x16x32_bf16 v[108:111], a[56:59], v[44:47], v[108:111]
    buffer_load_dwordx2 v[22:23], v7, s[8:11], s89 offen offset:64 sc1
    s_waitcnt lgkmcnt(2)
    v_mfma_f32_16x16x32_bf16 v[88:91], a[60:63], v[48:51], v[88:91]
    ds_read2st64_b64 v[40:43], v2 offset0:88 offset1:89
    ds_read2st64_b64 v[44:47], v4 offset0:88 offset1:89
    v_mfma_f32_16x16x32_bf16 v[100:103], a[60:63], v[52:55], v[100:103]
    v_fma_f32 v26, -v24, v24, v26
    v_max_f32 v26, 0x3727c5ac, v26
    v_mfma_f32_16x16x32_bf16 v[104:107], a[64:67], v[52:55], v[104:107]
    v_fma_f32 v27, -v25, v25, v27
    v_max_f32 v27, 0x3727c5ac, v27
    v_mfma_f32_16x16x32_bf16 v[92:95], a[64:67], v[48:51], v[92:95]
    v_rcp_f32 v26, v26
    v_mfma_f32_16x16x32_bf16 v[96:99], a[68:71], v[48:51], v[96:99]
    v_rcp_f32 v27, v27
    v_mfma_f32_16x16x32_bf16 v[108:111], a[68:71], v[52:55], v[108:111]
    v_fmac_f32 v64, v24, v28
    s_waitcnt lgkmcnt(2)
    v_mfma_f32_16x16x32_bf16 v[88:91], a[72:75], v[56:59], v[88:91]
    ds_read2st64_b64 v[48:51], v2 offset0:92 offset1:93
    ds_read2st64_b64 v[52:55], v4 offset0:92 offset1:93
    v_mfma_f32_16x16x32_bf16 v[100:103], a[72:75], v[60:63], v[100:103]
    v_fmac_f32 v65, v24, v29
    v_fmac_f32 v66, v24, v30
    v_mfma_f32_16x16x32_bf16 v[104:107], a[76:79], v[60:63], v[104:107]
    v_fmac_f32 v67, v24, v31
    v_fmac_f32 v68, v24, v32
    v_mfma_f32_16x16x32_bf16 v[92:95], a[76:79], v[56:59], v[92:95]
    v_fmac_f32 v69, v24, v33
    v_fmac_f32 v70, v24, v34
    v_mfma_f32_16x16x32_bf16 v[96:99], a[80:83], v[56:59], v[96:99]
    v_fmac_f32 v71, v24, v35
    v_fmac_f32 v72, v24, v36
    v_mfma_f32_16x16x32_bf16 v[108:111], a[80:83], v[60:63], v[108:111]
    v_fmac_f32 v73, v24, v37
    s_waitcnt lgkmcnt(2)
    v_mfma_f32_16x16x32_bf16 v[88:91], a[84:87], v[40:43], v[88:91]
    ds_read2st64_b64 v[56:59], v2 offset0:96 offset1:97
    ds_read2st64_b64 v[60:63], v4 offset0:96 offset1:97
    v_mfma_f32_16x16x32_bf16 v[100:103], a[84:87], v[44:47], v[100:103]
    v_fmac_f32 v74, v24, v38
    v_fmac_f32 v75, v24, v39
    v_mfma_f32_16x16x32_bf16 v[104:107], a[88:91], v[44:47], v[104:107]
    v_fmac_f32 v76, v25, v28
    v_fmac_f32 v77, v25, v29
    v_mfma_f32_16x16x32_bf16 v[92:95], a[88:91], v[40:43], v[92:95]
    v_fmac_f32 v78, v25, v30
    v_fmac_f32 v79, v25, v31
    v_mfma_f32_16x16x32_bf16 v[96:99], a[92:95], v[40:43], v[96:99]
    v_fmac_f32 v80, v25, v32
    v_fmac_f32 v81, v25, v33
    v_mfma_f32_16x16x32_bf16 v[108:111], a[92:95], v[44:47], v[108:111]
    v_fmac_f32 v82, v25, v34
    s_waitcnt lgkmcnt(2)
    v_mfma_f32_16x16x32_bf16 v[88:91], a[96:99], v[48:51], v[88:91]
    v_fmac_f32 v83, v25, v35
    v_fmac_f32 v84, v25, v36
    v_mfma_f32_16x16x32_bf16 v[100:103], a[96:99], v[52:55], v[100:103]
    v_fmac_f32 v85, v25, v37
    v_fmac_f32 v86, v25, v38
    v_mfma_f32_16x16x32_bf16 v[104:107], a[100:103], v[52:55], v[104:107]
    v_fmac_f32 v87, v25, v39
    s_waitcnt vmcnt(4)
    v_cmp_ne_u32 vcc, s68, v11
    s_cbranch_vccz L_pd_38
L_pl_37:
    s_cmp_eq_u32 s72, 0
    s_cbranch_scc1 L_pd_38
    s_sub_u32 s72, s72, 1
    buffer_load_dword v11, v0, s[8:11], s91 offen sc1
    s_waitcnt vmcnt(0)
    v_cmp_ne_u32 vcc, s68, v11
    s_cbranch_vccnz L_pl_37
L_pd_38:
    s_waitcnt lgkmcnt(0)
    s_barrier
    v_mfma_f32_16x16x32_bf16 v[92:95], a[100:103], v[48:51], v[92:95]
    ds_read2st64_b64 v[40:43], v1 offset0:0 offset1:1
    v_permlane32_swap_b32 v72, v74
    v_mfma_f32_16x16x32_bf16 v[96:99], a[104:107], v[48:51], v[96:99]
    ds_read2st64_b64 v[44:47], v3 offset0:0 offset1:1
    v_permlane32_swap_b32 v73, v75
    v_mfma_f32_16x16x32_bf16 v[108:111], a[104:107], v[52:55], v[108:111]
    v_max_f32 v64, 0, v64
    v_mfma_f32_16x16x32_bf16 v[88:91], a[108:111], v[56:59], v[88:91]
    ds_read2st64_b64 v[48:51], v1 offset0:4 offset1:5
    ds_read2st64_b64 v[52:55], v3 offset0:4 offset1:5
    v_mfma_f32_16x16x32_bf16 v[100:103], a[108:111], v[60:63], v[100:103]
    v_mul_f32 v68, v26, v68
    v_max_f32 v65, 0, v65
    v_mfma_f32_16x16x32_bf16 v[104:107], a[112:115], v[60:63], v[104:107]
    v_mul_f32 v69, v26, v69
    v_max_f32 v66, 0, v66
    v_mfma_f32_16x16x32_bf16 v[92:95], a[112:115], v[56:59], v[92:95]
    v_mul_f32 v70, v26, v70
    v_max_f32 v67, 0, v67
    v_mfma_f32_16x16x32_bf16 v[96:99], a[116:119], v[56:59], v[96:99]
    v_mul_f32 v71, v26, v71
    v_max_f32 v72, 0, v72
    v_mfma_f32_16x16x32_bf16 v[108:111], a[116:119], v[60:63], v[108:111]
    v_mul_f32 v74, v26, v74
    s_waitcnt lgkmcnt(2)
    v_mfma_f32_16x16x32_bf16 v[88:91], a[120:123], v[40:43], v[88:91]
    ds_read2st64_b64 v[56:59], v1 offset0:8 offset1:9
    ds_read2st64_b64 v[60:63], v3 offset0:8 offset1:9
    v_mfma_f32_16x16x32_bf16 v[100:103], a[120:123], v[44:47], v[100:103]
    s_add_u32 m0, s97, 20480
    s_add_u32 s84, s73, 1310720
    buffer_load_dwordx4 v5, s[8:11], s84 offen offset:0 sc1 lds
    v_mfma_f32_16x16x32_bf16 v[104:107], a[124:127], v[44:47], v[104:107]
    v_max_f32 v73, 0, v73
    v_mul_f32 v75, v26, v75
    v_mfma_f32_16x16x32_bf16 v[92:95], a[124:127], v[40:43], v[92:95]
    v_mul_f32 v64, v64, v68
    v_mul_f32 v65, v65, v69
    v_mfma_f32_16x16x32_bf16 v[96:99], a[128:131], v[40:43], v[96:99]
    v_mul_f32 v66, v66, v70
    v_mul_f32 v67, v67, v71
    v_mfma_f32_16x16x32_bf16 v[108:111], a[128:131], v[44:47], v[108:111]
    buffer_load_dwordx4 v5, s[8:11], s84 offen offset:1024 sc1 lds
    s_waitcnt lgkmcnt(2)
    v_mfma_f32_16x16x32_bf16 v[88:91], a[132:135], v[48:51], v[88:91]
    ds_read2st64_b64 v[40:43], v1 offset0:12 offset1:13
    ds_read2st64_b64 v[44:47], v3 offset0:12 offset1:13
    v_mfma_f32_16x16x32_bf16 v[100:103], a[132:135], v[52:55], v[100:103]
    v_mul_f32 v72, v72, v74
    v_mul_f32 v73, v73, v75
    v_mfma_f32_16x16x32_bf16 v[104:107], a[136:139], v[52:55], v[104:107]
    v_cvt_pk_bf16_f32 v28, v64, v65
    v_cvt_pk_bf16_f32 v29, v66, v67
    v_mfma_f32_16x16x32_bf16 v[92:95], a[136:139], v[48:51], v[92:95]
    v_cvt_pk_bf16_f32 v32, v72, v73
    v_permlane32_swap_b32 v84, v86
    v_mfma_f32_16x16x32_bf16 v[96:99], a[140:143], v[48:51], v[96:99]
    buffer_load_dwordx4 v5, s[8:11], s84 offen offset:2048 sc1 lds
    v_permlane32_swap_b32 v85, v87
    v_mfma_f32_16x16x32_bf16 v[108:111], a[140:143], v[52:55], v[108:111]
    v_max_f32 v76, 0, v76
    s_waitcnt lgkmcnt(2)
    v_mfma_f32_16x16x32_bf16 v[88:91], a[144:147], v[56:59], v[88:91]
    ds_read2st64_b64 v[48:51], v1 offset0:16 offset1:17
    ds_read2st64_b64 v[52:55], v3 offset0:16 offset1:17
    v_mfma_f32_16x16x32_bf16 v[100:103], a[144:147], v[60:63], v[100:103]
    v_mul_f32 v80, v27, v80
    v_max_f32 v77, 0, v77
    v_mfma_f32_16x16x32_bf16 v[104:107], a[148:151], v[60:63], v[104:107]
    buffer_load_dwordx4 v5, s[8:11], s84 offen offset:3072 sc1 lds
    s_add_u32 m0, s97, 24576
    s_add_u32 s84, s73, 1314816
    v_mfma_f32_16x16x32_bf16 v[92:95], a[148:151], v[56:59], v[92:95]
    v_mul_f32 v81, v27, v81
    v_max_f32 v78, 0, v78
    v_mfma_f32_16x16x32_bf16 v[96:99], a[152:155], v[56:59], v[96:99]
    v_mul_f32 v82, v27, v82
    v_max_f32 v79, 0, v79
    v_mfma_f32_16x16x32_bf16 v[108:111], a[152:155], v[60:63], v[108:111]
    v_mul_f32 v83, v27, v83
    s_waitcnt lgkmcnt(2)
    v_mfma_f32_16x16x32_bf16 v[88:91], a[156:159], v[40:43], v[88:91]
    ds_read2st64_b64 v[56:59], v2 offset0:0 offset1:1
    ds_read2st64_b64 v[60:63], v4 offset0:0 offset1:1
    v_mfma_f32_16x16x32_bf16 v[100:103], a[156:159], v[44:47], v[100:103]
    buffer_load_dwordx4 v5, s[8:11], s84 offen sc1 lds
    s_add_u32 m0, s97, 40960
    s_add_u32 s84, s73, 1320960
    v_mfma_f32_16x16x32_bf16 v[104:107], a[160:163], v[44:47], v[104:107]
    v_max_f32 v84, 0, v84
    v_mul_f32 v86, v27, v86
    v_mfma_f32_16x16x32_bf16 v[92:95], a[160:163], v[40:43], v[92:95]
    v_max_f32 v85, 0, v85
    v_mul_f32 v87, v27, v87
    v_mfma_f32_16x16x32_bf16 v[96:99], a[164:167], v[40:43], v[96:99]
    v_mul_f32 v76, v76, v80
    v_mul_f32 v77, v77, v81
    v_mfma_f32_16x16x32_bf16 v[108:111], a[164:167], v[44:47], v[108:111]
    buffer_load_dwordx4 v5, s[8:11], s84 offen offset:0 sc1 lds
    s_waitcnt lgkmcnt(2)
    v_mfma_f32_16x16x32_bf16 v[88:91], a[168:171], v[48:51], v[88:91]
    ds_read2st64_b64 v[40:43], v2 offset0:4 offset1:5
    ds_read2st64_b64 v[44:47], v4 offset0:4 offset1:5
    v_mfma_f32_16x16x32_bf16 v[100:103], a[168:171], v[52:55], v[100:103]
    v_mul_f32 v78, v78, v82
    v_mul_f32 v79, v79, v83
    v_mfma_f32_16x16x32_bf16 v[104:107], a[172:175], v[52:55], v[104:107]
    v_mul_f32 v84, v84, v86
    v_mul_f32 v85, v85, v87
    v_mfma_f32_16x16x32_bf16 v[92:95], a[172:175], v[48:51], v[92:95]
    v_cvt_pk_bf16_f32 v30, v76, v77
    v_cvt_pk_bf16_f32 v31, v78, v79
    v_mfma_f32_16x16x32_bf16 v[96:99], a[176:179], v[48:51], v[96:99]
    buffer_load_dwordx4 v5, s[8:11], s84 offen offset:1024 sc1 lds
    v_cvt_pk_bf16_f32 v33, v84, v85
    v_mfma_f32_16x16x32_bf16 v[108:111], a[176:179], v[52:55], v[108:111]
    v_bfe_u32 v34, v0, 8, 1
    s_waitcnt lgkmcnt(2)
    v_mfma_f32_16x16x32_bf16 v[88:91], a[180:183], v[56:59], v[88:91]
    ds_read2st64_b64 v[48:51], v2 offset0:8 offset1:9
    ds_read2st64_b64 v[52:55], v4 offset0:8 offset1:9
    v_mfma_f32_16x16x32_bf16 v[100:103], a[180:183], v[60:63], v[100:103]
    s_mov_b32 s88, -248
    v_mad_i32_i24 v34, v34, s88, v8
    v_mfma_f32_16x16x32_bf16 v[104:107], a[184:187], v[60:63], v[104:107]
    buffer_load_dwordx4 v5, s[8:11], s84 offen offset:2048 sc1 lds
    v_permlane32_swap_b32 v28, v30
    v_mfma_f32_16x16x32_bf16 v[92:95], a[184:187], v[56:59], v[92:95]
    v_permlane32_swap_b32 v29, v31
    v_mfma_f32_16x16x32_bf16 v[96:99], a[188:191], v[56:59], v[96:99]
    v_permlane32_swap_b32 v32, v33
    v_mfma_f32_16x16x32_bf16 v[108:111], a[188:191], v[60:63], v[108:111]
    s_add_u32 s88, s74, 0
    s_lshl_b32 s87, s62, 8
    s_waitcnt lgkmcnt(2)
    v_mfma_f32_16x16x32_bf16 v[88:91], a[192:195], v[40:43], v[88:91]
    ds_read2st64_b64 v[56:59], v2 offset0:12 offset1:13
    ds_read2st64_b64 v[60:63], v4 offset0:12 offset1:13
    v_mfma_f32_16x16x32_bf16 v[100:103], a[192:195], v[44:47], v[100:103]
    buffer_store_dwordx4 v[28:31], v8, s[8:11], s88 offen sc1
    s_add_u32 s88, s88, 2048
    s_sub_u32 s88, s88, s87
    v_mfma_f32_16x16x32_bf16 v[104:107], a[196:199], v[44:47], v[104:107]
    v_mfma_f32_16x16x32_bf16 v[92:95], a[196:199], v[40:43], v[92:95]
    v_mfma_f32_16x16x32_bf16 v[96:99], a[200:203], v[40:43], v[96:99]
    v_mfma_f32_16x16x32_bf16 v[108:111], a[200:203], v[44:47], v[108:111]
    s_waitcnt lgkmcnt(2)
    v_mfma_f32_16x16x32_bf16 v[88:91], a[204:207], v[48:51], v[88:91]
    ds_read2st64_b64 v[40:43], v2 offset0:16 offset1:17
    ds_read2st64_b64 v[44:47], v4 offset0:16 offset1:17
    v_mfma_f32_16x16x32_bf16 v[100:103], a[204:207], v[52:55], v[100:103]
    v_mfma_f32_16x16x32_bf16 v[104:107], a[208:211], v[52:55], v[104:107]
    v_mfma_f32_16x16x32_bf16 v[92:95], a[208:211], v[48:51], v[92:95]
    v_mfma_f32_16x16x32_bf16 v[96:99], a[212:215], v[48:51], v[96:99]
    v_mfma_f32_16x16x32_bf16 v[108:111], a[212:215], v[52:55], v[108:111]
    buffer_store_dwordx2 v[32:33], v34, s[8:11], s88 offen sc1
    s_waitcnt lgkmcnt(2)
    v_mfma_f32_16x16x32_bf16 v[88:91], a[216:219], v[56:59], v[88:91]
    v_mfma_f32_16x16x32_bf16 v[100:103], a[216:219], v[60:63], v[100:103]
    v_mfma_f32_16x16x32_bf16 v[104:107], a[220:223], v[60:63], v[104:107]
    s_waitcnt vmcnt(5) lgkmcnt(0)
    s_barrier
    v_mfma_f32_16x16x32_bf16 v[92:95], a[220:223], v[56:59], v[92:95]
    ds_read2st64_b64 v[48:51], v1 offset0:40 offset1:41
    v_mfma_f32_16x16x32_bf16 v[96:99], a[224:227], v[56:59], v[96:99]
    ds_read2st64_b64 v[52:55], v3 offset0:40 offset1:41
    buffer_load_dwordx4 v5, s[8:11], s84 offen offset:3072 sc1 lds
    v_mfma_f32_16x16x32_bf16 v[108:111], a[224:227], v[60:63], v[108:111]
    s_add_u32 m0, s97, 45056
    s_add_u32 s84, s73, 1325056
    v_mfma_f32_16x16x32_bf16 v[88:91], a[228:231], v[40:43], v[88:91]
    ds_read2st64_b64 v[56:59], v1 offset0:44 offset1:45
    ds_read2st64_b64 v[60:63], v3 offset0:44 offset1:45
    v_mfma_f32_16x16x32_bf16 v[100:103], a[228:231], v[44:47], v[100:103]
    v_mfma_f32_16x16x32_bf16 v[104:107], a[232:235], v[44:47], v[104:107]
    buffer_load_dwordx4 v5, s[8:11], s84 offen sc1 lds
    v_mfma_f32_16x16x32_bf16 v[92:95], a[232:235], v[40:43], v[92:95]
    v_mfma_f32_16x16x32_bf16 v[96:99], a[236:239], v[40:43], v[96:99]
    v_mfma_f32_16x16x32_bf16 v[108:111], a[236:239], v[44:47], v[108:111]
    s_waitcnt lgkmcnt(2)
    v_mfma_f32_16x16x32_bf16 v[64:67], a[0:3], v[48:51], 0
    ds_read2st64_b64 v[40:43], v1 offset0:48 offset1:49
    ds_read2st64_b64 v[44:47], v3 offset0:48 offset1:49
    v_mfma_f32_16x16x32_bf16 v[76:79], a[0:3], v[52:55], 0
    s_add_u32 m0, s97, 0
    s_add_u32 s84, s73, 1331200
    buffer_load_dwordx4 v5, s[8:11], s84 offen offset:0 sc1 lds
    v_mfma_f32_16x16x32_bf16 v[80:83], a[4:7], v[52:55], 0
    ds_read_b128 v[28:31], v10 offset:0
    ds_read_b128 v[32:35], v10 offset:64
    v_mfma_f32_16x16x32_bf16 v[68:71], a[4:7], v[48:51], 0
    ds_read_b128 v[36:39], v10 offset:128
    v_add_f32 v16, v16, v18
    v_mfma_f32_16x16x32_bf16 v[72:75], a[8:11], v[48:51], 0
    v_add_f32 v17, v17, v19
    v_add_f32 v20, v20, v22
    v_mfma_f32_16x16x32_bf16 v[84:87], a[8:11], v[52:55], 0
    buffer_load_dwordx4 v5, s[8:11], s84 offen offset:1024 sc1 lds
    s_waitcnt lgkmcnt(5)
    v_mfma_f32_16x16x32_bf16 v[64:67], a[12:15], v[56:59], v[64:67]
    ds_read2st64_b64 v[48:51], v1 offset0:52 offset1:53
    ds_read2st64_b64 v[52:55], v3 offset0:52 offset1:53
    v_mfma_f32_16x16x32_bf16 v[76:79], a[12:15], v[60:63], v[76:79]
    v_add_f32 v21, v21, v23
    v_permlane16_swap_b32 v16, v17
    v_mfma_f32_16x16x32_bf16 v[80:83], a[16:19], v[60:63], v[80:83]
    v_permlane16_swap_b32 v20, v21
    v_mfma_f32_16x16x32_bf16 v[68:71], a[16:19], v[56:59], v[68:71]
    v_add_f32 v16, v16, v17
    v_mov_b32 v17, v16
    v_mfma_f32_16x16x32_bf16 v[72:75], a[20:23], v[56:59], v[72:75]
    buffer_load_dwordx4 v5, s[8:11], s84 offen offset:2048 sc1 lds
    v_add_f32 v20, v20, v21
    v_mfma_f32_16x16x32_bf16 v[84:87], a[20:23], v[60:63], v[84:87]
    v_mov_b32 v21, v20
    s_waitcnt lgkmcnt(5)
    v_mfma_f32_16x16x32_bf16 v[64:67], a[24:27], v[40:43], v[64:67]
    ds_read2st64_b64 v[56:59], v1 offset0:56 offset1:57
    ds_read2st64_b64 v[60:63], v3 offset0:56 offset1:57
    v_mfma_f32_16x16x32_bf16 v[76:79], a[24:27], v[44:47], v[76:79]
    v_permlane32_swap_b32 v16, v17
    v_mfma_f32_16x16x32_bf16 v[80:83], a[28:31], v[44:47], v[80:83]
    buffer_load_dwordx4 v5, s[8:11], s84 offen offset:3072 sc1 lds
    s_add_u32 m0, s97, 4096
    s_add_u32 s84, s73, 1335296
    v_mfma_f32_16x16x32_bf16 v[68:71], a[28:31], v[40:43], v[68:71]
    v_permlane32_swap_b32 v20, v21
    v_mfma_f32_16x16x32_bf16 v[72:75], a[32:35], v[40:43], v[72:75]
    v_add_f32 v16, v16, v17
    v_mov_b32 v17, v16
    v_mfma_f32_16x16x32_bf16 v[84:87], a[32:35], v[44:47], v[84:87]
    v_add_f32 v20, v20, v21
    s_waitcnt lgkmcnt(2)
    v_mfma_f32_16x16x32_bf16 v[64:67], a[36:39], v[48:51], v[64:67]
    ds_read2st64_b64 v[40:43], v2 offset0:40 offset1:41
    ds_read2st64_b64 v[44:47], v4 offset0:40 offset1:41
    v_mfma_f32_16x16x32_bf16 v[76:79], a[36:39], v[52:55], v[76:79]
    buffer_load_dwordx4 v5, s[8:11], s84 offen sc1 lds
    v_mov_b32 v21, v20
    v_mfma_f32_16x16x32_bf16 v[80:83], a[40:43], v[52:55], v[80:83]
    v_permlane16_swap_b32 v16, v17
    v_mfma_f32_16x16x32_bf16 v[68:71], a[40:43], v[48:51], v[68:71]
    v_permlane16_swap_b32 v20, v21
    v_mfma_f32_16x16x32_bf16 v[72:75], a[44:47], v[48:51], v[72:75]
    v_mul_f32 v24, 0xbacccccd, v16
    v_mov_b32 v26, 0x3727c5ac
    v_mfma_f32_16x16x32_bf16 v[84:87], a[44:47], v[52:55], v[84:87]
    v_fmac_f32 v26, 0x3acccccd, v17
    s_waitcnt lgkmcnt(2)
    v_mfma_f32_16x16x32_bf16 v[64:67], a[48:51], v[56:59], v[64:67]
    ds_read2st64_b64 v[48:51], v2 offset0:44 offset1:45
    ds_read2st64_b64 v[52:55], v4 offset0:44 offset1:45
    v_mfma_f32_16x16x32_bf16 v[76:79], a[48:51], v[60:63], v[76:79]
    v_mul_f32 v25, 0xbacccccd, v20
    v_mov_b32 v27, 0x3727c5ac
    v_mfma_f32_16x16x32_bf16 v[80:83], a[52:55], v[60:63], v[80:83]
    v_fmac_f32 v27, 0x3acccccd, v21
    s_add_u32 s89, s90, 65536
    v_mfma_f32_16x16x32_bf16 v[68:71], a[52:55], v[56:59], v[68:71]
    buffer_load_dwordx2 v[16:17], v6, s[8:11], s89 offen offset:0 sc1
    v_mfma_f32_16x16x32_bf16 v[72:75], a[56:59], v[56:59], v[72:75]
    v_mfma_f32_16x16x32_bf16 v[84:87], a[56:59], v[60:63], v[84:87]
    buffer_load_dwordx2 v[18:19], v6, s[8:11], s89 offen offset:64 sc1
    s_waitcnt lgkmcnt(2)
    v_mfma_f32_16x16x32_bf16 v[64:67], a[60:63], v[40:43], v[64:67]
    ds_read2st64_b64 v[56:59], v2 offset0:48 offset1:49
    ds_read2st64_b64 v[60:63], v4 offset0:48 offset1:49
    v_mfma_f32_16x16x32_bf16 v[76:79], a[60:63], v[44:47], v[76:79]
    buffer_load_dwordx2 v[20:21], v7, s[8:11], s89 offen offset:0 sc1
    v_mfma_f32_16x16x32_bf16 v[80:83], a[64:67], v[44:47], v[80:83]
    v_mfma_f32_16x16x32_bf16 v[68:71], a[64:67], v[40:43], v[68:71]
    v_mfma_f32_16x16x32_bf16 v[72:75], a[68:71], v[40:43], v[72:75]
    buffer_load_dwordx2 v[22:23], v7, s[8:11], s89 offen offset:64 sc1
    v_fma_f32 v26, -v24, v24, v26
    v_mfma_f32_16x16x32_bf16 v[84:87], a[68:71], v[44:47], v[84:87]
    v_max_f32 v26, 0x3727c5ac, v26
    s_waitcnt lgkmcnt(2)
    v_mfma_f32_16x16x32_bf16 v[64:67], a[72:75], v[48:51], v[64:67]
    ds_read2st64_b64 v[40:43], v2 offset0:52 offset1:53
    ds_read2st64_b64 v[44:47], v4 offset0:52 offset1:53
    v_mfma_f32_16x16x32_bf16 v[76:79], a[72:75], v[52:55], v[76:79]
    v_fma_f32 v27, -v25, v25, v27
    v_max_f32 v27, 0x3727c5ac, v27
    v_mfma_f32_16x16x32_bf16 v[80:83], a[76:79], v[52:55], v[80:83]
    v_rcp_f32 v26, v26
    v_mfma_f32_16x16x32_bf16 v[68:71], a[76:79], v[48:51], v[68:71]
    v_rcp_f32 v27, v27
    v_mfma_f32_16x16x32_bf16 v[72:75], a[80:83], v[48:51], v[72:75]
    v_fmac_f32 v88, v24, v28
    v_fmac_f32 v89, v24, v29
    v_mfma_f32_16x16x32_bf16 v[84:87], a[80:83], v[52:55], v[84:87]
    v_fmac_f32 v90, v24, v30
    s_waitcnt lgkmcnt(2)
    v_mfma_f32_16x16x32_bf16 v[64:67], a[84:87], v[56:59], v[64:67]
    ds_read2st64_b64 v[48:51], v2 offset0:56 offset1:57
    ds_read2st64_b64 v[52:55], v4 offset0:56 offset1:57
    v_mfma_f32_16x16x32_bf16 v[76:79], a[84:87], v[60:63], v[76:79]
    v_fmac_f32 v91, v24, v31
    v_fmac_f32 v92, v24, v32
    v_mfma_f32_16x16x32_bf16 v[80:83], a[88:91], v[60:63], v[80:83]
    v_fmac_f32 v93, v24, v33
    v_fmac_f32 v94, v24, v34
    v_mfma_f32_16x16x32_bf16 v[68:71], a[88:91], v[56:59], v[68:71]
    v_fmac_f32 v95, v24, v35
    v_fmac_f32 v96, v24, v36
    v_mfma_f32_16x16x32_bf16 v[72:75], a[92:95], v[56:59], v[72:75]
    v_fmac_f32 v97, v24, v37
    v_fmac_f32 v98, v24, v38
    v_mfma_f32_16x16x32_bf16 v[84:87], a[92:95], v[60:63], v[84:87]
    v_fmac_f32 v99, v24, v39
    s_waitcnt lgkmcnt(2)
    v_mfma_f32_16x16x32_bf16 v[64:67], a[96:99], v[40:43], v[64:67]
    v_fmac_f32 v100, v25, v28
    v_fmac_f32 v101, v25, v29
    v_mfma_f32_16x16x32_bf16 v[76:79], a[96:99], v[44:47], v[76:79]
    v_fmac_f32 v102, v25, v30
    v_fmac_f32 v103, v25, v31
    v_mfma_f32_16x16x32_bf16 v[80:83], a[100:103], v[44:47], v[80:83]
    v_fmac_f32 v104, v25, v32
    s_waitcnt vmcnt(9) lgkmcnt(0)
    s_barrier
    v_mfma_f32_16x16x32_bf16 v[68:71], a[100:103], v[40:43], v[68:71]
    ds_read2st64_b64 v[56:59], v1 offset0:80 offset1:81
    v_fmac_f32 v105, v25, v33
    v_mfma_f32_16x16x32_bf16 v[72:75], a[104:107], v[40:43], v[72:75]
    ds_read2st64_b64 v[60:63], v3 offset0:80 offset1:81
    v_fmac_f32 v106, v25, v34
    v_mfma_f32_16x16x32_bf16 v[84:87], a[104:107], v[44:47], v[84:87]
    v_fmac_f32 v107, v25, v35
    v_mfma_f32_16x16x32_bf16 v[64:67], a[108:111], v[48:51], v[64:67]
    ds_read2st64_b64 v[40:43], v1 offset0:84 offset1:85
    ds_read2st64_b64 v[44:47], v3 offset0:84 offset1:85
    v_mfma_f32_16x16x32_bf16 v[76:79], a[108:111], v[52:55], v[76:79]
    v_fmac_f32 v108, v25, v36
    v_fmac_f32 v109, v25, v37
    v_mfma_f32_16x16x32_bf16 v[80:83], a[112:115], v[52:55], v[80:83]
    v_fmac_f32 v110, v25, v38
    v_fmac_f32 v111, v25, v39
    v_mfma_f32_16x16x32_bf16 v[68:71], a[112:115], v[48:51], v[68:71]
    s_lshl_b32 s85, s1, 2
    s_add_u32 s85, s85, s62
    s_lshl_b32 s85, s85, 6
    s_add_u32 s85, s85, s75
    v_mfma_f32_16x16x32_bf16 v[72:75], a[116:119], v[48:51], v[72:75]
    v_mov_b32 v37, s68
    s_add_u32 s85, s85, 0
    v_mfma_f32_16x16x32_bf16 v[84:87], a[116:119], v[52:55], v[84:87]
    s_waitcnt lgkmcnt(2)
    v_mfma_f32_16x16x32_bf16 v[64:67], a[120:123], v[56:59], v[64:67]
    ds_read2st64_b64 v[48:51], v1 offset0:88 offset1:89
    ds_read2st64_b64 v[52:55], v3 offset0:88 offset1:89
    v_mfma_f32_16x16x32_bf16 v[76:79], a[120:123], v[60:63], v[76:79]
    s_add_u32 m0, s97, 20480
    s_add_u32 s84, s73, 1341440
    v_mfma_f32_16x16x32_bf16 v[80:83], a[124:127], v[60:63], v[80:83]
    s_mov_b64 exec, 15
    buffer_store_dword v37, v0, s[8:11], s85 offen sc1
    s_mov_b64 exec, -1
    v_mfma_f32_16x16x32_bf16 v[68:71], a[124:127], v[56:59], v[68:71]
    buffer_load_dwordx4 v5, s[8:11], s84 offen offset:0 sc1 lds
    v_permlane32_swap_b32 v96, v98
    v_mfma_f32_16x16x32_bf16 v[72:75], a[128:131], v[56:59], v[72:75]
    v_permlane32_swap_b32 v97, v99
    v_mfma_f32_16x16x32_bf16 v[84:87], a[128:131], v[60:63], v[84:87]
    v_max_f32 v88, 0, v88
    s_waitcnt lgkmcnt(2)
    v_mfma_f32_16x16x32_bf16 v[64:67], a[132:135], v[40:43], v[64:67]
    ds_read2st64_b64 v[56:59], v1 offset0:92 offset1:93
    ds_read2st64_b64 v[60:63], v3 offset0:92 offset1:93
    v_mfma_f32_16x16x32_bf16 v[76:79], a[132:135], v[44:47], v[76:79]
    v_mul_f32 v92, v26, v92
    v_max_f32 v89, 0, v89
    v_mfma_f32_16x16x32_bf16 v[80:83], a[136:139], v[44:47], v[80:83]
    buffer_load_dwordx4 v5, s[8:11], s84 offen offset:1024 sc1 lds
    v_mul_f32 v93, v26, v93
    v_mfma_f32_16x16x32_bf16 v[68:71], a[136:139], v[40:43], v[68:71]
    v_max_f32 v90, 0, v90
    v_mul_f32 v94, v26, v94
    v_mfma_f32_16x16x32_bf16 v[72:75], a[140:143], v[40:43], v[72:75]
    v_max_f32 v91, 0, v91
    v_mul_f32 v95, v26, v95
    v_mfma_f32_16x16x32_bf16 v[84:87], a[140:143], v[44:47], v[84:87]
    v_max_f32 v96, 0, v96
    s_waitcnt lgkmcnt(2)
    v_mfma_f32_16x16x32_bf16 v[64:67], a[144:147], v[48:51], v[64:67]
    ds_read2st64_b64 v[40:43], v1 offset0:96 offset1:97
    ds_read2st64_b64 v[44:47], v3 offset0:96 offset1:97
    v_mfma_f32_16x16x32_bf16 v[76:79], a[144:147], v[52:55], v[76:79]
    buffer_load_dwordx4 v5, s[8:11], s84 offen offset:2048 sc1 lds
    v_mul_f32 v98, v26, v98
    v_mfma_f32_16x16x32_bf16 v[80:83], a[148:151], v[52:55], v[80:83]
    v_max_f32 v97, 0, v97
    v_mul_f32 v99, v26, v99
    v_mfma_f32_16x16x32_bf16 v[68:71], a[148:151], v[48:51], v[68:71]
    v_mul_f32 v88, v88, v92
    v_mul_f32 v89, v89, v93
    v_mfma_f32_16x16x32_bf16 v[72:75], a[152:155], v[48:51], v[72:75]
    v_mul_f32 v90, v90, v94
    v_mul_f32 v91, v91, v95
    v_mfma_f32_16x16x32_bf16 v[84:87], a[152:155], v[52:55], v[84:87]
    buffer_load_dwordx4 v5, s[8:11], s84 offen offset:3072 sc1 lds
    s_waitcnt lgkmcnt(2)
    v_mfma_f32_16x16x32_bf16 v[64:67], a[156:159], v[56:59], v[64:67]
    ds_read2st64_b64 v[48:51], v2 offset0:80 offset1:81
    ds_read2st64_b64 v[52:55], v4 offset0:80 offset1:81
    v_mfma_f32_16x16x32_bf16 v[76:79], a[156:159], v[60:63], v[76:79]
    s_add_u32 m0, s97, 24576
    s_add_u32 s84, s73, 1345536
    v_mul_f32 v96, v96, v98
    v_mfma_f32_16x16x32_bf16 v[80:83], a[160:163], v[60:63], v[80:83]
    v_mul_f32 v97, v97, v99
    v_cvt_pk_bf16_f32 v28, v88, v89
    v_mfma_f32_16x16x32_bf16 v[68:71], a[160:163], v[56:59], v[68:71]
    v_cvt_pk_bf16_f32 v29, v90, v91
    v_cvt_pk_bf16_f32 v32, v96, v97
    v_mfma_f32_16x16x32_bf16 v[72:75], a[164:167], v[56:59], v[72:75]
    buffer_load_dwordx4 v5, s[8:11], s84 offen sc1 lds
    v_permlane32_swap_b32 v108, v110
    v_mfma_f32_16x16x32_bf16 v[84:87], a[164:167], v[60:63], v[84:87]
    v_permlane32_swap_b32 v109, v111
    s_waitcnt lgkmcnt(2)
    v_mfma_f32_16x16x32_bf16 v[64:67], a[168:171], v[40:43], v[64:67]
    ds_read2st64_b64 v[56:59], v2 offset0:84 offset1:85
    ds_read2st64_b64 v[60:63], v4 offset0:84 offset1:85
    v_mfma_f32_16x16x32_bf16 v[76:79], a[168:171], v[44:47], v[76:79]
    v_max_f32 v100, 0, v100
    v_mul_f32 v104, v27, v104
    v_mfma_f32_16x16x32_bf16 v[80:83], a[172:175], v[44:47], v[80:83]
    v_max_f32 v101, 0, v101
    v_mul_f32 v105, v27, v105
    v_mfma_f32_16x16x32_bf16 v[68:71], a[172:175], v[40:43], v[68:71]
    v_max_f32 v102, 0, v102
    v_mul_f32 v106, v27, v106
    v_mfma_f32_16x16x32_bf16 v[72:75], a[176:179], v[40:43], v[72:75]
    v_max_f32 v103, 0, v103
    v_mul_f32 v107, v27, v107
    v_mfma_f32_16x16x32_bf16 v[84:87], a[176:179], v[44:47], v[84:87]
    v_max_f32 v108, 0, v108
    s_waitcnt lgkmcnt(2)
    v_mfma_f32_16x16x32_bf16 v[64:67], a[180:183], v[48:51], v[64:67]
    ds_read2st64_b64 v[40:43], v2 offset0:88 offset1:89
    ds_read2st64_b64 v[44:47], v4 offset0:88 offset1:89
    v_mfma_f32_16x16x32_bf16 v[76:79], a[180:183], v[52:55], v[76:79]
    v_mul_f32 v110, v27, v110
    v_max_f32 v109, 0, v109
    v_mfma_f32_16x16x32_bf16 v[80:83], a[184:187], v[52:55], v[80:83]
    v_mul_f32 v111, v27, v111
    v_mul_f32 v100, v100, v104
    v_mfma_f32_16x16x32_bf16 v[68:71], a[184:187], v[48:51], v[68:71]
    v_mul_f32 v101, v101, v105
    v_mul_f32 v102, v102, v106
    v_mfma_f32_16x16x32_bf16 v[72:75], a[188:191], v[48:51], v[72:75]
    v_mul_f32 v103, v103, v107
    v_mul_f32 v108, v108, v110
    v_mfma_f32_16x16x32_bf16 v[84:87], a[188:191], v[52:55], v[84:87]
    v_mul_f32 v109, v109, v111
    s_waitcnt lgkmcnt(2)
    v_mfma_f32_16x16x32_bf16 v[64:67], a[192:195], v[56:59], v[64:67]
    ds_read2st64_b64 v[48:51], v2 offset0:92 offset1:93
    ds_read2st64_b64 v[52:55], v4 offset0:92 offset1:93
    v_mfma_f32_16x16x32_bf16 v[76:79], a[192:195], v[60:63], v[76:79]
    v_cvt_pk_bf16_f32 v30, v100, v101
    v_cvt_pk_bf16_f32 v31, v102, v103
    v_mfma_f32_16x16x32_bf16 v[80:83], a[196:199], v[60:63], v[80:83]
    v_cvt_pk_bf16_f32 v33, v108, v109
    v_bfe_u32 v34, v0, 8, 1
    v_mfma_f32_16x16x32_bf16 v[68:71], a[196:199], v[56:59], v[68:71]
    s_mov_b32 s88, -248
    v_mad_i32_i24 v34, v34, s88, v8
    v_mfma_f32_16x16x32_bf16 v[72:75], a[200:203], v[56:59], v[72:75]
    v_permlane32_swap_b32 v28, v30
    v_mfma_f32_16x16x32_bf16 v[84:87], a[200:203], v[60:63], v[84:87]
    v_permlane32_swap_b32 v29, v31
    s_waitcnt lgkmcnt(2)
    v_mfma_f32_16x16x32_bf16 v[64:67], a[204:207], v[40:43], v[64:67]
    ds_read2st64_b64 v[56:59], v2 offset0:96 offset1:97
    ds_read2st64_b64 v[60:63], v4 offset0:96 offset1:97
    v_mfma_f32_16x16x32_bf16 v[76:79], a[204:207], v[44:47], v[76:79]
    v_permlane32_swap_b32 v32, v33
    v_mfma_f32_16x16x32_bf16 v[80:83], a[208:211], v[44:47], v[80:83]
    s_add_u32 s88, s74, 49152
    s_lshl_b32 s87, s62, 8
    buffer_store_dwordx4 v[28:31], v8, s[8:11], s88 offen sc1
    v_mfma_f32_16x16x32_bf16 v[68:71], a[208:211], v[40:43], v[68:71]
    s_add_u32 s88, s88, 2048
    s_sub_u32 s88, s88, s87
    v_mfma_f32_16x16x32_bf16 v[72:75], a[212:215], v[40:43], v[72:75]
    v_mfma_f32_16x16x32_bf16 v[84:87], a[212:215], v[44:47], v[84:87]
    s_waitcnt lgkmcnt(2)
    v_mfma_f32_16x16x32_bf16 v[64:67], a[216:219], v[48:51], v[64:67]
    v_mfma_f32_16x16x32_bf16 v[76:79], a[216:219], v[52:55], v[76:79]
    v_mfma_f32_16x16x32_bf16 v[80:83], a[220:223], v[52:55], v[80:83]
    s_waitcnt vmcnt(11) lgkmcnt(0)
    s_barrier
    v_mfma_f32_16x16x32_bf16 v[68:71], a[220:223], v[48:51], v[68:71]
    ds_read2st64_b64 v[40:43], v1 offset0:0 offset1:1
    v_mfma_f32_16x16x32_bf16 v[72:75], a[224:227], v[48:51], v[72:75]
    ds_read2st64_b64 v[44:47], v3 offset0:0 offset1:1
    v_mfma_f32_16x16x32_bf16 v[84:87], a[224:227], v[52:55], v[84:87]
    v_mfma_f32_16x16x32_bf16 v[64:67], a[228:231], v[56:59], v[64:67]
    ds_read2st64_b64 v[48:51], v1 offset0:4 offset1:5
    ds_read2st64_b64 v[52:55], v3 offset0:4 offset1:5
    v_mfma_f32_16x16x32_bf16 v[76:79], a[228:231], v[60:63], v[76:79]
    buffer_store_dwordx2 v[32:33], v34, s[8:11], s88 offen sc1
    v_mfma_f32_16x16x32_bf16 v[80:83], a[232:235], v[60:63], v[80:83]
    v_mfma_f32_16x16x32_bf16 v[68:71], a[232:235], v[56:59], v[68:71]
    v_mfma_f32_16x16x32_bf16 v[72:75], a[236:239], v[56:59], v[72:75]
    v_mfma_f32_16x16x32_bf16 v[84:87], a[236:239], v[60:63], v[84:87]
    s_waitcnt lgkmcnt(2)
    v_mfma_f32_16x16x32_bf16 v[88:91], a[0:3], v[40:43], 0
    ds_read2st64_b64 v[56:59], v1 offset0:8 offset1:9
    ds_read2st64_b64 v[60:63], v3 offset0:8 offset1:9
    v_mfma_f32_16x16x32_bf16 v[100:103], a[0:3], v[44:47], 0
    ds_read_b128 v[28:31], v10 offset:0
    ds_read_b128 v[32:35], v10 offset:64
    v_mfma_f32_16x16x32_bf16 v[104:107], a[4:7], v[44:47], 0
    ds_read_b128 v[36:39], v10 offset:128
    s_waitcnt vmcnt(10)
    v_add_f32 v16, v16, v18
    v_mfma_f32_16x16x32_bf16 v[92:95], a[4:7], v[40:43], 0
    v_add_f32 v17, v17, v19
    s_waitcnt vmcnt(8)
    v_add_f32 v20, v20, v22
    v_mfma_f32_16x16x32_bf16 v[96:99], a[8:11], v[40:43], 0
    v_add_f32 v21, v21, v23
    v_permlane16_swap_b32 v16, v17
    v_mfma_f32_16x16x32_bf16 v[108:111], a[8:11], v[44:47], 0
    v_permlane16_swap_b32 v20, v21
    s_waitcnt lgkmcnt(5)
    v_mfma_f32_16x16x32_bf16 v[88:91], a[12:15], v[48:51], v[88:91]
    ds_read2st64_b64 v[40:43], v1 offset0:12 offset1:13
    ds_read2st64_b64 v[44:47], v3 offset0:12 offset1:13
    v_mfma_f32_16x16x32_bf16 v[100:103], a[12:15], v[52:55], v[100:103]
    v_add_f32 v16, v16, v17
    v_mov_b32 v17, v16
    v_mfma_f32_16x16x32_bf16 v[104:107], a[16:19], v[52:55], v[104:107]
    v_add_f32 v20, v20, v21
    v_mov_b32 v21, v20
    v_mfma_f32_16x16x32_bf16 v[92:95], a[16:19], v[48:51], v[92:95]
    v_permlane32_swap_b32 v16, v17
    v_mfma_f32_16x16x32_bf16 v[96:99], a[20:23], v[48:51], v[96:99]
    v_permlane32_swap_b32 v20, v21
    v_mfma_f32_16x16x32_bf16 v[108:111], a[20:23], v[52:55], v[108:111]
    v_add_f32 v16, v16, v17
    s_waitcnt lgkmcnt(5)
    v_mfma_f32_16x16x32_bf16 v[88:91], a[24:27], v[56:59], v[88:91]
    ds_read2st64_b64 v[48:51], v1 offset0:16 offset1:17
    ds_read2st64_b64 v[52:55], v3 offset0:16 offset1:17
    v_mfma_f32_16x16x32_bf16 v[100:103], a[24:27], v[60:63], v[100:103]
    v_mov_b32 v17, v16
    v_add_f32 v20, v20, v21
    v_mfma_f32_16x16x32_bf16 v[104:107], a[28:31], v[60:63], v[104:107]
    v_mov_b32 v21, v20
    v_permlane16_swap_b32 v16, v17
    v_mfma_f32_16x16x32_bf16 v[92:95], a[28:31], v[56:59], v[92:95]
    v_permlane16_swap_b32 v20, v21
    v_mfma_f32_16x16x32_bf16 v[96:99], a[32:35], v[56:59], v[96:99]
    v_mul_f32 v24, 0xbacccccd, v16
    v_mov_b32 v26, 0x3727c5ac
    v_mfma_f32_16x16x32_bf16 v[108:111], a[32:35], v[60:63], v[108:111]
    v_fmac_f32 v26, 0x3acccccd, v17
    s_waitcnt lgkmcnt(2)
    v_mfma_f32_16x16x32_bf16 v[88:91], a[36:39], v[40:43], v[88:91]
    ds_read2st64_b64 v[56:59], v2 offset0:0 offset1:1
    ds_read2st64_b64 v[60:63], v4 offset0:0 offset1:1
    v_mfma_f32_16x16x32_bf16 v[100:103], a[36:39], v[44:47], v[100:103]
    v_mul_f32 v25, 0xbacccccd, v20
    v_mov_b32 v27, 0x3727c5ac
    v_mfma_f32_16x16x32_bf16 v[104:107], a[40:43], v[44:47], v[104:107]
    v_fmac_f32 v27, 0x3acccccd, v21
    s_add_u32 s89, s90, 66560
    v_mfma_f32_16x16x32_bf16 v[92:95], a[40:43], v[40:43], v[92:95]
    buffer_load_dwordx2 v[16:17], v6, s[8:11], s89 offen offset:0 sc1
    v_mfma_f32_16x16x32_bf16 v[96:99], a[44:47], v[40:43], v[96:99]
    v_mfma_f32_16x16x32_bf16 v[108:111], a[44:47], v[44:47], v[108:111]
    buffer_load_dwordx2 v[18:19], v6, s[8:11], s89 offen offset:64 sc1
    s_waitcnt lgkmcnt(2)
    v_mfma_f32_16x16x32_bf16 v[88:91], a[48:51], v[48:51], v[88:91]
    ds_read2st64_b64 v[40:43], v2 offset0:4 offset1:5
    ds_read2st64_b64 v[44:47], v4 offset0:4 offset1:5
    v_mfma_f32_16x16x32_bf16 v[100:103], a[48:51], v[52:55], v[100:103]
    buffer_load_dwordx2 v[20:21], v7, s[8:11], s89 offen offset:0 sc1
    v_mfma_f32_16x16x32_bf16 v[104:107], a[52:55], v[52:55], v[104:107]
    v_mfma_f32_16x16x32_bf16 v[92:95], a[52:55], v[48:51], v[92:95]
    v_mfma_f32_16x16x32_bf16 v[96:99], a[56:59], v[48:51], v[96:99]
    buffer_load_dwordx2 v[22:23], v7, s[8:11], s89 offen offset:64 sc1
    v_fma_f32 v26, -v24, v24, v26
    v_mfma_f32_16x16x32_bf16 v[108:111], a[56:59], v[52:55], v[108:111]
    v_max_f32 v26, 0x3727c5ac, v26
    s_waitcnt lgkmcnt(2)
    v_mfma_f32_16x16x32_bf16 v[88:91], a[60:63], v[56:59], v[88:91]
    ds_read2st64_b64 v[48:51], v2 offset0:8 offset1:9
    ds_read2st64_b64 v[52:55], v4 offset0:8 offset1:9
    v_mfma_f32_16x16x32_bf16 v[100:103], a[60:63], v[60:63], v[100:103]
    s_lshl_b32 s91, s63, 4
    s_add_u32 s91, s91, s62
    s_lshl_b32 s91, s91, 10
    s_add_u32 s91, s91, 35913728
    v_mfma_f32_16x16x32_bf16 v[104:107], a[64:67], v[60:63], v[104:107]
    buffer_load_dword v11, v0, s[8:11], s91 offen sc1
    v_fma_f32 v27, -v25, v25, v27
    v_mfma_f32_16x16x32_bf16 v[92:95], a[64:67], v[56:59], v[92:95]
    v_max_f32 v27, 0x3727c5ac, v27
    v_rcp_f32 v26, v26
    v_mfma_f32_16x16x32_bf16 v[96:99], a[68:71], v[56:59], v[96:99]
    v_rcp_f32 v27, v27
    v_mfma_f32_16x16x32_bf16 v[108:111], a[68:71], v[60:63], v[108:111]
    v_fmac_f32 v64, v24, v28
    s_waitcnt lgkmcnt(2)
    v_mfma_f32_16x16x32_bf16 v[88:91], a[72:75], v[40:43], v[88:91]
    ds_read2st64_b64 v[56:59], v2 offset0:12 offset1:13
    ds_read2st64_b64 v[60:63], v4 offset0:12 offset1:13
    v_mfma_f32_16x16x32_bf16 v[100:103], a[72:75], v[44:47], v[100:103]
    v_fmac_f32 v65, v24, v29
    v_fmac_f32 v66, v24, v30
    v_mfma_f32_16x16x32_bf16 v[104:107], a[76:79], v[44:47], v[104:107]
    v_fmac_f32 v67, v24, v31
    v_fmac_f32 v68, v24, v32
    v_mfma_f32_16x16x32_bf16 v[92:95], a[76:79], v[40:43], v[92:95]
    v_fmac_f32 v69, v24, v33
    v_fmac_f32 v70, v24, v34
    v_mfma_f32_16x16x32_bf16 v[96:99], a[80:83], v[40:43], v[96:99]
    v_fmac_f32 v71, v24, v35
    v_fmac_f32 v72, v24, v36
    v_mfma_f32_16x16x32_bf16 v[108:111], a[80:83], v[44:47], v[108:111]
    v_fmac_f32 v73, v24, v37
    s_waitcnt lgkmcnt(2)
    v_mfma_f32_16x16x32_bf16 v[88:91], a[84:87], v[48:51], v[88:91]
    ds_read2st64_b64 v[40:43], v2 offset0:16 offset1:17
    ds_read2st64_b64 v[44:47], v4 offset0:16 offset1:17
    v_mfma_f32_16x16x32_bf16 v[100:103], a[84:87], v[52:55], v[100:103]
    v_fmac_f32 v74, v24, v38
    v_fmac_f32 v75, v24, v39
    v_mfma_f32_16x16x32_bf16 v[104:107], a[88:91], v[52:55], v[104:107]
    v_fmac_f32 v76, v25, v28
    v_fmac_f32 v77, v25, v29
    v_mfma_f32_16x16x32_bf16 v[92:95], a[88:91], v[48:51], v[92:95]
    v_fmac_f32 v78, v25, v30
    v_fmac_f32 v79, v25, v31
    v_mfma_f32_16x16x32_bf16 v[96:99], a[92:95], v[48:51], v[96:99]
    v_fmac_f32 v80, v25, v32
    v_fmac_f32 v81, v25, v33
    v_mfma_f32_16x16x32_bf16 v[108:111], a[92:95], v[52:55], v[108:111]
    v_fmac_f32 v82, v25, v34
    s_waitcnt lgkmcnt(2)
    v_mfma_f32_16x16x32_bf16 v[88:91], a[96:99], v[56:59], v[88:91]
    v_fmac_f32 v83, v25, v35
    v_fmac_f32 v84, v25, v36
    v_mfma_f32_16x16x32_bf16 v[100:103], a[96:99], v[60:63], v[100:103]
    v_fmac_f32 v85, v25, v37
    v_fmac_f32 v86, v25, v38
    v_mfma_f32_16x16x32_bf16 v[104:107], a[100:103], v[60:63], v[104:107]
    v_fmac_f32 v87, v25, v39
    s_waitcnt vmcnt(7) lgkmcnt(0)
    s_barrier
    v_mfma_f32_16x16x32_bf16 v[92:95], a[100:103], v[56:59], v[92:95]
    ds_read2st64_b64 v[48:51], v1 offset0:40 offset1:41
    s_lshl_b32 s85, s1, 2
    s_add_u32 s85, s85, s62
    v_mfma_f32_16x16x32_bf16 v[96:99], a[104:107], v[56:59], v[96:99]
    ds_read2st64_b64 v[52:55], v3 offset0:40 offset1:41
    s_lshl_b32 s85, s85, 6
    s_add_u32 s85, s85, s75
    v_mfma_f32_16x16x32_bf16 v[108:111], a[104:107], v[60:63], v[108:111]
    v_mfma_f32_16x16x32_bf16 v[88:91], a[108:111], v[40:43], v[88:91]
    ds_read2st64_b64 v[56:59], v1 offset0:44 offset1:45
    ds_read2st64_b64 v[60:63], v3 offset0:44 offset1:45
    v_mfma_f32_16x16x32_bf16 v[100:103], a[108:111], v[44:47], v[100:103]
    v_mov_b32 v37, s68
    s_add_u32 s85, s85, 4096
    v_mfma_f32_16x16x32_bf16 v[104:107], a[112:115], v[44:47], v[104:107]
    s_waitcnt vmcnt(5)
    v_mfma_f32_16x16x32_bf16 v[92:95], a[112:115], v[40:43], v[92:95]
    s_mov_b64 exec, 15
    buffer_store_dword v37, v0, s[8:11], s85 offen sc1
    s_mov_b64 exec, -1
    v_mfma_f32_16x16x32_bf16 v[96:99], a[116:119], v[40:43], v[96:99]
    v_permlane32_swap_b32 v72, v74
    v_mfma_f32_16x16x32_bf16 v[108:111], a[116:119], v[44:47], v[108:111]
    v_permlane32_swap_b32 v73, v75
    s_waitcnt lgkmcnt(2)
    v_mfma_f32_16x16x32_bf16 v[88:91], a[120:123], v[48:51], v[88:91]
    ds_read2st64_b64 v[40:43], v1 offset0:48 offset1:49
    ds_read2st64_b64 v[44:47], v3 offset0:48 offset1:49
    v_mfma_f32_16x16x32_bf16 v[100:103], a[120:123], v[52:55], v[100:103]
    v_max_f32 v64, 0, v64
    v_mul_f32 v68, v26, v68
    v_mfma_f32_16x16x32_bf16 v[104:107], a[124:127], v[52:55], v[104:107]
    v_max_f32 v65, 0, v65
    v_mul_f32 v69, v26, v69
    v_mfma_f32_16x16x32_bf16 v[92:95], a[124:127], v[48:51], v[92:95]
    v_max_f32 v66, 0, v66
    v_mul_f32 v70, v26, v70
    v_mfma_f32_16x16x32_bf16 v[96:99], a[128:131], v[48:51], v[96:99]
    v_max_f32 v67, 0, v67
    v_mul_f32 v71, v26, v71
    v_mfma_f32_16x16x32_bf16 v[108:111], a[128:131], v[52:55], v[108:111]
    v_max_f32 v72, 0, v72
    s_waitcnt lgkmcnt(2)
    v_mfma_f32_16x16x32_bf16 v[88:91], a[132:135], v[56:59], v[88:91]
    ds_read2st64_b64 v[48:51], v1 offset0:52 offset1:53
    ds_read2st64_b64 v[52:55], v3 offset0:52 offset1:53
    v_mfma_f32_16x16x32_bf16 v[100:103], a[132:135], v[60:63], v[100:103]
    v_mul_f32 v74, v26, v74
    v_max_f32 v73, 0, v73
    v_mfma_f32_16x16x32_bf16 v[104:107], a[136:139], v[60:63], v[104:107]
    v_mul_f32 v75, v26, v75
    v_mul_f32 v64, v64, v68
    v_mfma_f32_16x16x32_bf16 v[92:95], a[136:139], v[56:59], v[92:95]
    v_mul_f32 v65, v65, v69
    v_mul_f32 v66, v66, v70
    v_mfma_f32_16x16x32_bf16 v[96:99], a[140:143], v[56:59], v[96:99]
    v_mul_f32 v67, v67, v71
    v_mul_f32 v72, v72, v74
    v_mfma_f32_16x16x32_bf16 v[108:111], a[140:143], v[60:63], v[108:111]
    v_mul_f32 v73, v73, v75
    s_waitcnt lgkmcnt(2)
    v_mfma_f32_16x16x32_bf16 v[88:91], a[144:147], v[40:43], v[88:91]
    ds_read2st64_b64 v[56:59], v1 offset0:56 offset1:57
    ds_read2st64_b64 v[60:63], v3 offset0:56 offset1:57
    v_mfma_f32_16x16x32_bf16 v[100:103], a[144:147], v[44:47], v[100:103]
    v_cvt_pk_bf16_f32 v28, v64, v65
    v_cvt_pk_bf16_f32 v29, v66, v67
    v_mfma_f32_16x16x32_bf16 v[104:107], a[148:151], v[44:47], v[104:107]
    v_cvt_pk_bf16_f32 v32, v72, v73
    v_permlane32_swap_b32 v84, v86
    v_mfma_f32_16x16x32_bf16 v[92:95], a[148:151], v[40:43], v[92:95]
    v_permlane32_swap_b32 v85, v87
    v_mfma_f32_16x16x32_bf16 v[96:99], a[152:155], v[40:43], v[96:99]
    v_max_f32 v76, 0, v76
    v_mul_f32 v80, v27, v80
    v_mfma_f32_16x16x32_bf16 v[108:111], a[152:155], v[44:47], v[108:111]
    v_max_f32 v77, 0, v77
    s_waitcnt lgkmcnt(2)
    v_mfma_f32_16x16x32_bf16 v[88:91], a[156:159], v[48:51], v[88:91]
    ds_read2st64_b64 v[40:43], v2 offset0:40 offset1:41
    ds_read2st64_b64 v[44:47], v4 offset0:40 offset1:41
    v_mfma_f32_16x16x32_bf16 v[100:103], a[156:159], v[52:55], v[100:103]
    v_mul_f32 v81, v27, v81
    v_max_f32 v78, 0, v78
    v_mfma_f32_16x16x32_bf16 v[104:107], a[160:163], v[52:55], v[104:107]
    v_mul_f32 v82, v27, v82
    v_max_f32 v79, 0, v79
    v_mfma_f32_16x16x32_bf16 v[92:95], a[160:163], v[48:51], v[92:95]
    v_mul_f32 v83, v27, v83
    v_max_f32 v84, 0, v84
    v_mfma_f32_16x16x32_bf16 v[96:99], a[164:167], v[48:51], v[96:99]
    v_mul_f32 v86, v27, v86
    v_max_f32 v85, 0, v85
    v_mfma_f32_16x16x32_bf16 v[108:111], a[164:167], v[52:55], v[108:111]
    v_mul_f32 v87, v27, v87
    s_waitcnt lgkmcnt(2)
    v_mfma_f32_16x16x32_bf16 v[88:91], a[168:171], v[56:59], v[88:91]
    ds_read2st64_b64 v[48:51], v2 offset0:44 offset1:45
    ds_read2st64_b64 v[52:55], v4 offset0:44 offset1:45
    v_mfma_f32_16x16x32_bf16 v[100:103], a[168:171], v[60:63], v[100:103]
    v_mul_f32 v76, v76, v80
    v_mul_f32 v77, v77, v81
    v_mfma_f32_16x16x32_bf16 v[104:107], a[172:175], v[60:63], v[104:107]
    v_mul_f32 v78, v78, v82
    v_mul_f32 v79, v79, v83
    v_mfma_f32_16x16x32_bf16 v[92:95], a[172:175], v[56:59], v[92:95]
    v_mul_f32 v84, v84, v86
    v_mul_f32 v85, v85, v87
    v_mfma_f32_16x16x32_bf16 v[96:99], a[176:179], v[56:59], v[96:99]
    v_cvt_pk_bf16_f32 v30, v76, v77
    v_cvt_pk_bf16_f32 v31, v78, v79
    v_mfma_f32_16x16x32_bf16 v[108:111], a[176:179], v[60:63], v[108:111]
    v_cvt_pk_bf16_f32 v33, v84, v85
    s_waitcnt lgkmcnt(2)
    s_waitcnt vmcnt(1)
    v_cmp_ne_u32 vcc, s68, v11
    s_cbranch_vccz L_pd_40
L_pl_39:
    s_cmp_eq_u32 s72, 0
    s_cbranch_scc1 L_pd_40
    s_sub_u32 s72, s72, 1
    buffer_load_dword v11, v0, s[8:11], s91 offen sc1
    s_waitcnt vmcnt(0)
    v_cmp_ne_u32 vcc, s68, v11
    s_cbranch_vccnz L_pl_39
L_pd_40:
    v_bfe_u32 v34, v0, 8, 1
    s_mov_b32 s88, -248
    v_mad_i32_i24 v34, v34, s88, v8
    v_permlane32_swap_b32 v28, v30
    v_permlane32_swap_b32 v29, v31
    v_permlane32_swap_b32 v32, v33
    s_add_u32 s88, s74, 3145728
    s_lshl_b32 s87, s62, 8
    buffer_store_dwordx4 v[28:31], v8, s[8:11], s88 offen sc1
    s_add_u32 s88, s88, 2048
    s_sub_u32 s88, s88, s87
    buffer_store_dwordx2 v[32:33], v34, s[8:11], s88 offen sc1
    v_mfma_f32_16x16x32_bf16 v[88:91], a[180:183], v[40:43], v[88:91]
    ds_read2st64_b64 v[56:59], v2 offset0:48 offset1:49
    ds_read2st64_b64 v[60:63], v4 offset0:48 offset1:49
    v_mfma_f32_16x16x32_bf16 v[100:103], a[180:183], v[44:47], v[100:103]
    s_mul_i32 s92, s66, 98304
    s_mul_i32 s93, s62, 12288
    s_add_u32 s92, s92, s93
    s_mul_i32 s93, s63, 196608
    v_mfma_f32_16x16x32_bf16 v[104:107], a[184:187], v[44:47], v[104:107]
    s_add_u32 s92, s92, s93
    s_add_u32 s92, s92, 22020096
    s_add_u32 s93, s92, 0
    v_mfma_f32_16x16x32_bf16 v[92:95], a[184:187], v[40:43], v[92:95]
    buffer_load_dwordx4 v[64:67], v0, s[8:11], s93 offen offset:0 sc1
    v_mfma_f32_16x16x32_bf16 v[96:99], a[188:191], v[40:43], v[96:99]
    v_mfma_f32_16x16x32_bf16 v[108:111], a[188:191], v[44:47], v[108:111]
    s_waitcnt lgkmcnt(2)
    v_mfma_f32_16x16x32_bf16 v[88:91], a[192:195], v[48:51], v[88:91]
    ds_read2st64_b64 v[40:43], v2 offset0:52 offset1:53
    ds_read2st64_b64 v[44:47], v4 offset0:52 offset1:53
    v_mfma_f32_16x16x32_bf16 v[100:103], a[192:195], v[52:55], v[100:103]
    buffer_load_dwordx4 v[68:71], v0, s[8:11], s93 offen offset:1024 sc1
    v_mfma_f32_16x16x32_bf16 v[104:107], a[196:199], v[52:55], v[104:107]
    v_mfma_f32_16x16x32_bf16 v[92:95], a[196:199], v[48:51], v[92:95]
    v_mfma_f32_16x16x32_bf16 v[96:99], a[200:203], v[48:51], v[96:99]
    v_mfma_f32_16x16x32_bf16 v[108:111], a[200:203], v[52:55], v[108:111]
    s_waitcnt lgkmcnt(2)
    v_mfma_f32_16x16x32_bf16 v[88:91], a[204:207], v[56:59], v[88:91]
    ds_read2st64_b64 v[48:51], v2 offset0:56 offset1:57
    ds_read2st64_b64 v[52:55], v4 offset0:56 offset1:57
    v_mfma_f32_16x16x32_bf16 v[100:103], a[204:207], v[60:63], v[100:103]
    buffer_load_dwordx4 v[72:75], v0, s[8:11], s93 offen offset:2048 sc1
    v_mfma_f32_16x16x32_bf16 v[104:107], a[208:211], v[60:63], v[104:107]
    v_mfma_f32_16x16x32_bf16 v[92:95], a[208:211], v[56:59], v[92:95]
    v_mfma_f32_16x16x32_bf16 v[96:99], a[212:215], v[56:59], v[96:99]
    v_mfma_f32_16x16x32_bf16 v[108:111], a[212:215], v[60:63], v[108:111]
    buffer_load_dwordx4 v[76:79], v0, s[8:11], s93 offen offset:3072 sc1
    s_waitcnt lgkmcnt(2)
    v_mfma_f32_16x16x32_bf16 v[88:91], a[216:219], v[40:43], v[88:91]
    s_add_u32 s93, s92, 4096
    v_mfma_f32_16x16x32_bf16 v[100:103], a[216:219], v[44:47], v[100:103]
    v_mfma_f32_16x16x32_bf16 v[104:107], a[220:223], v[44:47], v[104:107]
    s_waitcnt lgkmcnt(0)
    s_barrier
    v_mfma_f32_16x16x32_bf16 v[92:95], a[220:223], v[40:43], v[92:95]
    v_mfma_f32_16x16x32_bf16 v[96:99], a[224:227], v[40:43], v[96:99]
    buffer_load_dwordx4 v[80:83], v0, s[8:11], s93 offen offset:0 sc1
    v_mfma_f32_16x16x32_bf16 v[108:111], a[224:227], v[44:47], v[108:111]
    v_mfma_f32_16x16x32_bf16 v[88:91], a[228:231], v[48:51], v[88:91]
    v_mfma_f32_16x16x32_bf16 v[100:103], a[228:231], v[52:55], v[100:103]
    v_mfma_f32_16x16x32_bf16 v[104:107], a[232:235], v[52:55], v[104:107]
    buffer_load_dwordx4 v[84:87], v0, s[8:11], s93 offen offset:1024 sc1
    v_mfma_f32_16x16x32_bf16 v[92:95], a[232:235], v[48:51], v[92:95]
    v_mfma_f32_16x16x32_bf16 v[96:99], a[236:239], v[48:51], v[96:99]
    v_mfma_f32_16x16x32_bf16 v[108:111], a[236:239], v[52:55], v[108:111]
    ds_read_b128 v[28:31], v10 offset:0
    ds_read_b128 v[32:35], v10 offset:64
    ds_read_b128 v[36:39], v10 offset:128
    v_add_f32 v16, v16, v18
    v_add_f32 v17, v17, v19
    v_add_f32 v20, v20, v22
    v_add_f32 v21, v21, v23
    v_permlane16_swap_b32 v16, v17
    s_lshl_b32 s91, s63, 4
    s_add_u32 s91, s91, s62
    s_lshl_b32 s91, s91, 10
    s_add_u32 s91, s91, 35917824
    buffer_load_dword v11, v0, s[8:11], s91 offen sc1
    v_permlane16_swap_b32 v20, v21
    v_add_f32 v16, v16, v17
    v_mov_b32 v17, v16
    v_add_f32 v20, v20, v21
    v_mov_b32 v21, v20
    v_permlane32_swap_b32 v16, v17
    s_nop 0
    v_permlane32_swap_b32 v20, v21
    v_add_f32 v16, v16, v17
    buffer_load_dwordx4 v[40:43], v0, s[8:11], s93 offen offset:2048 sc1
    v_mov_b32 v17, v16
    v_add_f32 v20, v20, v21
    v_mov_b32 v21, v20
    v_permlane16_swap_b32 v16, v17
    s_nop 0
    v_permlane16_swap_b32 v20, v21
    v_mul_f32 v24, 0xbacccccd, v16
    v_mov_b32 v26, 0x3727c5ac
    v_fmac_f32 v26, 0x3acccccd, v17
    buffer_load_dwordx4 v[44:47], v0, s[8:11], s93 offen offset:3072 sc1
    v_mul_f32 v25, 0xbacccccd, v20
    v_mov_b32 v27, 0x3727c5ac
    v_fmac_f32 v27, 0x3acccccd, v21
    v_fma_f32 v26, -v24, v24, v26
    v_max_f32 v26, 0x3727c5ac, v26
    v_fma_f32 v27, -v25, v25, v27
    v_max_f32 v27, 0x3727c5ac, v27
    v_rcp_f32 v26, v26
    s_add_u32 s93, s92, 8192
    buffer_load_dwordx4 v[48:51], v0, s[8:11], s93 offen offset:0 sc1
    v_rcp_f32 v27, v27
    s_waitcnt lgkmcnt(2)
    v_pk_fma_f32 v[88:89], v[24:25], v[28:29], v[88:89] op_sel:[0,0,0] op_sel_hi:[0,1,1]
    v_pk_fma_f32 v[90:91], v[24:25], v[30:31], v[90:91] op_sel:[0,0,0] op_sel_hi:[0,1,1]
    s_waitcnt lgkmcnt(1)
    v_pk_fma_f32 v[92:93], v[24:25], v[32:33], v[92:93] op_sel:[0,0,0] op_sel_hi:[0,1,1]
    v_pk_fma_f32 v[94:95], v[24:25], v[34:35], v[94:95] op_sel:[0,0,0] op_sel_hi:[0,1,1]
    s_waitcnt lgkmcnt(0)
    v_pk_fma_f32 v[96:97], v[24:25], v[36:37], v[96:97] op_sel:[0,0,0] op_sel_hi:[0,1,1]
    v_pk_fma_f32 v[98:99], v[24:25], v[38:39], v[98:99] op_sel:[0,0,0] op_sel_hi:[0,1,1]
    v_pk_fma_f32 v[100:101], v[24:25], v[28:29], v[100:101] op_sel:[1,0,0] op_sel_hi:[1,1,1]
    buffer_load_dwordx4 v[52:55], v0, s[8:11], s93 offen offset:1024 sc1
    v_pk_fma_f32 v[102:103], v[24:25], v[30:31], v[102:103] op_sel:[1,0,0] op_sel_hi:[1,1,1]
    v_pk_fma_f32 v[104:105], v[24:25], v[32:33], v[104:105] op_sel:[1,0,0] op_sel_hi:[1,1,1]
    v_pk_fma_f32 v[106:107], v[24:25], v[34:35], v[106:107] op_sel:[1,0,0] op_sel_hi:[1,1,1]
    v_pk_fma_f32 v[108:109], v[24:25], v[36:37], v[108:109] op_sel:[1,0,0] op_sel_hi:[1,1,1]
    v_pk_fma_f32 v[110:111], v[24:25], v[38:39], v[110:111] op_sel:[1,0,0] op_sel_hi:[1,1,1]
    s_lshl_b32 s85, s1, 2
    s_add_u32 s85, s85, s62
    s_lshl_b32 s85, s85, 6
    s_add_u32 s85, s85, s75
    buffer_load_dwordx4 v[56:59], v0, s[8:11], s93 offen offset:2048 sc1
    v_mov_b32 v37, s68
    s_add_u32 s85, s85, 8192
    s_waitcnt vmcnt(12)
    s_mov_b64 exec, 15
    buffer_store_dword v37, v0, s[8:11], s85 offen sc1
    s_mov_b64 exec, -1
    v_permlane32_swap_b32 v96, v98
    v_permlane32_swap_b32 v97, v99
    v_pk_mul_f32 v[92:93], v[26:27], v[92:93] op_sel:[0,0] op_sel_hi:[0,1]
    v_pk_mul_f32 v[94:95], v[26:27], v[94:95] op_sel:[0,0] op_sel_hi:[0,1]
    v_pk_mul_f32 v[98:99], v[26:27], v[98:99] op_sel:[0,0] op_sel_hi:[0,1]
    buffer_load_dwordx4 v[60:63], v0, s[8:11], s93 offen offset:3072 sc1
    v_max_f32 v88, 0, v88
    v_max_f32 v89, 0, v89
    v_max_f32 v90, 0, v90
    v_max_f32 v91, 0, v91
    v_max_f32 v96, 0, v96
    v_max_f32 v97, 0, v97
    v_pk_mul_f32 v[88:89], v[88:89], v[92:93]
    v_pk_mul_f32 v[90:91], v[90:91], v[94:95]
    v_pk_mul_f32 v[96:97], v[96:97], v[98:99]
    v_cvt_pk_bf16_f32 v28, v88, v89
    v_cvt_pk_bf16_f32 v29, v90, v91
    v_cvt_pk_bf16_f32 v32, v96, v97
    v_permlane32_swap_b32 v108, v110
    v_permlane32_swap_b32 v109, v111
    v_pk_mul_f32 v[104:105], v[26:27], v[104:105] op_sel:[1,0] op_sel_hi:[1,1]
    v_pk_mul_f32 v[106:107], v[26:27], v[106:107] op_sel:[1,0] op_sel_hi:[1,1]
    v_pk_mul_f32 v[110:111], v[26:27], v[110:111] op_sel:[1,0] op_sel_hi:[1,1]
    v_max_f32 v100, 0, v100
    v_max_f32 v101, 0, v101
    v_max_f32 v102, 0, v102
    v_max_f32 v103, 0, v103
    v_max_f32 v108, 0, v108
    v_max_f32 v109, 0, v109
    v_pk_mul_f32 v[100:101], v[100:101], v[104:105]
    v_pk_mul_f32 v[102:103], v[102:103], v[106:107]
    v_pk_mul_f32 v[108:109], v[108:109], v[110:111]
    v_cvt_pk_bf16_f32 v30, v100, v101
    v_cvt_pk_bf16_f32 v31, v102, v103
    v_cvt_pk_bf16_f32 v33, v108, v109
    v_bfe_u32 v34, v0, 8, 1
    s_mov_b32 s88, -248
    v_mad_i32_i24 v34, v34, s88, v8
    v_permlane32_swap_b32 v28, v30
    v_permlane32_swap_b32 v29, v31
    v_permlane32_swap_b32 v32, v33
    s_add_u32 s88, s74, 3194880
    s_lshl_b32 s87, s62, 8
    buffer_store_dwordx4 v[28:31], v8, s[8:11], s88 offen sc1
    s_add_u32 s88, s88, 2048
    s_sub_u32 s88, s88, s87
    buffer_store_dwordx2 v[32:33], v34, s[8:11], s88 offen sc1
    s_waitcnt vmcnt(9)
    v_cmp_ne_u32 vcc, s68, v11
    s_cbranch_vccz L_pd_42
L_pl_41:
    s_cmp_eq_u32 s72, 0
    s_cbranch_scc1 L_pd_42
    s_sub_u32 s72, s72, 1
    buffer_load_dword v11, v0, s[8:11], s91 offen sc1
    s_waitcnt vmcnt(0)
    v_cmp_ne_u32 vcc, s68, v11
    s_cbranch_vccnz L_pl_41
L_pd_42:
L_g2_1:
    v_mfma_f32_16x16x32_bf16 v[12:15], v[112:115], v[64:67], 0
    v_lshrrev_b32 v1, 8, v0
    v_lshl_add_u32 v1, v1, 6, v0
    v_mfma_f32_16x16x32_bf16 v[16:19], v[116:119], v[64:67], 0
    v_and_b32 v1, 0xf0, v1
    v_and_b32 v8, 0x300, v0
    v_mfma_f32_16x16x32_bf16 v[20:23], v[120:123], v[64:67], 0
    v_or_b32 v1, v1, v8
    s_mul_i32 s87, s62, 10240
    v_mfma_f32_16x16x32_bf16 v[24:27], v[124:127], v[64:67], 0
    v_add_u32 v1, s87, v1
    s_lshr_b32 s87, s62, 1
    s_mul_i32 s87, s87, 5120
    v_mfma_f32_16x16x32_bf16 v[28:31], v[128:131], v[64:67], 0
    v_bfe_u32 v8, v0, 4, 2
    v_mfma_f32_16x16x32_bf16 v[12:15], v[132:135], v[68:71], v[12:15]
    v_lshrrev_b32 v10, 7, v0
    s_lshl_b32 s89, s69, 3
    v_mfma_f32_16x16x32_bf16 v[16:19], v[136:139], v[68:71], v[16:19]
    s_add_u32 s93, s92, 49152
    buffer_load_dwordx4 v[64:67], v0, s[8:11], s93 offen offset:0 sc1
    v_mfma_f32_16x16x32_bf16 v[20:23], v[140:143], v[68:71], v[20:23]
    v_add_u32 v10, s89, v10
    v_lshl_add_u32 v10, v8, 2, v10
    v_mfma_f32_16x16x32_bf16 v[24:27], v[144:147], v[68:71], v[24:27]
    v_and_b32 v10, 15, v10
    v_lshl_add_u32 v8, v8, 4, v10
    v_mfma_f32_16x16x32_bf16 v[28:31], v[148:151], v[68:71], v[28:31]
    v_lshlrev_b32 v8, 4, v8
    v_mfma_f32_16x16x32_bf16 v[12:15], v[152:155], v[72:75], v[12:15]
    v_bfe_u32 v10, v0, 6, 1
    v_lshl_add_u32 v8, v10, 10, v8
    v_mfma_f32_16x16x32_bf16 v[16:19], v[156:159], v[72:75], v[16:19]
    buffer_load_dwordx4 v[68:71], v0, s[8:11], s93 offen offset:1024 sc1
    v_add_u32 v8, s87, v8
    v_mfma_f32_16x16x32_bf16 v[20:23], v[160:163], v[72:75], v[20:23]
    v_lshrrev_b32 v3, 7, v0
    v_mul_u32_u24 v2, 1280, v3
    v_mfma_f32_16x16x32_bf16 v[24:27], v[164:167], v[72:75], v[24:27]
    v_mul_u32_u24 v3, 160, v3
    v_and_b32 v10, 0x70, v0
    v_mfma_f32_16x16x32_bf16 v[28:31], v[168:171], v[72:75], v[28:31]
    v_lshrrev_b32 v10, 1, v10
    v_mfma_f32_16x16x32_bf16 v[12:15], v[172:175], v[76:79], v[12:15]
    s_mul_i32 s87, s62, 1280
    s_add_u32 s87, s87, 61440
    v_add3_u32 v3, v3, v10, s87
    v_mfma_f32_16x16x32_bf16 v[16:19], v[176:179], v[76:79], v[16:19]
    buffer_load_dwordx4 v[72:75], v0, s[8:11], s93 offen offset:2048 sc1
    v_add_u32 v2, v2, v10
    v_mfma_f32_16x16x32_bf16 v[20:23], v[180:183], v[76:79], v[20:23]
    s_mul_i32 s99, s63, 81920
    s_mul_i32 s87, s66, 40960
    s_add_u32 s99, s99, s87
    s_mul_i32 s87, s62, 10240
    v_mfma_f32_16x16x32_bf16 v[24:27], v[184:187], v[76:79], v[24:27]
    s_add_u32 s99, s99, s87
    s_mul_i32 s87, s65, 160
    s_add_u32 s99, s99, s87
    v_mfma_f32_16x16x32_bf16 v[28:31], v[188:191], v[76:79], v[28:31]
    s_mov_b32 s88, 0x0f0f0f0f
    s_mov_b32 s89, 0x0f0f0f0f
    v_mfma_f32_16x16x32_bf16 v[12:15], v[192:195], v[80:83], v[12:15]
    v_mfma_f32_16x16x32_bf16 v[16:19], v[196:199], v[80:83], v[16:19]
    buffer_load_dwordx4 v[76:79], v0, s[8:11], s93 offen offset:3072 sc1
    v_mfma_f32_16x16x32_bf16 v[20:23], v[200:203], v[80:83], v[20:23]
    v_mfma_f32_16x16x32_bf16 v[24:27], v[204:207], v[80:83], v[24:27]
    v_mfma_f32_16x16x32_bf16 v[28:31], v[208:211], v[80:83], v[28:31]
    v_mfma_f32_16x16x32_bf16 v[12:15], v[212:215], v[84:87], v[12:15]
    v_mfma_f32_16x16x32_bf16 v[16:19], v[216:219], v[84:87], v[16:19]
    s_add_u32 s93, s92, 53248
    buffer_load_dwordx4 v[80:83], v0, s[8:11], s93 offen offset:0 sc1
    v_mfma_f32_16x16x32_bf16 v[20:23], v[220:223], v[84:87], v[20:23]
    v_mfma_f32_16x16x32_bf16 v[24:27], v[224:227], v[84:87], v[24:27]
    v_mfma_f32_16x16x32_bf16 v[28:31], v[228:231], v[84:87], v[28:31]
    s_waitcnt vmcnt(13)
    v_mfma_f32_16x16x32_bf16 v[12:15], v[232:235], v[40:43], v[12:15]
    v_mfma_f32_16x16x32_bf16 v[16:19], v[236:239], v[40:43], v[16:19]
    buffer_load_dwordx4 v[84:87], v0, s[8:11], s93 offen offset:1024 sc1
    v_mfma_f32_16x16x32_bf16 v[20:23], v[240:243], v[40:43], v[20:23]
    v_mfma_f32_16x16x32_bf16 v[24:27], v[244:247], v[40:43], v[24:27]
    ds_read_b128 v[88:91], v9 offset:0
    v_mfma_f32_16x16x32_bf16 v[28:31], v[248:251], v[40:43], v[28:31]
    ds_read_b128 v[92:95], v9 offset:1024
    s_waitcnt vmcnt(13)
    v_mfma_f32_16x16x32_bf16 v[12:15], a[240:243], v[44:47], v[12:15]
    ds_read_b128 v[96:99], v9 offset:2048
    v_mfma_f32_16x16x32_bf16 v[16:19], a[244:247], v[44:47], v[16:19]
    ds_read_b128 v[100:103], v9 offset:3072
    buffer_load_dwordx4 v[40:43], v0, s[8:11], s93 offen offset:2048 sc1
    v_mfma_f32_16x16x32_bf16 v[20:23], a[248:251], v[44:47], v[20:23]
    ds_read_b128 v[104:107], v9 offset:4096
    v_mfma_f32_16x16x32_bf16 v[24:27], a[252:255], v[44:47], v[24:27]
    ds_read_b128 v[32:35], v9 offset:5120
    v_mfma_f32_16x16x32_bf16 v[28:31], v[252:255], v[44:47], v[28:31]
    ds_read_b128 v[36:39], v9 offset:6144
    s_waitcnt vmcnt(13)
    s_waitcnt lgkmcnt(5)
    v_mfma_f32_16x16x32_bf16 v[12:15], v[88:91], v[48:51], v[12:15]
    ds_read_b128 v[108:111], v9 offset:7168
    v_mfma_f32_16x16x32_bf16 v[16:19], v[92:95], v[48:51], v[16:19]
    ds_read_b128 v[88:91], v9 offset:8192
    buffer_load_dwordx4 v[44:47], v0, s[8:11], s93 offen offset:3072 sc1
    s_waitcnt lgkmcnt(5)
    v_mfma_f32_16x16x32_bf16 v[20:23], v[96:99], v[48:51], v[20:23]
    ds_read_b128 v[92:95], v9 offset:9216
    v_mfma_f32_16x16x32_bf16 v[24:27], v[100:103], v[48:51], v[24:27]
    ds_read_b128 v[96:99], v9 offset:10240
    s_waitcnt lgkmcnt(5)
    v_mfma_f32_16x16x32_bf16 v[28:31], v[104:107], v[48:51], v[28:31]
    ds_read_b128 v[100:103], v9 offset:11264
    s_waitcnt vmcnt(13)
    v_mfma_f32_16x16x32_bf16 v[12:15], v[32:35], v[52:55], v[12:15]
    ds_read_b128 v[104:107], v9 offset:12288
    s_waitcnt lgkmcnt(5)
    v_mfma_f32_16x16x32_bf16 v[16:19], v[36:39], v[52:55], v[16:19]
    ds_read_b128 v[32:35], v9 offset:13312
    s_add_u32 s93, s92, 57344
    buffer_load_dwordx4 v[48:51], v0, s[8:11], s93 offen offset:0 sc1
    v_mfma_f32_16x16x32_bf16 v[20:23], v[108:111], v[52:55], v[20:23]
    ds_read_b128 v[36:39], v9 offset:14336
    s_waitcnt lgkmcnt(5)
    v_mfma_f32_16x16x32_bf16 v[24:27], v[88:91], v[52:55], v[24:27]
    ds_read_b128 v[108:111], v9 offset:15360
    v_mfma_f32_16x16x32_bf16 v[28:31], v[92:95], v[52:55], v[28:31]
    ds_read_b128 v[88:91], v9 offset:16384
    s_waitcnt vmcnt(13)
    s_waitcnt lgkmcnt(5)
    v_mfma_f32_16x16x32_bf16 v[12:15], v[96:99], v[56:59], v[12:15]
    ds_read_b128 v[92:95], v9 offset:17408
    s_lshl_b32 s85, s1, 2
    s_add_u32 s85, s85, s62
    v_mfma_f32_16x16x32_bf16 v[16:19], v[100:103], v[56:59], v[16:19]
    ds_read_b128 v[96:99], v9 offset:18432
    buffer_load_dwordx4 v[52:55], v0, s[8:11], s93 offen offset:1024 sc1
    s_waitcnt lgkmcnt(5)
    v_mfma_f32_16x16x32_bf16 v[20:23], v[104:107], v[56:59], v[20:23]
    ds_read_b128 v[100:103], v9 offset:19456
    s_lshl_b32 s85, s85, 6
    s_add_u32 s85, s85, s75
    v_mfma_f32_16x16x32_bf16 v[24:27], v[32:35], v[56:59], v[24:27]
    s_waitcnt lgkmcnt(4)
    v_mfma_f32_16x16x32_bf16 v[28:31], v[36:39], v[56:59], v[28:31]
    s_waitcnt vmcnt(12)
    v_mfma_f32_16x16x32_bf16 v[12:15], v[108:111], v[60:63], v[12:15]
    s_waitcnt lgkmcnt(2)
    v_mfma_f32_16x16x32_bf16 v[16:19], v[88:91], v[60:63], v[16:19]
    buffer_load_dwordx4 v[56:59], v0, s[8:11], s93 offen offset:2048 sc1
    v_mfma_f32_16x16x32_bf16 v[20:23], v[92:95], v[60:63], v[20:23]
    s_waitcnt lgkmcnt(0)
    v_mfma_f32_16x16x32_bf16 v[24:27], v[96:99], v[60:63], v[24:27]
    v_mov_b32 v11, s68
    s_add_u32 s85, s85, 12288
    v_mfma_f32_16x16x32_bf16 v[28:31], v[100:103], v[60:63], v[28:31]
    s_waitcnt vmcnt(11)
    s_mov_b64 exec, 15
    buffer_store_dword v11, v0, s[8:11], s85 offen sc1
    s_mov_b64 exec, -1
    buffer_load_dwordx4 v[60:63], v0, s[8:11], s93 offen offset:3072 sc1
    s_barrier
    s_waitcnt vmcnt(12)
    v_mfma_f32_16x16x32_bf16 v[88:91], v[112:115], v[64:67], 0
    ds_write_b128 v1, v[12:15] offset:0
    ds_write_b128 v1, v[16:19] offset:1024
    v_mfma_f32_16x16x32_bf16 v[92:95], v[116:119], v[64:67], 0
    ds_write_b128 v1, v[20:23] offset:2048
    ds_write_b128 v1, v[24:27] offset:3072
    v_mfma_f32_16x16x32_bf16 v[96:99], v[120:123], v[64:67], 0
    ds_write_b128 v1, v[28:31] offset:4096
    v_mfma_f32_16x16x32_bf16 v[100:103], v[124:127], v[64:67], 0
    v_mfma_f32_16x16x32_bf16 v[104:107], v[128:131], v[64:67], 0
    s_waitcnt vmcnt(11)
    v_mfma_f32_16x16x32_bf16 v[88:91], v[132:135], v[68:71], v[88:91]
    v_mfma_f32_16x16x32_bf16 v[92:95], v[136:139], v[68:71], v[92:95]
    v_mfma_f32_16x16x32_bf16 v[96:99], v[140:143], v[68:71], v[96:99]
    v_mfma_f32_16x16x32_bf16 v[100:103], v[144:147], v[68:71], v[100:103]
    v_mfma_f32_16x16x32_bf16 v[104:107], v[148:151], v[68:71], v[104:107]
    s_waitcnt vmcnt(10)
    v_mfma_f32_16x16x32_bf16 v[88:91], v[152:155], v[72:75], v[88:91]
    v_mfma_f32_16x16x32_bf16 v[92:95], v[156:159], v[72:75], v[92:95]
    v_mfma_f32_16x16x32_bf16 v[96:99], v[160:163], v[72:75], v[96:99]
    v_mfma_f32_16x16x32_bf16 v[100:103], v[164:167], v[72:75], v[100:103]
    v_mfma_f32_16x16x32_bf16 v[104:107], v[168:171], v[72:75], v[104:107]
    s_waitcnt vmcnt(9)
    v_mfma_f32_16x16x32_bf16 v[88:91], v[172:175], v[76:79], v[88:91]
    s_lshl_b32 s91, s63, 4
    s_add_u32 s91, s91, s62
    s_lshl_b32 s91, s91, 10
    s_add_u32 s91, s91, 35921920
    v_mfma_f32_16x16x32_bf16 v[92:95], v[176:179], v[76:79], v[92:95]
    buffer_load_dword v11, v0, s[8:11], s91 offen sc1
    ds_read_b64 v[64:65], v3 offset:0
    v_mfma_f32_16x16x32_bf16 v[96:99], v[180:183], v[76:79], v[96:99]
    ds_read_b64 v[68:69], v3 offset:64
    ds_read_b64 v[72:73], v3 offset:128
    v_mfma_f32_16x16x32_bf16 v[100:103], v[184:187], v[76:79], v[100:103]
    v_mfma_f32_16x16x32_bf16 v[104:107], v[188:191], v[76:79], v[104:107]
    s_waitcnt vmcnt(9)
    v_mfma_f32_16x16x32_bf16 v[88:91], v[192:195], v[80:83], v[88:91]
    v_mfma_f32_16x16x32_bf16 v[92:95], v[196:199], v[80:83], v[92:95]
    v_mfma_f32_16x16x32_bf16 v[96:99], v[200:203], v[80:83], v[96:99]
    s_waitcnt lgkmcnt(2)
    v_and_b32 v67, s70, v65
    v_lshlrev_b32 v66, 16, v65
    v_mfma_f32_16x16x32_bf16 v[100:103], v[204:207], v[80:83], v[100:103]
    v_and_b32 v65, s70, v64
    v_lshlrev_b32 v64, 16, v64
    v_mfma_f32_16x16x32_bf16 v[104:107], v[208:211], v[80:83], v[104:107]
    s_waitcnt lgkmcnt(1)
    v_and_b32 v71, s70, v69
    s_waitcnt vmcnt(8)
    v_mfma_f32_16x16x32_bf16 v[88:91], v[212:215], v[84:87], v[88:91]
    v_lshlrev_b32 v70, 16, v69
    v_and_b32 v69, s70, v68
    v_mfma_f32_16x16x32_bf16 v[92:95], v[216:219], v[84:87], v[92:95]
    v_lshlrev_b32 v68, 16, v68
    s_waitcnt lgkmcnt(0)
    v_and_b32 v75, s70, v73
    v_mfma_f32_16x16x32_bf16 v[96:99], v[220:223], v[84:87], v[96:99]
    v_lshlrev_b32 v74, 16, v73
    v_and_b32 v73, s70, v72
    v_mfma_f32_16x16x32_bf16 v[100:103], v[224:227], v[84:87], v[100:103]
    v_lshlrev_b32 v72, 16, v72
    v_mfma_f32_16x16x32_bf16 v[104:107], v[228:231], v[84:87], v[104:107]
    s_waitcnt vmcnt(7)
    v_mfma_f32_16x16x32_bf16 v[88:91], v[232:235], v[40:43], v[88:91]
    v_mfma_f32_16x16x32_bf16 v[92:95], v[236:239], v[40:43], v[92:95]
    v_mfma_f32_16x16x32_bf16 v[96:99], v[240:243], v[40:43], v[96:99]
    v_mfma_f32_16x16x32_bf16 v[100:103], v[244:247], v[40:43], v[100:103]
    ds_read_b128 v[12:15], v9 offset:0
    v_mfma_f32_16x16x32_bf16 v[104:107], v[248:251], v[40:43], v[104:107]
    ds_read_b128 v[16:19], v9 offset:1024
    s_waitcnt vmcnt(6)
    v_mfma_f32_16x16x32_bf16 v[88:91], a[240:243], v[44:47], v[88:91]
    ds_read_b128 v[20:23], v9 offset:2048
    v_mfma_f32_16x16x32_bf16 v[92:95], a[244:247], v[44:47], v[92:95]
    ds_read_b128 v[24:27], v9 offset:3072
    v_mfma_f32_16x16x32_bf16 v[96:99], a[248:251], v[44:47], v[96:99]
    ds_read_b128 v[28:31], v9 offset:4096
    v_mfma_f32_16x16x32_bf16 v[100:103], a[252:255], v[44:47], v[100:103]
    ds_read_b128 v[32:35], v9 offset:5120
    v_mfma_f32_16x16x32_bf16 v[104:107], v[252:255], v[44:47], v[104:107]
    ds_read_b128 v[36:39], v9 offset:10240
    s_waitcnt vmcnt(5)
    s_waitcnt lgkmcnt(5)
    v_mfma_f32_16x16x32_bf16 v[88:91], v[12:15], v[48:51], v[88:91]
    ds_read_b128 v[108:111], v9 offset:15360
    v_mfma_f32_16x16x32_bf16 v[92:95], v[16:19], v[48:51], v[92:95]
    ds_read_b128 v[12:15], v9 offset:6144
    s_waitcnt lgkmcnt(5)
    v_mfma_f32_16x16x32_bf16 v[96:99], v[20:23], v[48:51], v[96:99]
    ds_read_b128 v[16:19], v9 offset:11264
    v_mfma_f32_16x16x32_bf16 v[100:103], v[24:27], v[48:51], v[100:103]
    ds_read_b128 v[20:23], v9 offset:16384
    s_waitcnt lgkmcnt(5)
    v_mfma_f32_16x16x32_bf16 v[104:107], v[28:31], v[48:51], v[104:107]
    ds_read_b128 v[24:27], v9 offset:7168
    s_waitcnt vmcnt(1)
    v_mfma_f32_16x16x32_bf16 v[88:91], v[32:35], v[52:55], v[88:91]
    ds_read_b128 v[28:31], v9 offset:12288
    s_waitcnt lgkmcnt(5)
    v_mfma_f32_16x16x32_bf16 v[88:91], v[36:39], v[56:59], v[88:91]
    ds_read_b128 v[32:35], v9 offset:17408
    v_mfma_f32_16x16x32_bf16 v[88:91], v[108:111], v[60:63], v[88:91]
    ds_read_b128 v[36:39], v9 offset:8192
    s_waitcnt lgkmcnt(5)
    v_mfma_f32_16x16x32_bf16 v[92:95], v[12:15], v[52:55], v[92:95]
    ds_read_b128 v[108:111], v9 offset:13312
    v_mfma_f32_16x16x32_bf16 v[92:95], v[16:19], v[56:59], v[92:95]
    ds_read_b128 v[12:15], v9 offset:18432
    s_waitcnt lgkmcnt(5)
    v_mfma_f32_16x16x32_bf16 v[92:95], v[20:23], v[60:63], v[92:95]
    ds_read_b128 v[16:19], v9 offset:9216
    v_mfma_f32_16x16x32_bf16 v[96:99], v[24:27], v[52:55], v[96:99]
    ds_read_b128 v[20:23], v9 offset:14336
    ds_write_b128 v1, v[88:91] offset:5120
    s_waitcnt lgkmcnt(6)
    v_mfma_f32_16x16x32_bf16 v[96:99], v[28:31], v[56:59], v[96:99]
    ds_read_b128 v[24:27], v9 offset:19456
    v_mfma_f32_16x16x32_bf16 v[96:99], v[32:35], v[60:63], v[96:99]
    s_waitcnt lgkmcnt(5)
    v_mfma_f32_16x16x32_bf16 v[100:103], v[36:39], v[52:55], v[100:103]
    ds_write_b128 v1, v[92:95] offset:6144
    v_mfma_f32_16x16x32_bf16 v[100:103], v[108:111], v[56:59], v[100:103]
    s_waitcnt lgkmcnt(4)
    v_mfma_f32_16x16x32_bf16 v[100:103], v[12:15], v[60:63], v[100:103]
    v_mfma_f32_16x16x32_bf16 v[104:107], v[16:19], v[52:55], v[104:107]
    s_nop 0
    ds_write_b128 v1, v[96:99] offset:7168
    s_waitcnt lgkmcnt(2)
    v_mfma_f32_16x16x32_bf16 v[104:107], v[20:23], v[56:59], v[104:107]
    v_mfma_f32_16x16x32_bf16 v[104:107], v[24:27], v[60:63], v[104:107]
    s_waitcnt vmcnt(0)
    v_cmp_ne_u32 vcc, s68, v11
    s_cbranch_vccz L_pd_44
L_pl_43:
    s_cmp_eq_u32 s72, 0
    s_cbranch_scc1 L_pd_44
    s_sub_u32 s72, s72, 1
    buffer_load_dword v11, v0, s[8:11], s91 offen sc1
    s_waitcnt vmcnt(0)
    v_cmp_ne_u32 vcc, s68, v11
    s_cbranch_vccnz L_pl_43
L_pd_44:
    s_add_u32 s93, s92, 3145728
    buffer_load_dwordx4 v[76:79], v0, s[8:11], s93 offen offset:0 sc1
    ds_write_b128 v1, v[100:103] offset:8192
    buffer_load_dwordx4 v[80:83], v0, s[8:11], s93 offen offset:1024 sc1
    ds_write_b128 v1, v[104:107] offset:9216
    buffer_load_dwordx4 v[84:87], v0, s[8:11], s93 offen offset:2048 sc1
    s_waitcnt lgkmcnt(0)
    s_barrier
    ds_read_b128 v[12:15], v8 offset:0
    ds_read_b128 v[16:19], v8 offset:2048
    s_mov_b64 exec, s[88:89]
    ds_read_b128 v[20:23], v8 offset:4096
    s_mov_b64 exec, -1
    ds_read_b128 v[88:91], v8 offset:10240
    buffer_load_dwordx4 v[40:43], v0, s[8:11], s93 offen offset:3072 sc1
    ds_read_b128 v[92:95], v8 offset:12288
    s_mov_b64 exec, s[88:89]
    ds_read_b128 v[96:99], v8 offset:14336
    s_mov_b64 exec, -1
    ds_read_b128 v[100:103], v8 offset:20480
    ds_read_b128 v[104:107], v8 offset:22528
    s_add_u32 s93, s92, 3149824
    buffer_load_dwordx4 v[44:47], v0, s[8:11], s93 offen offset:0 sc1
    s_mov_b64 exec, s[88:89]
    ds_read_b128 v[108:111], v8 offset:24576
    s_mov_b64 exec, -1
    ds_read_b128 v[24:27], v8 offset:30720
    ds_read_b128 v[28:31], v8 offset:32768
    s_mov_b64 exec, s[88:89]
    ds_read_b128 v[32:35], v8 offset:34816
    s_mov_b64 exec, -1
    buffer_load_dwordx4 v[48:51], v0, s[8:11], s93 offen offset:1024 sc1
    s_waitcnt lgkmcnt(11)
    v_pk_add_f32 v[12:13], v[12:13], v[64:65]
    v_pk_add_f32 v[14:15], v[14:15], v[66:67]
    s_waitcnt lgkmcnt(10)
    v_pk_add_f32 v[16:17], v[16:17], v[68:69]
    v_pk_add_f32 v[18:19], v[18:19], v[70:71]
    s_waitcnt lgkmcnt(9)
    v_pk_add_f32 v[20:21], v[20:21], v[72:73]
    v_pk_add_f32 v[22:23], v[22:23], v[74:75]
    buffer_load_dwordx4 v[52:55], v0, s[8:11], s93 offen offset:2048 sc1
    s_waitcnt lgkmcnt(8)
    v_pk_add_f32 v[12:13], v[12:13], v[88:89]
    v_pk_add_f32 v[14:15], v[14:15], v[90:91]
    s_waitcnt lgkmcnt(7)
    v_pk_add_f32 v[16:17], v[16:17], v[92:93]
    v_pk_add_f32 v[18:19], v[18:19], v[94:95]
    s_waitcnt lgkmcnt(6)
    v_pk_add_f32 v[20:21], v[20:21], v[96:97]
    v_pk_add_f32 v[22:23], v[22:23], v[98:99]
    s_lshl_b32 s91, s63, 4
    s_add_u32 s91, s91, s62
    s_lshl_b32 s91, s91, 10
    s_add_u32 s91, s91, 35926016
    buffer_load_dword v11, v0, s[8:11], s91 offen sc1
    s_waitcnt lgkmcnt(5)
    v_pk_add_f32 v[12:13], v[12:13], v[100:101]
    v_pk_add_f32 v[14:15], v[14:15], v[102:103]
    s_waitcnt lgkmcnt(4)
    v_pk_add_f32 v[16:17], v[16:17], v[104:105]
    v_pk_add_f32 v[18:19], v[18:19], v[106:107]
    s_waitcnt lgkmcnt(3)
    v_pk_add_f32 v[20:21], v[20:21], v[108:109]
    v_pk_add_f32 v[22:23], v[22:23], v[110:111]
    buffer_load_dwordx4 v[56:59], v0, s[8:11], s93 offen offset:3072 sc1
    s_waitcnt lgkmcnt(2)
    v_pk_add_f32 v[12:13], v[12:13], v[24:25]
    v_pk_add_f32 v[14:15], v[14:15], v[26:27]
    s_waitcnt lgkmcnt(1)
    v_pk_add_f32 v[16:17], v[16:17], v[28:29]
    v_pk_add_f32 v[18:19], v[18:19], v[30:31]
    s_waitcnt lgkmcnt(0)
    v_pk_add_f32 v[20:21], v[20:21], v[32:33]
    v_pk_add_f32 v[22:23], v[22:23], v[34:35]
    s_add_u32 s93, s92, 3153920
    buffer_load_dwordx4 v[60:63], v0, s[8:11], s93 offen offset:0 sc1
    v_cvt_pk_bf16_f32 v24, v12, v13
    v_cvt_pk_bf16_f32 v25, v14, v15
    buffer_store_dwordx2 v[24:25], v2, s[28:31], s99 offen offset:0
    v_cvt_pk_bf16_f32 v26, v16, v17
    v_cvt_pk_bf16_f32 v27, v18, v19
    buffer_store_dwordx2 v[26:27], v2, s[28:31], s99 offen offset:64
    buffer_load_dwordx4 v[64:67], v0, s[8:11], s93 offen offset:1024 sc1
    v_cvt_pk_bf16_f32 v28, v20, v21
    v_cvt_pk_bf16_f32 v29, v22, v23
    s_mov_b64 exec, s[88:89]
    buffer_store_dwordx2 v[28:29], v2, s[28:31], s99 offen offset:128
    s_mov_b64 exec, -1
    buffer_load_dwordx4 v[68:71], v0, s[8:11], s93 offen offset:2048 sc1
    buffer_load_dwordx4 v[72:75], v0, s[8:11], s93 offen offset:3072 sc1
    s_waitcnt vmcnt(15)
    v_mfma_f32_16x16x32_bf16 v[12:15], v[112:115], v[76:79], 0
    v_mfma_f32_16x16x32_bf16 v[16:19], v[116:119], v[76:79], 0
    v_mfma_f32_16x16x32_bf16 v[20:23], v[120:123], v[76:79], 0
    v_mfma_f32_16x16x32_bf16 v[24:27], v[124:127], v[76:79], 0
    v_mfma_f32_16x16x32_bf16 v[28:31], v[128:131], v[76:79], 0
    s_waitcnt vmcnt(14)
    v_mfma_f32_16x16x32_bf16 v[12:15], v[132:135], v[80:83], v[12:15]
    v_mfma_f32_16x16x32_bf16 v[16:19], v[136:139], v[80:83], v[16:19]
    v_mfma_f32_16x16x32_bf16 v[20:23], v[140:143], v[80:83], v[20:23]
    v_mfma_f32_16x16x32_bf16 v[24:27], v[144:147], v[80:83], v[24:27]
    v_mfma_f32_16x16x32_bf16 v[28:31], v[148:151], v[80:83], v[28:31]
    s_waitcnt vmcnt(8)
    v_cmp_ne_u32 vcc, s68, v11
    s_cbranch_vccz L_pd_46
L_pl_45:
    s_cmp_eq_u32 s72, 0
    s_cbranch_scc1 L_pd_46
    s_sub_u32 s72, s72, 1
    buffer_load_dword v11, v0, s[8:11], s91 offen sc1
    s_waitcnt vmcnt(0)
    v_cmp_ne_u32 vcc, s68, v11
    s_cbranch_vccnz L_pl_45
L_pd_46:
    v_mfma_f32_16x16x32_bf16 v[12:15], v[152:155], v[84:87], v[12:15]
    v_mfma_f32_16x16x32_bf16 v[16:19], v[156:159], v[84:87], v[16:19]
    s_add_u32 s93, s92, 3194880
    buffer_load_dwordx4 v[76:79], v0, s[8:11], s93 offen offset:0 sc1
    v_mfma_f32_16x16x32_bf16 v[20:23], v[160:163], v[84:87], v[20:23]
    v_mfma_f32_16x16x32_bf16 v[24:27], v[164:167], v[84:87], v[24:27]
    v_mfma_f32_16x16x32_bf16 v[28:31], v[168:171], v[84:87], v[28:31]
    v_mfma_f32_16x16x32_bf16 v[12:15], v[172:175], v[40:43], v[12:15]
    v_mfma_f32_16x16x32_bf16 v[16:19], v[176:179], v[40:43], v[16:19]
    buffer_load_dwordx4 v[80:83], v0, s[8:11], s93 offen offset:1024 sc1
    v_mfma_f32_16x16x32_bf16 v[20:23], v[180:183], v[40:43], v[20:23]
    v_mfma_f32_16x16x32_bf16 v[24:27], v[184:187], v[40:43], v[24:27]
    v_mfma_f32_16x16x32_bf16 v[28:31], v[188:191], v[40:43], v[28:31]
    v_mfma_f32_16x16x32_bf16 v[12:15], v[192:195], v[44:47], v[12:15]
    v_mfma_f32_16x16x32_bf16 v[16:19], v[196:199], v[44:47], v[16:19]
    buffer_load_dwordx4 v[84:87], v0, s[8:11], s93 offen offset:2048 sc1
    v_mfma_f32_16x16x32_bf16 v[20:23], v[200:203], v[44:47], v[20:23]
    v_mfma_f32_16x16x32_bf16 v[24:27], v[204:207], v[44:47], v[24:27]
    v_mfma_f32_16x16x32_bf16 v[28:31], v[208:211], v[44:47], v[28:31]
    v_mfma_f32_16x16x32_bf16 v[12:15], v[212:215], v[48:51], v[12:15]
    v_mfma_f32_16x16x32_bf16 v[16:19], v[216:219], v[48:51], v[16:19]
    buffer_load_dwordx4 v[40:43], v0, s[8:11], s93 offen offset:3072 sc1
    v_mfma_f32_16x16x32_bf16 v[20:23], v[220:223], v[48:51], v[20:23]
    v_mfma_f32_16x16x32_bf16 v[24:27], v[224:227], v[48:51], v[24:27]
    v_mfma_f32_16x16x32_bf16 v[28:31], v[228:231], v[48:51], v[28:31]
    v_mfma_f32_16x16x32_bf16 v[12:15], v[232:235], v[52:55], v[12:15]
    v_mfma_f32_16x16x32_bf16 v[16:19], v[236:239], v[52:55], v[16:19]
    s_add_u32 s93, s92, 3198976
    buffer_load_dwordx4 v[44:47], v0, s[8:11], s93 offen offset:0 sc1
    v_mfma_f32_16x16x32_bf16 v[20:23], v[240:243], v[52:55], v[20:23]
    v_mfma_f32_16x16x32_bf16 v[24:27], v[244:247], v[52:55], v[24:27]
    ds_read_b128 v[88:91], v9 offset:0
    v_mfma_f32_16x16x32_bf16 v[28:31], v[248:251], v[52:55], v[28:31]
    ds_read_b128 v[92:95], v9 offset:1024
    s_waitcnt vmcnt(12)
    v_mfma_f32_16x16x32_bf16 v[12:15], a[240:243], v[56:59], v[12:15]
    ds_read_b128 v[96:99], v9 offset:2048
    v_mfma_f32_16x16x32_bf16 v[16:19], a[244:247], v[56:59], v[16:19]
    ds_read_b128 v[100:103], v9 offset:3072
    buffer_load_dwordx4 v[48:51], v0, s[8:11], s93 offen offset:1024 sc1
    v_mfma_f32_16x16x32_bf16 v[20:23], a[248:251], v[56:59], v[20:23]
    ds_read_b128 v[104:107], v9 offset:4096
    v_mfma_f32_16x16x32_bf16 v[24:27], a[252:255], v[56:59], v[24:27]
    ds_read_b128 v[32:35], v9 offset:5120
    v_mfma_f32_16x16x32_bf16 v[28:31], v[252:255], v[56:59], v[28:31]
    ds_read_b128 v[36:39], v9 offset:6144
    s_waitcnt vmcnt(12)
    s_waitcnt lgkmcnt(5)
    v_mfma_f32_16x16x32_bf16 v[12:15], v[88:91], v[60:63], v[12:15]
    ds_read_b128 v[108:111], v9 offset:7168
    v_mfma_f32_16x16x32_bf16 v[16:19], v[92:95], v[60:63], v[16:19]
    ds_read_b128 v[88:91], v9 offset:8192
    buffer_load_dwordx4 v[52:55], v0, s[8:11], s93 offen offset:2048 sc1
    s_waitcnt lgkmcnt(5)
    v_mfma_f32_16x16x32_bf16 v[20:23], v[96:99], v[60:63], v[20:23]
    ds_read_b128 v[92:95], v9 offset:9216
    v_mfma_f32_16x16x32_bf16 v[24:27], v[100:103], v[60:63], v[24:27]
    ds_read_b128 v[96:99], v9 offset:10240
    s_waitcnt lgkmcnt(5)
    v_mfma_f32_16x16x32_bf16 v[28:31], v[104:107], v[60:63], v[28:31]
    ds_read_b128 v[100:103], v9 offset:11264
    s_waitcnt vmcnt(10)
    v_mfma_f32_16x16x32_bf16 v[12:15], v[32:35], v[64:67], v[12:15]
    ds_read_b128 v[104:107], v9 offset:12288
    s_waitcnt lgkmcnt(5)
    v_mfma_f32_16x16x32_bf16 v[16:19], v[36:39], v[64:67], v[16:19]
    ds_read_b128 v[32:35], v9 offset:13312
    buffer_load_dwordx4 v[56:59], v0, s[8:11], s93 offen offset:3072 sc1
    v_mfma_f32_16x16x32_bf16 v[20:23], v[108:111], v[64:67], v[20:23]
    ds_read_b128 v[36:39], v9 offset:14336
    s_waitcnt lgkmcnt(5)
    v_mfma_f32_16x16x32_bf16 v[24:27], v[88:91], v[64:67], v[24:27]
    ds_read_b128 v[108:111], v9 offset:15360
    v_mfma_f32_16x16x32_bf16 v[28:31], v[92:95], v[64:67], v[28:31]
    ds_read_b128 v[88:91], v9 offset:16384
    s_waitcnt vmcnt(9)
    s_waitcnt lgkmcnt(5)
    v_mfma_f32_16x16x32_bf16 v[12:15], v[96:99], v[68:71], v[12:15]
    ds_read_b128 v[92:95], v9 offset:17408
    v_mfma_f32_16x16x32_bf16 v[16:19], v[100:103], v[68:71], v[16:19]
    ds_read_b128 v[96:99], v9 offset:18432
    s_add_u32 s93, s92, 3203072
    buffer_load_dwordx4 v[60:63], v0, s[8:11], s93 offen offset:0 sc1
    s_waitcnt lgkmcnt(5)
    v_mfma_f32_16x16x32_bf16 v[20:23], v[104:107], v[68:71], v[20:23]
    ds_read_b128 v[100:103], v9 offset:19456
    v_mfma_f32_16x16x32_bf16 v[24:27], v[32:35], v[68:71], v[24:27]
    s_waitcnt lgkmcnt(4)
    v_mfma_f32_16x16x32_bf16 v[28:31], v[36:39], v[68:71], v[28:31]
    s_waitcnt vmcnt(9)
    v_mfma_f32_16x16x32_bf16 v[12:15], v[108:111], v[72:75], v[12:15]
    s_waitcnt lgkmcnt(2)
    v_mfma_f32_16x16x32_bf16 v[16:19], v[88:91], v[72:75], v[16:19]
    buffer_load_dwordx4 v[64:67], v0, s[8:11], s93 offen offset:1024 sc1
    v_mfma_f32_16x16x32_bf16 v[20:23], v[92:95], v[72:75], v[20:23]
    s_waitcnt lgkmcnt(0)
    v_mfma_f32_16x16x32_bf16 v[24:27], v[96:99], v[72:75], v[24:27]
    v_mfma_f32_16x16x32_bf16 v[28:31], v[100:103], v[72:75], v[28:31]
    buffer_load_dwordx4 v[68:71], v0, s[8:11], s93 offen offset:2048 sc1
    buffer_load_dwordx4 v[72:75], v0, s[8:11], s93 offen offset:3072 sc1
    s_barrier
    s_waitcnt vmcnt(11)
    v_mfma_f32_16x16x32_bf16 v[88:91], v[112:115], v[76:79], 0
    ds_write_b128 v1, v[12:15] offset:0
    ds_write_b128 v1, v[16:19] offset:1024
    v_mfma_f32_16x16x32_bf16 v[92:95], v[116:119], v[76:79], 0
    ds_write_b128 v1, v[20:23] offset:2048
    ds_write_b128 v1, v[24:27] offset:3072
    v_mfma_f32_16x16x32_bf16 v[96:99], v[120:123], v[76:79], 0
    ds_write_b128 v1, v[28:31] offset:4096
    v_mfma_f32_16x16x32_bf16 v[100:103], v[124:127], v[76:79], 0
    v_mfma_f32_16x16x32_bf16 v[104:107], v[128:131], v[76:79], 0
    s_waitcnt vmcnt(10)
    v_mfma_f32_16x16x32_bf16 v[88:91], v[132:135], v[80:83], v[88:91]
    v_mfma_f32_16x16x32_bf16 v[92:95], v[136:139], v[80:83], v[92:95]
    v_mfma_f32_16x16x32_bf16 v[96:99], v[140:143], v[80:83], v[96:99]
    v_mfma_f32_16x16x32_bf16 v[100:103], v[144:147], v[80:83], v[100:103]
    v_mfma_f32_16x16x32_bf16 v[104:107], v[148:151], v[80:83], v[104:107]
    s_waitcnt vmcnt(9)
    v_mfma_f32_16x16x32_bf16 v[88:91], v[152:155], v[84:87], v[88:91]
    v_mfma_f32_16x16x32_bf16 v[92:95], v[156:159], v[84:87], v[92:95]
    v_mfma_f32_16x16x32_bf16 v[96:99], v[160:163], v[84:87], v[96:99]
    v_mfma_f32_16x16x32_bf16 v[100:103], v[164:167], v[84:87], v[100:103]
    v_mfma_f32_16x16x32_bf16 v[104:107], v[168:171], v[84:87], v[104:107]
    s_waitcnt vmcnt(8)
    v_mfma_f32_16x16x32_bf16 v[88:91], v[172:175], v[40:43], v[88:91]
    ds_read_b64 v[76:77], v3 offset:5120
    ds_read_b64 v[80:81], v3 offset:5184
    v_mfma_f32_16x16x32_bf16 v[92:95], v[176:179], v[40:43], v[92:95]
    ds_read_b64 v[84:85], v3 offset:5248
    v_mfma_f32_16x16x32_bf16 v[96:99], v[180:183], v[40:43], v[96:99]
    v_mfma_f32_16x16x32_bf16 v[100:103], v[184:187], v[40:43], v[100:103]
    v_mfma_f32_16x16x32_bf16 v[104:107], v[188:191], v[40:43], v[104:107]
    s_waitcnt vmcnt(7)
    v_mfma_f32_16x16x32_bf16 v[88:91], v[192:195], v[44:47], v[88:91]
    v_mfma_f32_16x16x32_bf16 v[92:95], v[196:199], v[44:47], v[92:95]
    s_waitcnt lgkmcnt(2)
    v_and_b32 v79, s70, v77
    v_lshlrev_b32 v78, 16, v77
    v_mfma_f32_16x16x32_bf16 v[96:99], v[200:203], v[44:47], v[96:99]
    v_and_b32 v77, s70, v76
    v_lshlrev_b32 v76, 16, v76
    v_mfma_f32_16x16x32_bf16 v[100:103], v[204:207], v[44:47], v[100:103]
    s_waitcnt lgkmcnt(1)
    v_and_b32 v83, s70, v81
    v_lshlrev_b32 v82, 16, v81
    v_mfma_f32_16x16x32_bf16 v[104:107], v[208:211], v[44:47], v[104:107]
    v_and_b32 v81, s70, v80
    s_waitcnt vmcnt(6)
    v_mfma_f32_16x16x32_bf16 v[88:91], v[212:215], v[48:51], v[88:91]
    v_lshlrev_b32 v80, 16, v80
    s_waitcnt lgkmcnt(0)
    v_and_b32 v87, s70, v85
    v_mfma_f32_16x16x32_bf16 v[92:95], v[216:219], v[48:51], v[92:95]
    v_lshlrev_b32 v86, 16, v85
    v_and_b32 v85, s70, v84
    v_mfma_f32_16x16x32_bf16 v[96:99], v[220:223], v[48:51], v[96:99]
    v_lshlrev_b32 v84, 16, v84
    v_mfma_f32_16x16x32_bf16 v[100:103], v[224:227], v[48:51], v[100:103]
    v_mfma_f32_16x16x32_bf16 v[104:107], v[228:231], v[48:51], v[104:107]
    s_waitcnt vmcnt(5)
    v_mfma_f32_16x16x32_bf16 v[88:91], v[232:235], v[52:55], v[88:91]
    v_mfma_f32_16x16x32_bf16 v[92:95], v[236:239], v[52:55], v[92:95]
    v_mfma_f32_16x16x32_bf16 v[96:99], v[240:243], v[52:55], v[96:99]
    v_mfma_f32_16x16x32_bf16 v[100:103], v[244:247], v[52:55], v[100:103]
    ds_read_b128 v[12:15], v9 offset:0
    v_mfma_f32_16x16x32_bf16 v[104:107], v[248:251], v[52:55], v[104:107]
    ds_read_b128 v[16:19], v9 offset:1024
    s_waitcnt vmcnt(4)
    v_mfma_f32_16x16x32_bf16 v[88:91], a[240:243], v[56:59], v[88:91]
    ds_read_b128 v[20:23], v9 offset:2048
    v_mfma_f32_16x16x32_bf16 v[92:95], a[244:247], v[56:59], v[92:95]
    ds_read_b128 v[24:27], v9 offset:3072
    v_mfma_f32_16x16x32_bf16 v[96:99], a[248:251], v[56:59], v[96:99]
    ds_read_b128 v[28:31], v9 offset:4096
    v_mfma_f32_16x16x32_bf16 v[100:103], a[252:255], v[56:59], v[100:103]
    ds_read_b128 v[32:35], v9 offset:5120
    v_mfma_f32_16x16x32_bf16 v[104:107], v[252:255], v[56:59], v[104:107]
    ds_read_b128 v[36:39], v9 offset:10240
    s_waitcnt vmcnt(3)
    s_waitcnt lgkmcnt(5)
    v_mfma_f32_16x16x32_bf16 v[88:91], v[12:15], v[60:63], v[88:91]
    ds_read_b128 v[108:111], v9 offset:15360
    v_mfma_f32_16x16x32_bf16 v[92:95], v[16:19], v[60:63], v[92:95]
    ds_read_b128 v[12:15], v9 offset:6144
    s_waitcnt lgkmcnt(5)
    v_mfma_f32_16x16x32_bf16 v[96:99], v[20:23], v[60:63], v[96:99]
    ds_read_b128 v[16:19], v9 offset:11264
    v_mfma_f32_16x16x32_bf16 v[100:103], v[24:27], v[60:63], v[100:103]
    ds_read_b128 v[20:23], v9 offset:16384
    s_waitcnt lgkmcnt(5)
    v_mfma_f32_16x16x32_bf16 v[104:107], v[28:31], v[60:63], v[104:107]
    ds_read_b128 v[24:27], v9 offset:7168
    s_waitcnt vmcnt(0)
    v_mfma_f32_16x16x32_bf16 v[88:91], v[32:35], v[64:67], v[88:91]
    ds_read_b128 v[28:31], v9 offset:12288
    s_waitcnt lgkmcnt(5)
    v_mfma_f32_16x16x32_bf16 v[88:91], v[36:39], v[68:71], v[88:91]
    ds_read_b128 v[32:35], v9 offset:17408
    v_mfma_f32_16x16x32_bf16 v[88:91], v[108:111], v[72:75], v[88:91]
    ds_read_b128 v[36:39], v9 offset:8192
    s_waitcnt lgkmcnt(5)
    v_mfma_f32_16x16x32_bf16 v[92:95], v[12:15], v[64:67], v[92:95]
    ds_read_b128 v[108:111], v9 offset:13312
    v_mfma_f32_16x16x32_bf16 v[92:95], v[16:19], v[68:71], v[92:95]
    ds_read_b128 v[12:15], v9 offset:18432
    s_waitcnt lgkmcnt(5)
    v_mfma_f32_16x16x32_bf16 v[92:95], v[20:23], v[72:75], v[92:95]
    ds_read_b128 v[16:19], v9 offset:9216
    v_mfma_f32_16x16x32_bf16 v[96:99], v[24:27], v[64:67], v[96:99]
    ds_read_b128 v[20:23], v9 offset:14336
    ds_write_b128 v1, v[88:91] offset:5120
    s_waitcnt lgkmcnt(6)
    v_mfma_f32_16x16x32_bf16 v[96:99], v[28:31], v[68:71], v[96:99]
    ds_read_b128 v[24:27], v9 offset:19456
    v_mfma_f32_16x16x32_bf16 v[96:99], v[32:35], v[72:75], v[96:99]
    s_waitcnt lgkmcnt(5)
    v_mfma_f32_16x16x32_bf16 v[100:103], v[36:39], v[64:67], v[100:103]
    ds_write_b128 v1, v[92:95] offset:6144
    v_mfma_f32_16x16x32_bf16 v[100:103], v[108:111], v[68:71], v[100:103]
    s_waitcnt lgkmcnt(4)
    v_mfma_f32_16x16x32_bf16 v[100:103], v[12:15], v[72:75], v[100:103]
    v_mfma_f32_16x16x32_bf16 v[104:107], v[16:19], v[64:67], v[104:107]
    s_nop 0
    ds_write_b128 v1, v[96:99] offset:7168
    s_waitcnt lgkmcnt(2)
    v_mfma_f32_16x16x32_bf16 v[104:107], v[20:23], v[68:71], v[104:107]
    v_mfma_f32_16x16x32_bf16 v[104:107], v[24:27], v[72:75], v[104:107]
    s_nop 1
    ds_write_b128 v1, v[100:103] offset:8192
    s_nop 4
    ds_write_b128 v1, v[104:107] offset:9216
    s_waitcnt lgkmcnt(0)
    s_barrier
    ds_read_b128 v[12:15], v8 offset:0
    ds_read_b128 v[16:19], v8 offset:2048
    s_mov_b64 exec, s[88:89]
    ds_read_b128 v[20:23], v8 offset:4096
    s_mov_b64 exec, -1
    ds_read_b128 v[88:91], v8 offset:10240
    ds_read_b128 v[92:95], v8 offset:12288
    s_mov_b64 exec, s[88:89]
    ds_read_b128 v[96:99], v8 offset:14336
    s_mov_b64 exec, -1
    ds_read_b128 v[100:103], v8 offset:20480
    ds_read_b128 v[104:107], v8 offset:22528
    s_mov_b64 exec, s[88:89]
    ds_read_b128 v[108:111], v8 offset:24576
    s_mov_b64 exec, -1
    ds_read_b128 v[24:27], v8 offset:30720
    ds_read_b128 v[28:31], v8 offset:32768
    s_mov_b64 exec, s[88:89]
    ds_read_b128 v[32:35], v8 offset:34816
    s_mov_b64 exec, -1
    s_waitcnt lgkmcnt(11)
    v_pk_add_f32 v[12:13], v[12:13], v[76:77]
    v_pk_add_f32 v[14:15], v[14:15], v[78:79]
    s_waitcnt lgkmcnt(10)
    v_pk_add_f32 v[16:17], v[16:17], v[80:81]
    v_pk_add_f32 v[18:19], v[18:19], v[82:83]
    s_waitcnt lgkmcnt(9)
    v_pk_add_f32 v[20:21], v[20:21], v[84:85]
    v_pk_add_f32 v[22:23], v[22:23], v[86:87]
    s_waitcnt lgkmcnt(8)
    v_pk_add_f32 v[12:13], v[12:13], v[88:89]
    v_pk_add_f32 v[14:15], v[14:15], v[90:91]
    s_waitcnt lgkmcnt(7)
    v_pk_add_f32 v[16:17], v[16:17], v[92:93]
    v_pk_add_f32 v[18:19], v[18:19], v[94:95]
    s_waitcnt lgkmcnt(6)
    v_pk_add_f32 v[20:21], v[20:21], v[96:97]
    v_pk_add_f32 v[22:23], v[22:23], v[98:99]
    s_waitcnt lgkmcnt(5)
    v_pk_add_f32 v[12:13], v[12:13], v[100:101]
    v_pk_add_f32 v[14:15], v[14:15], v[102:103]
    s_waitcnt lgkmcnt(4)
    v_pk_add_f32 v[16:17], v[16:17], v[104:105]
    v_pk_add_f32 v[18:19], v[18:19], v[106:107]
    s_waitcnt lgkmcnt(3)
    v_pk_add_f32 v[20:21], v[20:21], v[108:109]
    v_pk_add_f32 v[22:23], v[22:23], v[110:111]
    s_waitcnt lgkmcnt(2)
    v_pk_add_f32 v[12:13], v[12:13], v[24:25]
    v_pk_add_f32 v[14:15], v[14:15], v[26:27]
    s_waitcnt lgkmcnt(1)
    v_pk_add_f32 v[16:17], v[16:17], v[28:29]
    v_pk_add_f32 v[18:19], v[18:19], v[30:31]
    s_waitcnt lgkmcnt(0)
    v_pk_add_f32 v[20:21], v[20:21], v[32:33]
    v_pk_add_f32 v[22:23], v[22:23], v[34:35]
    s_add_u32 s99, s99, 1310720
    v_cvt_pk_bf16_f32 v24, v12, v13
    v_cvt_pk_bf16_f32 v25, v14, v15
    buffer_store_dwordx2 v[24:25], v2, s[28:31], s99 offen offset:0
    v_cvt_pk_bf16_f32 v26, v16, v17
    v_cvt_pk_bf16_f32 v27, v18, v19
    buffer_store_dwordx2 v[26:27], v2, s[28:31], s99 offen offset:64
    v_cvt_pk_bf16_f32 v28, v20, v21
    v_cvt_pk_bf16_f32 v29, v22, v23
    s_mov_b64 exec, s[88:89]
    buffer_store_dwordx2 v[28:29], v2, s[28:31], s99 offen offset:128
    s_mov_b64 exec, -1
L_exit:
    s_endpgm
L_other:
    s_cmp_lt_u32 s87, 2
    s_cbranch_scc1 L_stats
    s_add_u32 s87, s87, 6
L_p0:
    s_mov_b32 s93, s87
    s_cmp_ge_u32 s87, 5
    s_cselect_b32 s89, 1, 0
    s_mul_i32 s90, s89, 5
    s_lshl_b32 s88, s86, 1
    s_sub_u32 s86, s87, s90
    s_add_u32 s87, s88, s89
    s_lshl_b32 s88, s86, 4
    s_add_u32 s88, s88, s87
    v_lshrrev_b32 v1, 8, v0
    v_bfe_u32 v3, v0, 5, 3
    v_xor_b32 v3, v3, v1
    v_and_b32 v4, 16, v0
    v_mul_u32_u24 v1, 1280, v1
    s_mul_i32 s89, s87, 163840
    s_lshl_b32 s90, s86, 8
    s_add_u32 s89, s89, s90
    s_mul_i32 s90, s62, 5120
    s_add_u32 s89, s89, s90
    v_add3_u32 v1, v1, v4, s89
    s_lshr_b32 s90, s62, 1
    s_lshl_b32 s90, s90, 2
    v_xor_b32 v3, s90, v3
    v_lshl_add_u32 v7, v3, 5, v1
    s_lshl_b32 s91, s62, 10
    v_bfe_u32 v1, v0, 6, 2
    v_lshrrev_b32 v6, 8, v0
    v_lshl_add_u32 v3, v6, 3, v1
    v_lshlrev_b32 v3, 8, v3
    v_bfe_u32 v4, v0, 4, 2
    v_lshl_add_u32 v3, v4, 3, v3
    v_and_b32 v4, 1, v6
    v_lshl_or_b32 v1, v4, 2, v1
    s_lshl_b32 s90, s62, 1
    v_xor_b32 v1, s90, v1
    v_lshl_add_u32 v4, v1, 5, v3
    v_xor_b32 v5, 32, v4
    v_bfe_u32 v8, v0, 4, 3
    s_lshl_b32 s90, s86, 7
    s_lshl_b32 s89, s62, 5
    s_add_u32 s90, s90, s89
    v_add_u32 v8, s90, v8
    v_lshlrev_b32 v8, 12, v8
    v_lshl_add_u32 v8, v6, 4, v8
    v_bfe_u32 v1, v0, 7, 1
    v_lshl_add_u32 v8, v1, 6, v8
    s_lshl_b32 s90, s87, 8
    v_add_u32 v8, s90, v8
    s_waitcnt lgkmcnt(0)
    s_mov_b32 s72, 60000
    s_mov_b32 s70, 0xffff0000
    s_mov_b32 s82, 1120
    s_cmp_eq_u32 s62, 0
    s_cselect_b32 s83, 0, 36175872
    s_lshr_b32 s65, s2, 5
    s_and_b32 s66, s2, 1
    s_lshl_b32 s64, s66, 3
    s_add_u32 s64, s64, s65
    s_bfe_u32 s63, s2, 0x20001
    s_lshl_b32 s63, s63, 2
    s_bfe_u32 s85, s2, 0x20003
    s_add_u32 s63, s63, s85
    s_and_b32 s1, s2, 3
    s_lshl_b32 s1, s1, 2
    s_bfe_u32 s84, s2, 0x20005
    s_add_u32 s1, s1, s84
    s_bfe_u32 s3, s2, 0x10002
    s_lshl_b32 s3, s3, 1
    s_lshr_b32 s84, s2, 7
    s_add_u32 s3, s3, s84
    s_lshl_b32 s3, s3, 2
    s_add_u32 s3, s3, s85
    s_mov_b32 s8, s60
    s_mov_b32 s9, s61
    s_mov_b32 s10, 36175872
    s_mov_b32 s11, 0x20000
    s_cmp_lt_u32 s62, 2
    s_cselect_b32 s20, s50, s52
    s_cselect_b32 s21, s51, s53
    s_mov_b32 s22, 1966080
    s_mov_b32 s23, 0x20000
    s_mov_b32 s24, s54
    s_mov_b32 s25, s55
    s_mov_b32 s26, 1966080
    s_mov_b32 s27, 0x20000
    s_mov_b32 s28, s56
    s_mov_b32 s29, s57
    s_mov_b32 s30, 2621440
    s_mov_b32 s31, 0x20000
    v_lshrrev_b32 v240, 4, v0
    v_add_u32 v240, 0, v240
    v_mul_u32_u24 v245, 43691, v240
    v_lshrrev_b32 v245, 19, v245
    v_mul_u32_u24 v246, 12, v245
    v_sub_u32 v240, v240, v246
    v_bfe_u32 v246, v245, 2, 1
    v_xor_b32 v240, v240, v246
    v_lshlrev_b32 v240, 4, v240
    v_mul_u32_u24 v245, 3072, v245
    v_add_u32 v240, v240, v245
    v_lshrrev_b32 v241, 4, v0
    v_add_u32 v241, 64, v241
    v_mul_u32_u24 v245, 43691, v241
    v_lshrrev_b32 v245, 19, v245
    v_mul_u32_u24 v246, 12, v245
    v_sub_u32 v241, v241, v246
    v_bfe_u32 v246, v245, 2, 1
    v_xor_b32 v241, v241, v246
    v_lshlrev_b32 v241, 4, v241
    v_mul_u32_u24 v245, 3072, v245
    v_add_u32 v241, v241, v245
    v_subrev_u32 v241, 1024, v241
    v_lshrrev_b32 v242, 4, v0
    v_add_u32 v242, 128, v242
    v_mul_u32_u24 v245, 43691, v242
    v_lshrrev_b32 v245, 19, v245
    v_mul_u32_u24 v246, 12, v245
    v_sub_u32 v242, v242, v246
    v_bfe_u32 v246, v245, 2, 1
    v_xor_b32 v242, v242, v246
    v_lshlrev_b32 v242, 4, v242
    v_mul_u32_u24 v245, 3072, v245
    v_add_u32 v242, v242, v245
    v_subrev_u32 v242, 2048, v242
    s_mul_i32 s84, s69, 49152
    s_mul_i32 s85, s1, 192
    s_add_u32 s98, s84, s85
    s_mul_i32 s99, s62, 3072
    s_add_u32 s99, s99, 84992
    s_and_b32 s92, s2, 7
    s_mul_i32 s92, s92, 10
    s_add_u32 s92, s92, s93
    s_mul_i32 s94, s92, 13108
    s_lshr_b32 s94, s94, 16
    s_mul_i32 s93, s94, 5
    s_sub_u32 s93, s92, s93
    s_mov_b32 s12, s36
    s_mov_b32 s13, s37
    s_mov_b32 s14, 2621440
    s_mov_b32 s15, 0x20000
    s_add_u32 m0, s91, 0
    s_mov_b32 s90, 0
    buffer_load_dwordx4 v7, s[12:15], s90 offen lds
    s_add_u32 m0, s91, 4096
    s_mov_b32 s90, 20480
    buffer_load_dwordx4 v7, s[12:15], s90 offen lds
    s_add_u32 m0, s91, 8192
    s_mov_b32 s90, 40960
    buffer_load_dwordx4 v7, s[12:15], s90 offen lds
    s_add_u32 m0, s91, 12288
    s_mov_b32 s90, 61440
    buffer_load_dwordx4 v7, s[12:15], s90 offen lds
    s_add_u32 m0, s91, 16384
    s_mov_b32 s90, 81920
    buffer_load_dwordx4 v7, s[12:15], s90 offen lds
    s_add_u32 m0, s91, 20480
    s_mov_b32 s90, 102400
    buffer_load_dwordx4 v7, s[12:15], s90 offen lds
    s_add_u32 m0, s91, 24576
    s_mov_b32 s90, 122880
    buffer_load_dwordx4 v7, s[12:15], s90 offen lds
    s_add_u32 m0, s91, 28672
    s_mov_b32 s90, 143360
    buffer_load_dwordx4 v7, s[12:15], s90 offen lds
    s_bfe_u32 s84, s2, 0x20003
    s_lshr_b32 s90, s2, 5
    s_add_u32 s85, s90, 8
    s_cmp_eq_u32 s84, 3
    s_cselect_b32 s90, s90, s85
    s_lshl_b32 s90, s90, 1
    s_add_u32 s90, s90, s69
    s_add_u32 s90, s90, 0
    s_mul_i32 s90, s90, 3072
    s_and_b32 s84, s2, 3
    s_mul_i32 s84, s84, 768
    s_add_u32 s90, s90, s84
    v_lshrrev_b32 v248, 4, v0
    v_add_u32 v248, 0, v248
    v_mul_u32_u24 v249, 43691, v248
    v_lshrrev_b32 v249, 18, v249
    v_mul_u32_u24 v250, 6, v249
    v_sub_u32 v248, v248, v250
    v_lshlrev_b32 v248, 7, v248
    v_mul_u32_u24 v249, 73728, v249
    v_add_u32 v248, v248, v249
    s_mov_b32 exec_hi, 0xf
    buffer_load_dword v252, v248, s[20:23], s90 offen
    s_mov_b64 exec, -1
    v_lshrrev_b32 v245, 6, v0
    v_mul_u32_u24 v245, 192, v245
    v_add_u32 v245, 84992, v245
    v_bfe_u32 v246, v0, 8, 1
    v_bfe_u32 v249, v0, 4, 1
    v_bfe_u32 v250, v0, 5, 1
    s_lshr_b32 s84, s62, 1
    s_lshl_b32 s85, s84, 2
    s_add_u32 s85, s85, s69
    v_lshl_add_u32 v243, v250, 1, s85
    v_xor_b32 v243, v243, v246
    v_lshlrev_b32 v243, 4, v243
    v_lshl_add_u32 v243, v249, 3, v243
    v_add_u32 v243, v243, v245
    s_add_u32 s84, s84, 8
    v_lshl_add_u32 v244, v249, 1, s84
    v_xor_b32 v244, v244, v246
    v_lshlrev_b32 v244, 4, v244
    s_lshl_b32 s85, s69, 3
    v_add_u32 v244, s85, v244
    v_mul_u32_u24 v250, 6144, v250
    v_add3_u32 v244, v244, v250, v245
    s_mul_i32 s84, s69, 12288
    s_sub_u32 s85, 12288, s84
    v_add_u32 v245, s85, v243
    v_add_u32 v243, s84, v243
    v_add_u32 v246, s85, v244
    v_add_u32 v244, s84, v244
    v_mov_b32 v12, 0x3f803f80
    v_mov_b32 v13, 0x3f803f80
    v_mov_b32 v14, 0x3f803f80
    v_mov_b32 v15, 0x3f803f80
    s_waitcnt vmcnt(1)
    s_barrier
    ds_read_b64_tr_b16 v[24:25], v4 offset:0
    ds_read_b64_tr_b16 v[26:27], v4 offset:1024
    ds_read_b64_tr_b16 v[28:29], v4 offset:8192
    ds_read_b64_tr_b16 v[30:31], v4 offset:9216
    ds_read_b64_tr_b16 v[32:33], v4 offset:16384
    ds_read_b64_tr_b16 v[34:35], v4 offset:17408
    ds_read_b64_tr_b16 v[36:37], v4 offset:24576
    ds_read_b64_tr_b16 v[38:39], v4 offset:25600
    ds_read_b64_tr_b16 v[40:41], v5 offset:0
    ds_read_b64_tr_b16 v[42:43], v5 offset:1024
    ds_read_b64_tr_b16 v[44:45], v5 offset:8192
    ds_read_b64_tr_b16 v[46:47], v5 offset:9216
    ds_read_b64_tr_b16 v[48:49], v5 offset:16384
    ds_read_b64_tr_b16 v[50:51], v5 offset:17408
    ds_read_b64_tr_b16 v[52:53], v5 offset:24576
    ds_read_b64_tr_b16 v[54:55], v5 offset:25600
    s_waitcnt lgkmcnt(15)
    v_mov_b32 v112, v24
    v_mov_b32 v113, v25
    s_waitcnt lgkmcnt(14)
    v_mov_b32 v114, v26
    v_mov_b32 v115, v27
    s_waitcnt lgkmcnt(13)
    v_mov_b32_dpp v24, v28 row_ror:8 row_mask:0xf bank_mask:0xc
    v_mov_b32_dpp v25, v29 row_ror:8 row_mask:0xf bank_mask:0xc
    s_waitcnt lgkmcnt(12)
    v_mov_b32_dpp v26, v30 row_ror:8 row_mask:0xf bank_mask:0xc
    v_mov_b32_dpp v27, v31 row_ror:8 row_mask:0xf bank_mask:0xc
    v_mov_b32_dpp v28, v112 row_ror:8 row_mask:0xf bank_mask:0x3
    v_mov_b32_dpp v29, v113 row_ror:8 row_mask:0xf bank_mask:0x3
    v_mov_b32_dpp v30, v114 row_ror:8 row_mask:0xf bank_mask:0x3
    v_mov_b32_dpp v31, v115 row_ror:8 row_mask:0xf bank_mask:0x3
    s_mov_b32 s90, 2621440
    buffer_store_dwordx4 v[24:27], v8, s[8:11], s90 offen offset:0 sc1
    s_mov_b32 s90, 2654208
    buffer_store_dwordx4 v[28:31], v8, s[8:11], s90 offen offset:0 sc1
    s_waitcnt lgkmcnt(11)
    v_mov_b32 v112, v32
    v_mov_b32 v113, v33
    s_waitcnt lgkmcnt(10)
    v_mov_b32 v114, v34
    v_mov_b32 v115, v35
    s_waitcnt lgkmcnt(9)
    v_mov_b32_dpp v32, v36 row_ror:8 row_mask:0xf bank_mask:0xc
    v_mov_b32_dpp v33, v37 row_ror:8 row_mask:0xf bank_mask:0xc
    s_waitcnt lgkmcnt(8)
    v_mov_b32_dpp v34, v38 row_ror:8 row_mask:0xf bank_mask:0xc
    v_mov_b32_dpp v35, v39 row_ror:8 row_mask:0xf bank_mask:0xc
    v_mov_b32_dpp v36, v112 row_ror:8 row_mask:0xf bank_mask:0x3
    v_mov_b32_dpp v37, v113 row_ror:8 row_mask:0xf bank_mask:0x3
    v_mov_b32_dpp v38, v114 row_ror:8 row_mask:0xf bank_mask:0x3
    v_mov_b32_dpp v39, v115 row_ror:8 row_mask:0xf bank_mask:0x3
    s_mov_b32 s90, 2621440
    buffer_store_dwordx4 v[32:35], v8, s[8:11], s90 offen offset:128 sc1
    s_mov_b32 s90, 2654208
    buffer_store_dwordx4 v[36:39], v8, s[8:11], s90 offen offset:128 sc1
    s_waitcnt lgkmcnt(7)
    v_mov_b32 v112, v40
    v_mov_b32 v113, v41
    s_waitcnt lgkmcnt(6)
    v_mov_b32 v114, v42
    v_mov_b32 v115, v43
    s_waitcnt lgkmcnt(5)
    v_mov_b32_dpp v40, v44 row_ror:8 row_mask:0xf bank_mask:0xc
    v_mov_b32_dpp v41, v45 row_ror:8 row_mask:0xf bank_mask:0xc
    s_waitcnt lgkmcnt(4)
    v_mov_b32_dpp v42, v46 row_ror:8 row_mask:0xf bank_mask:0xc
    v_mov_b32_dpp v43, v47 row_ror:8 row_mask:0xf bank_mask:0xc
    v_mov_b32_dpp v44, v112 row_ror:8 row_mask:0xf bank_mask:0x3
    v_mov_b32_dpp v45, v113 row_ror:8 row_mask:0xf bank_mask:0x3
    v_mov_b32_dpp v46, v114 row_ror:8 row_mask:0xf bank_mask:0x3
    v_mov_b32_dpp v47, v115 row_ror:8 row_mask:0xf bank_mask:0x3
    s_mov_b32 s90, 2686976
    buffer_store_dwordx4 v[40:43], v8, s[8:11], s90 offen offset:0 sc1
    s_mov_b32 s90, 2719744
    buffer_store_dwordx4 v[44:47], v8, s[8:11], s90 offen offset:0 sc1
    s_waitcnt lgkmcnt(3)
    v_mov_b32 v112, v48
    v_mov_b32 v113, v49
    s_waitcnt lgkmcnt(2)
    v_mov_b32 v114, v50
    v_mov_b32 v115, v51
    s_waitcnt lgkmcnt(1)
    v_mov_b32_dpp v48, v52 row_ror:8 row_mask:0xf bank_mask:0xc
    v_mov_b32_dpp v49, v53 row_ror:8 row_mask:0xf bank_mask:0xc
    s_waitcnt lgkmcnt(0)
    v_mov_b32_dpp v50, v54 row_ror:8 row_mask:0xf bank_mask:0xc
    v_mov_b32_dpp v51, v55 row_ror:8 row_mask:0xf bank_mask:0xc
    v_mov_b32_dpp v52, v112 row_ror:8 row_mask:0xf bank_mask:0x3
    v_mov_b32_dpp v53, v113 row_ror:8 row_mask:0xf bank_mask:0x3
    v_mov_b32_dpp v54, v114 row_ror:8 row_mask:0xf bank_mask:0x3
    v_mov_b32_dpp v55, v115 row_ror:8 row_mask:0xf bank_mask:0x3
    s_mov_b32 s90, 2686976
    buffer_store_dwordx4 v[48:51], v8, s[8:11], s90 offen offset:128 sc1
    s_mov_b32 s90, 2719744
    buffer_store_dwordx4 v[52:55], v8, s[8:11], s90 offen offset:128 sc1
    s_mov_b32 s16, s58
    s_mov_b32 s17, s59
    s_mov_b32 s18, 256
    s_mov_b32 s19, 0x20000
    v_mov_b32 v251, 0
    buffer_load_dword v11, v251, s[16:19], 0 offen sc1
    s_mul_i32 s92, s69, 49152
    s_mul_i32 s85, s94, 192
    s_add_u32 s92, s92, s85
    s_mul_i32 s85, s93, 196608
    s_add_u32 s92, s92, s85
    s_mul_i32 s85, s62, 3072
    s_add_u32 s84, s92, 983040
    s_add_u32 m0, s85, 32768
    s_nop 0
    buffer_load_dwordx4 v240, s[20:23], s84 offen offset:0 lds
    buffer_load_dwordx4 v241, s[20:23], s84 offen offset:1024 lds
    buffer_load_dwordx4 v242, s[20:23], s84 offen offset:2048 lds
    s_add_u32 s84, s92, 1081344
    s_add_u32 m0, s85, 45056
    s_nop 0
    buffer_load_dwordx4 v240, s[20:23], s84 offen offset:0 lds
    buffer_load_dwordx4 v241, s[20:23], s84 offen offset:1024 lds
    buffer_load_dwordx4 v242, s[20:23], s84 offen offset:2048 lds
    s_bfe_u32 s84, s2, 0x20003
    s_lshr_b32 s87, s2, 5
    s_add_u32 s85, s87, 8
    s_cmp_eq_u32 s84, 3
    s_cselect_b32 s87, s87, s85
    s_and_b32 s86, s2, 7
    s_mul_i32 s95, s62, 491520
    s_mul_i32 s85, s86, 160
    s_add_u32 s95, s95, s85
    s_mul_i32 s85, s87, 40960
    s_add_u32 s95, s95, s85
    s_mul_i32 s96, s62, 5120
    s_add_u32 s96, s96, 57344
    v_add_u32 v200, 0, v0
    v_mul_u32_u24 v200, 6554, v200
    v_lshrrev_b32 v200, 20, v200
    v_mad_u32_u24 v200, v200, s82, v0
    v_add_u32 v201, 1024, v0
    v_mul_u32_u24 v201, 6554, v201
    v_lshrrev_b32 v201, 20, v201
    v_mad_u32_u24 v201, v201, s82, v0
    v_add_u32 v202, 2048, v0
    v_mul_u32_u24 v202, 6554, v202
    v_lshrrev_b32 v202, 20, v202
    v_mad_u32_u24 v202, v202, s82, v0
    v_add_u32 v203, 3072, v0
    v_mul_u32_u24 v203, 6554, v203
    v_lshrrev_b32 v203, 20, v203
    v_mad_u32_u24 v203, v203, s82, v0
    v_add_u32 v204, 4096, v0
    v_mul_u32_u24 v204, 6554, v204
    v_lshrrev_b32 v204, 20, v204
    v_mad_u32_u24 v204, v204, s82, v0
    s_waitcnt vmcnt(6)
    v_readfirstlane_b32 s68, v11
    s_nop 0
    s_cmp_lg_u32 s68, 0
    s_cbranch_scc1 L_nd_48
L_nn_47:
    s_cmp_eq_u32 s72, 0
    s_cbranch_scc1 L_nd_48
    s_sub_u32 s72, s72, 1
    buffer_load_dword v11, v251, s[16:19], 0 offen sc1
    s_waitcnt vmcnt(0)
    v_readfirstlane_b32 s68, v11
    s_nop 0
    s_cmp_eq_u32 s68, 0
    s_cbranch_scc1 L_nn_47
L_nd_48:
    s_barrier
    s_lshl_b32 s90, s88, 6
    s_add_u32 s90, s90, 28573696
    v_mov_b32 v11, s68
    s_add_u32 s90, s90, s83
    s_mov_b64 exec, 15
    buffer_store_dword v11, v0, s[8:11], s90 offen sc1
    s_mov_b64 exec, -1
    s_bfe_u32 s84, s2, 0x20003
    s_lshr_b32 s90, s2, 5
    s_add_u32 s85, s90, 8
    s_cmp_eq_u32 s84, 3
    s_cselect_b32 s90, s90, s85
    s_lshl_b32 s90, s90, 1
    s_add_u32 s90, s90, s69
    s_add_u32 s90, s90, 144
    s_mul_i32 s90, s90, 3072
    s_and_b32 s84, s2, 3
    s_mul_i32 s84, s84, 768
    s_add_u32 s90, s90, s84
    v_lshrrev_b32 v248, 4, v0
    v_add_u32 v248, 0, v248
    v_mul_u32_u24 v249, 43691, v248
    v_lshrrev_b32 v249, 18, v249
    v_mul_u32_u24 v250, 6, v249
    v_sub_u32 v248, v248, v250
    v_lshlrev_b32 v248, 7, v248
    v_mul_u32_u24 v249, 73728, v249
    v_add_u32 v248, v248, v249
    s_mov_b32 exec_hi, 0xffff
    buffer_load_dword v252, v248, s[20:23], s90 offen
    s_mov_b64 exec, -1
    s_waitcnt vmcnt(2)
    s_barrier
    s_mul_i32 s84, s69, 12288
    s_add_u32 s84, s84, 52224
    v_subrev_u32 v2, s84, v243
    v_subrev_u32 v3, s84, v244
    ds_read_b64_tr_b16 v[152:153], v2 offset:0
    ds_read_b64_tr_b16 v[154:155], v2 offset:3072
    ds_read_b64_tr_b16 v[156:157], v2 offset:6144
    ds_read_b64_tr_b16 v[158:159], v2 offset:9216
    ds_read_b64_tr_b16 v[160:161], v3 offset:0
    ds_read_b64_tr_b16 v[162:163], v3 offset:3072
    ds_read_b64_tr_b16 v[164:165], v2 offset:12288
    ds_read_b64_tr_b16 v[166:167], v2 offset:15360
    ds_read_b64_tr_b16 v[168:169], v2 offset:18432
    ds_read_b64_tr_b16 v[170:171], v2 offset:21504
    ds_read_b64_tr_b16 v[172:173], v3 offset:12288
    ds_read_b64_tr_b16 v[174:175], v3 offset:15360
    s_mul_i32 s84, s94, 245760
    s_mul_i32 s85, s93, 24576
    s_add_u32 s84, s84, s85
    s_mul_i32 s85, s62, 3072
    s_add_u32 s84, s84, s85
    s_add_u32 s92, s84, 29483008
    s_waitcnt lgkmcnt(10)
    buffer_store_dwordx4 v[152:155], v0, s[8:11], s92 offen offset:0 sc1
    s_waitcnt lgkmcnt(8)
    buffer_store_dwordx4 v[156:159], v0, s[8:11], s92 offen offset:1024 sc1
    s_waitcnt lgkmcnt(6)
    buffer_store_dwordx4 v[160:163], v0, s[8:11], s92 offen offset:2048 sc1
    s_add_u32 s92, s92, 12288
    s_waitcnt lgkmcnt(4)
    buffer_store_dwordx4 v[164:167], v0, s[8:11], s92 offen offset:0 sc1
    s_waitcnt lgkmcnt(2)
    buffer_store_dwordx4 v[168:171], v0, s[8:11], s92 offen offset:1024 sc1
    s_waitcnt lgkmcnt(0)
    buffer_store_dwordx4 v[172:175], v0, s[8:11], s92 offen offset:2048 sc1
    s_add_u32 m0, s96, 0
    s_add_u32 s84, s95, 0
    buffer_load_dwordx4 v200, s[24:27], s84 offen offset:0 lds
    buffer_load_dwordx4 v201, s[24:27], s84 offen offset:1024 lds
    buffer_load_dwordx4 v202, s[24:27], s84 offen offset:2048 lds
    buffer_load_dwordx4 v203, s[24:27], s84 offen offset:3072 lds
    s_add_u32 m0, s96, 4096
    s_add_u32 s84, s95, 4096
    buffer_load_dwordx4 v204, s[24:27], s84 offen lds
    s_waitcnt vmcnt(5)
    s_barrier
    s_lshl_b32 s84, s94, 4
    s_add_u32 s84, s84, s93
    s_lshl_b32 s84, s84, 6
    s_add_u32 s84, s84, 28590592
    v_mov_b32 v11, s68
    s_add_u32 s84, s84, s83
    s_mov_b64 exec, 15
    buffer_store_dword v11, v0, s[8:11], s84 offen sc1
    s_mov_b64 exec, -1
    s_add_u32 s84, s98, 0
    s_add_u32 m0, s99, 24576
    s_nop 0
    buffer_load_dwordx4 v240, s[20:23], s84 offen offset:0 lds
    buffer_load_dwordx4 v241, s[20:23], s84 offen offset:1024 lds
    buffer_load_dwordx4 v242, s[20:23], s84 offen offset:2048 lds
    s_add_u32 s84, s98, 98304
    s_add_u32 m0, s99, 36864
    s_nop 0
    buffer_load_dwordx4 v240, s[20:23], s84 offen offset:0 lds
    buffer_load_dwordx4 v241, s[20:23], s84 offen offset:1024 lds
    buffer_load_dwordx4 v242, s[20:23], s84 offen offset:2048 lds
    s_add_u32 s84, s98, 196608
    s_add_u32 m0, s99, 49152
    s_nop 0
    buffer_load_dwordx4 v240, s[20:23], s84 offen offset:0 lds
    buffer_load_dwordx4 v241, s[20:23], s84 offen offset:1024 lds
    buffer_load_dwordx4 v242, s[20:23], s84 offen offset:2048 lds
    s_add_u32 s84, s98, 294912
    s_add_u32 m0, s99, 61440
    s_nop 0
    buffer_load_dwordx4 v240, s[20:23], s84 offen offset:0 lds
    buffer_load_dwordx4 v241, s[20:23], s84 offen offset:1024 lds
    buffer_load_dwordx4 v242, s[20:23], s84 offen offset:2048 lds
    s_branch L_nonconv
L_stats:
    s_lshl_b32 s88, s86, 1
    s_add_u32 s88, s88, s87
    v_lshrrev_b32 v1, 7, v0
    v_and_b32 v2, 0x70, v0
    v_mul_u32_u24 v3, 1280, v1
    v_add_u32 v3, v3, v2
    s_lshl_b32 s89, s88, 2
    s_add_u32 s89, s89, s62
    s_lshl_b32 s91, s89, 7
    s_mul_i32 s89, s89, 40960
    s_waitcnt lgkmcnt(0)
    s_or_b32 s90, s87, s62
    s_cmp_lg_u32 s90, 0
    s_cbranch_scc1 L_non_49
    s_mov_b32 s16, s58
    s_mov_b32 s17, s59
    s_mov_b32 s18, 256
    s_mov_b32 s19, 0x20000
    s_or_b32 s84, s84, 1
    v_mov_b32 v6, s84
    v_mov_b32 v7, 0
    v_lshlrev_b32 v4, 8, v0
    buffer_atomic_cmpswap v[6:7], v4, s[16:19], 0 offen sc1
L_non_49:
    s_mov_b32 s72, 60000
    s_mov_b32 s70, 0xffff0000
    s_mov_b32 s82, 1120
    s_cmp_eq_u32 s62, 0
    s_cselect_b32 s83, 0, 36175872
    s_lshr_b32 s65, s2, 5
    s_and_b32 s66, s2, 1
    s_lshl_b32 s64, s66, 3
    s_add_u32 s64, s64, s65
    s_bfe_u32 s63, s2, 0x20001
    s_lshl_b32 s63, s63, 2
    s_bfe_u32 s85, s2, 0x20003
    s_add_u32 s63, s63, s85
    s_and_b32 s1, s2, 3
    s_lshl_b32 s1, s1, 2
    s_bfe_u32 s84, s2, 0x20005
    s_add_u32 s1, s1, s84
    s_bfe_u32 s3, s2, 0x10002
    s_lshl_b32 s3, s3, 1
    s_lshr_b32 s84, s2, 7
    s_add_u32 s3, s3, s84
    s_lshl_b32 s3, s3, 2
    s_add_u32 s3, s3, s85
    s_mov_b32 s8, s60
    s_mov_b32 s9, s61
    s_mov_b32 s10, 36175872
    s_mov_b32 s11, 0x20000
    s_cmp_lt_u32 s62, 2
    s_cselect_b32 s20, s50, s52
    s_cselect_b32 s21, s51, s53
    s_mov_b32 s22, 1966080
    s_mov_b32 s23, 0x20000
    s_mov_b32 s24, s54
    s_mov_b32 s25, s55
    s_mov_b32 s26, 1966080
    s_mov_b32 s27, 0x20000
    s_mov_b32 s28, s56
    s_mov_b32 s29, s57
    s_mov_b32 s30, 2621440
    s_mov_b32 s31, 0x20000
    s_bfe_u32 s84, s2, 0x20003
    s_lshr_b32 s90, s2, 5
    s_add_u32 s85, s90, 8
    s_cmp_eq_u32 s84, 3
    s_cselect_b32 s90, s90, s85
    s_lshl_b32 s90, s90, 1
    s_add_u32 s90, s90, s69
    s_add_u32 s90, s90, 0
    s_mul_i32 s90, s90, 3072
    s_and_b32 s84, s2, 3
    s_mul_i32 s84, s84, 768
    s_add_u32 s90, s90, s84
    v_lshrrev_b32 v248, 4, v0
    v_add_u32 v248, 0, v248
    v_mul_u32_u24 v249, 43691, v248
    v_lshrrev_b32 v249, 18, v249
    v_mul_u32_u24 v250, 6, v249
    v_sub_u32 v248, v248, v250
    v_lshlrev_b32 v248, 7, v248
    v_mul_u32_u24 v249, 73728, v249
    v_add_u32 v248, v248, v249
    s_mov_b32 exec_hi, 0xf
    buffer_load_dword v252, v248, s[20:23], s90 offen
    s_mov_b64 exec, -1
    s_mov_b32 s12, s36
    s_mov_b32 s13, s37
    s_mov_b32 s14, 2621440
    s_mov_b32 s15, 0x20000
    buffer_load_dwordx4 v[16:19], v3, s[12:15], s89 offen offset:0
    buffer_load_dwordx4 v[20:23], v3, s[12:15], s89 offen offset:128
    buffer_load_dwordx4 v[24:27], v3, s[12:15], s89 offen offset:256
    buffer_load_dwordx4 v[28:31], v3, s[12:15], s89 offen offset:384
    buffer_load_dwordx4 v[32:35], v3, s[12:15], s89 offen offset:512
    buffer_load_dwordx4 v[36:39], v3, s[12:15], s89 offen offset:640
    buffer_load_dwordx4 v[40:43], v3, s[12:15], s89 offen offset:768
    buffer_load_dwordx4 v[44:47], v3, s[12:15], s89 offen offset:896
    buffer_load_dwordx4 v[48:51], v3, s[12:15], s89 offen offset:1024
    buffer_load_dwordx4 v[52:55], v3, s[12:15], s89 offen offset:1152
    s_add_u32 s89, s89, 10240
    buffer_load_dwordx4 v[56:59], v3, s[12:15], s89 offen offset:0
    buffer_load_dwordx4 v[60:63], v3, s[12:15], s89 offen offset:128
    buffer_load_dwordx4 v[64:67], v3, s[12:15], s89 offen offset:256
    buffer_load_dwordx4 v[68:71], v3, s[12:15], s89 offen offset:384
    buffer_load_dwordx4 v[72:75], v3, s[12:15], s89 offen offset:512
    buffer_load_dwordx4 v[76:79], v3, s[12:15], s89 offen offset:640
    buffer_load_dwordx4 v[80:83], v3, s[12:15], s89 offen offset:768
    buffer_load_dwordx4 v[84:87], v3, s[12:15], s89 offen offset:896
    buffer_load_dwordx4 v[88:91], v3, s[12:15], s89 offen offset:1024
    buffer_load_dwordx4 v[92:95], v3, s[12:15], s89 offen offset:1152
    s_add_u32 s89, s89, 10240
    buffer_load_dwordx4 v[96:99], v3, s[12:15], s89 offen offset:0
    buffer_load_dwordx4 v[100:103], v3, s[12:15], s89 offen offset:128
    buffer_load_dwordx4 v[104:107], v3, s[12:15], s89 offen offset:256
    buffer_load_dwordx4 v[108:111], v3, s[12:15], s89 offen offset:384
    buffer_load_dwordx4 v[112:115], v3, s[12:15], s89 offen offset:512
    buffer_load_dwordx4 v[116:119], v3, s[12:15], s89 offen offset:640
    buffer_load_dwordx4 v[120:123], v3, s[12:15], s89 offen offset:768
    buffer_load_dwordx4 v[124:127], v3, s[12:15], s89 offen offset:896
    buffer_load_dwordx4 v[128:131], v3, s[12:15], s89 offen offset:1024
    buffer_load_dwordx4 v[132:135], v3, s[12:15], s89 offen offset:1152
    s_add_u32 s89, s89, 10240
    buffer_load_dwordx4 v[136:139], v3, s[12:15], s89 offen offset:0
    buffer_load_dwordx4 v[140:143], v3, s[12:15], s89 offen offset:128
    buffer_load_dwordx4 v[144:147], v3, s[12:15], s89 offen offset:256
    buffer_load_dwordx4 v[148:151], v3, s[12:15], s89 offen offset:384
    buffer_load_dwordx4 v[152:155], v3, s[12:15], s89 offen offset:512
    buffer_load_dwordx4 v[156:159], v3, s[12:15], s89 offen offset:640
    buffer_load_dwordx4 v[160:163], v3, s[12:15], s89 offen offset:768
    buffer_load_dwordx4 v[164:167], v3, s[12:15], s89 offen offset:896
    buffer_load_dwordx4 v[168:171], v3, s[12:15], s89 offen offset:1024
    buffer_load_dwordx4 v[172:175], v3, s[12:15], s89 offen offset:1152
    v_lshrrev_b32 v240, 4, v0
    v_add_u32 v240, 0, v240
    v_mul_u32_u24 v245, 43691, v240
    v_lshrrev_b32 v245, 19, v245
    v_mul_u32_u24 v246, 12, v245
    v_sub_u32 v240, v240, v246
    v_bfe_u32 v246, v245, 2, 1
    v_xor_b32 v240, v240, v246
    v_lshlrev_b32 v240, 4, v240
    v_mul_u32_u24 v245, 3072, v245
    v_add_u32 v240, v240, v245
    v_lshrrev_b32 v241, 4, v0
    v_add_u32 v241, 64, v241
    v_mul_u32_u24 v245, 43691, v241
    v_lshrrev_b32 v245, 19, v245
    v_mul_u32_u24 v246, 12, v245
    v_sub_u32 v241, v241, v246
    v_bfe_u32 v246, v245, 2, 1
    v_xor_b32 v241, v241, v246
    v_lshlrev_b32 v241, 4, v241
    v_mul_u32_u24 v245, 3072, v245
    v_add_u32 v241, v241, v245
    v_subrev_u32 v241, 1024, v241
    v_lshrrev_b32 v242, 4, v0
    v_add_u32 v242, 128, v242
    v_mul_u32_u24 v245, 43691, v242
    v_lshrrev_b32 v245, 19, v245
    v_mul_u32_u24 v246, 12, v245
    v_sub_u32 v242, v242, v246
    v_bfe_u32 v246, v245, 2, 1
    v_xor_b32 v242, v242, v246
    v_lshlrev_b32 v242, 4, v242
    v_mul_u32_u24 v245, 3072, v245
    v_add_u32 v242, v242, v245
    v_subrev_u32 v242, 2048, v242
    s_mul_i32 s84, s69, 49152
    s_mul_i32 s85, s1, 192
    s_add_u32 s98, s84, s85
    s_mul_i32 s99, s62, 3072
    s_add_u32 s99, s99, 84992
    v_lshrrev_b32 v245, 6, v0
    v_mul_u32_u24 v245, 192, v245
    v_add_u32 v245, 84992, v245
    v_bfe_u32 v246, v0, 8, 1
    v_bfe_u32 v249, v0, 4, 1
    v_bfe_u32 v250, v0, 5, 1
    s_lshr_b32 s84, s62, 1
    s_lshl_b32 s85, s84, 2
    s_add_u32 s85, s85, s69
    v_lshl_add_u32 v243, v250, 1, s85
    v_xor_b32 v243, v243, v246
    v_lshlrev_b32 v243, 4, v243
    v_lshl_add_u32 v243, v249, 3, v243
    v_add_u32 v243, v243, v245
    s_add_u32 s84, s84, 8
    v_lshl_add_u32 v244, v249, 1, s84
    v_xor_b32 v244, v244, v246
    v_lshlrev_b32 v244, 4, v244
    s_lshl_b32 s85, s69, 3
    v_add_u32 v244, s85, v244
    v_mul_u32_u24 v250, 6144, v250
    v_add3_u32 v244, v244, v250, v245
    s_mul_i32 s84, s69, 12288
    s_sub_u32 s85, 12288, s84
    v_add_u32 v245, s85, v243
    v_add_u32 v243, s84, v243
    v_add_u32 v246, s85, v244
    v_add_u32 v244, s84, v244
    v_mov_b32 v12, 0x3f803f80
    v_mov_b32 v13, 0x3f803f80
    v_mov_b32 v14, 0x3f803f80
    v_mov_b32 v15, 0x3f803f80
    s_bfe_u32 s84, s2, 0x20003
    s_lshr_b32 s87, s2, 5
    s_add_u32 s85, s87, 8
    s_cmp_eq_u32 s84, 3
    s_cselect_b32 s87, s87, s85
    s_and_b32 s86, s2, 7
    s_mul_i32 s95, s62, 491520
    s_mul_i32 s85, s86, 160
    s_add_u32 s95, s95, s85
    s_mul_i32 s85, s87, 40960
    s_add_u32 s95, s95, s85
    s_mul_i32 s96, s62, 5120
    s_add_u32 s96, s96, 57344
    v_add_u32 v200, 0, v0
    v_mul_u32_u24 v200, 6554, v200
    v_lshrrev_b32 v200, 20, v200
    v_mad_u32_u24 v200, v200, s82, v0
    v_add_u32 v201, 1024, v0
    v_mul_u32_u24 v201, 6554, v201
    v_lshrrev_b32 v201, 20, v201
    v_mad_u32_u24 v201, v201, s82, v0
    v_add_u32 v202, 2048, v0
    v_mul_u32_u24 v202, 6554, v202
    v_lshrrev_b32 v202, 20, v202
    v_mad_u32_u24 v202, v202, s82, v0
    v_add_u32 v203, 3072, v0
    v_mul_u32_u24 v203, 6554, v203
    v_lshrrev_b32 v203, 20, v203
    v_mad_u32_u24 v203, v203, s82, v0
    v_add_u32 v204, 4096, v0
    v_mul_u32_u24 v204, 6554, v204
    v_lshrrev_b32 v204, 20, v204
    v_mad_u32_u24 v204, v204, s82, v0
    v_lshlrev_b32 v4, 1, v2
    v_lshl_add_u32 v4, v1, 2, v4
    v_and_b32 v5, 0x40, v0
    v_lshl_add_u32 v4, v5, 22, v4
    s_waitcnt vmcnt(39)
    v_dot2_f32_bf16 v6, v16, v12, 0
    v_dot2_f32_bf16 v7, v16, v16, 0
    v_dot2_f32_bf16 v6, v17, v12, v6
    v_dot2_f32_bf16 v7, v17, v17, v7
    v_dot2_f32_bf16 v6, v18, v12, v6
    v_dot2_f32_bf16 v7, v18, v18, v7
    v_dot2_f32_bf16 v6, v19, v12, v6
    v_dot2_f32_bf16 v7, v19, v19, v7
    s_waitcnt vmcnt(38)
    v_dot2_f32_bf16 v6, v20, v12, v6
    v_dot2_f32_bf16 v7, v20, v20, v7
    v_dot2_f32_bf16 v6, v21, v12, v6
    v_dot2_f32_bf16 v7, v21, v21, v7
    v_dot2_f32_bf16 v6, v22, v12, v6
    v_dot2_f32_bf16 v7, v22, v22, v7
    v_dot2_f32_bf16 v6, v23, v12, v6
    v_dot2_f32_bf16 v7, v23, v23, v7
    s_waitcnt vmcnt(37)
    v_dot2_f32_bf16 v6, v24, v12, v6
    v_dot2_f32_bf16 v7, v24, v24, v7
    v_dot2_f32_bf16 v6, v25, v12, v6
    v_dot2_f32_bf16 v7, v25, v25, v7
    v_dot2_f32_bf16 v6, v26, v12, v6
    v_dot2_f32_bf16 v7, v26, v26, v7
    v_dot2_f32_bf16 v6, v27, v12, v6
    v_dot2_f32_bf16 v7, v27, v27, v7
    s_waitcnt vmcnt(36)
    v_dot2_f32_bf16 v6, v28, v12, v6
    v_dot2_f32_bf16 v7, v28, v28, v7
    v_dot2_f32_bf16 v6, v29, v12, v6
    v_dot2_f32_bf16 v7, v29, v29, v7
    v_dot2_f32_bf16 v6, v30, v12, v6
    v_dot2_f32_bf16 v7, v30, v30, v7
    v_dot2_f32_bf16 v6, v31, v12, v6
    v_dot2_f32_bf16 v7, v31, v31, v7
    s_waitcnt vmcnt(35)
    v_dot2_f32_bf16 v6, v32, v12, v6
    v_dot2_f32_bf16 v7, v32, v32, v7
    v_dot2_f32_bf16 v6, v33, v12, v6
    v_dot2_f32_bf16 v7, v33, v33, v7
    v_dot2_f32_bf16 v6, v34, v12, v6
    v_dot2_f32_bf16 v7, v34, v34, v7
    v_dot2_f32_bf16 v6, v35, v12, v6
    v_dot2_f32_bf16 v7, v35, v35, v7
    s_waitcnt vmcnt(34)
    v_dot2_f32_bf16 v6, v36, v12, v6
    v_dot2_f32_bf16 v7, v36, v36, v7
    v_dot2_f32_bf16 v6, v37, v12, v6
    v_dot2_f32_bf16 v7, v37, v37, v7
    v_dot2_f32_bf16 v6, v38, v12, v6
    v_dot2_f32_bf16 v7, v38, v38, v7
    v_dot2_f32_bf16 v6, v39, v12, v6
    v_dot2_f32_bf16 v7, v39, v39, v7
    s_waitcnt vmcnt(33)
    v_dot2_f32_bf16 v6, v40, v12, v6
    v_dot2_f32_bf16 v7, v40, v40, v7
    v_dot2_f32_bf16 v6, v41, v12, v6
    v_dot2_f32_bf16 v7, v41, v41, v7
    v_dot2_f32_bf16 v6, v42, v12, v6
    v_dot2_f32_bf16 v7, v42, v42, v7
    v_dot2_f32_bf16 v6, v43, v12, v6
    v_dot2_f32_bf16 v7, v43, v43, v7
    s_waitcnt vmcnt(32)
    v_dot2_f32_bf16 v6, v44, v12, v6
    v_dot2_f32_bf16 v7, v44, v44, v7
    v_dot2_f32_bf16 v6, v45, v12, v6
    v_dot2_f32_bf16 v7, v45, v45, v7
    v_dot2_f32_bf16 v6, v46, v12, v6
    v_dot2_f32_bf16 v7, v46, v46, v7
    v_dot2_f32_bf16 v6, v47, v12, v6
    v_dot2_f32_bf16 v7, v47, v47, v7
    s_waitcnt vmcnt(31)
    v_dot2_f32_bf16 v6, v48, v12, v6
    v_dot2_f32_bf16 v7, v48, v48, v7
    v_dot2_f32_bf16 v6, v49, v12, v6
    v_dot2_f32_bf16 v7, v49, v49, v7
    v_dot2_f32_bf16 v6, v50, v12, v6
    v_dot2_f32_bf16 v7, v50, v50, v7
    v_dot2_f32_bf16 v6, v51, v12, v6
    v_dot2_f32_bf16 v7, v51, v51, v7
    s_waitcnt vmcnt(30)
    v_dot2_f32_bf16 v6, v52, v12, v6
    v_dot2_f32_bf16 v7, v52, v52, v7
    v_dot2_f32_bf16 v6, v53, v12, v6
    v_dot2_f32_bf16 v7, v53, v53, v7
    v_dot2_f32_bf16 v6, v54, v12, v6
    v_dot2_f32_bf16 v7, v54, v54, v7
    v_dot2_f32_bf16 v6, v55, v12, v6
    v_dot2_f32_bf16 v7, v55, v55, v7
    v_cmp_eq_u32 vcc, 0, v2
    s_nop 0
    v_add_f32_dpp v6, v6, v6 quad_perm:[1,0,3,2] row_mask:0xf bank_mask:0xf
    v_add_f32_dpp v7, v7, v7 quad_perm:[1,0,3,2] row_mask:0xf bank_mask:0xf
    s_nop 0
    v_add_f32_dpp v6, v6, v6 quad_perm:[2,3,0,1] row_mask:0xf bank_mask:0xf
    v_add_f32_dpp v7, v7, v7 quad_perm:[2,3,0,1] row_mask:0xf bank_mask:0xf
    s_nop 0
    v_add_f32_dpp v6, v6, v6 row_half_mirror row_mask:0xf bank_mask:0xf
    v_add_f32_dpp v7, v7, v7 row_half_mirror row_mask:0xf bank_mask:0xf
    v_mov_b32 v8, v6
    v_mov_b32 v9, v7
    s_waitcnt vmcnt(29)
    v_dot2_f32_bf16 v6, v56, v12, 0
    v_dot2_f32_bf16 v7, v56, v56, 0
    v_dot2_f32_bf16 v6, v57, v12, v6
    v_dot2_f32_bf16 v7, v57, v57, v7
    v_dot2_f32_bf16 v6, v58, v12, v6
    v_dot2_f32_bf16 v7, v58, v58, v7
    v_dot2_f32_bf16 v6, v59, v12, v6
    v_dot2_f32_bf16 v7, v59, v59, v7
    s_waitcnt vmcnt(28)
    v_dot2_f32_bf16 v6, v60, v12, v6
    v_dot2_f32_bf16 v7, v60, v60, v7
    v_dot2_f32_bf16 v6, v61, v12, v6
    v_dot2_f32_bf16 v7, v61, v61, v7
    v_dot2_f32_bf16 v6, v62, v12, v6
    v_dot2_f32_bf16 v7, v62, v62, v7
    v_dot2_f32_bf16 v6, v63, v12, v6
    v_dot2_f32_bf16 v7, v63, v63, v7
    s_waitcnt vmcnt(27)
    v_dot2_f32_bf16 v6, v64, v12, v6
    v_dot2_f32_bf16 v7, v64, v64, v7
    v_dot2_f32_bf16 v6, v65, v12, v6
    v_dot2_f32_bf16 v7, v65, v65, v7
    v_dot2_f32_bf16 v6, v66, v12, v6
    v_dot2_f32_bf16 v7, v66, v66, v7
    v_dot2_f32_bf16 v6, v67, v12, v6
    v_dot2_f32_bf16 v7, v67, v67, v7
    s_waitcnt vmcnt(26)
    v_dot2_f32_bf16 v6, v68, v12, v6
    v_dot2_f32_bf16 v7, v68, v68, v7
    v_dot2_f32_bf16 v6, v69, v12, v6
    v_dot2_f32_bf16 v7, v69, v69, v7
    v_dot2_f32_bf16 v6, v70, v12, v6
    v_dot2_f32_bf16 v7, v70, v70, v7
    v_dot2_f32_bf16 v6, v71, v12, v6
    v_dot2_f32_bf16 v7, v71, v71, v7
    s_waitcnt vmcnt(25)
    v_dot2_f32_bf16 v6, v72, v12, v6
    v_dot2_f32_bf16 v7, v72, v72, v7
    v_dot2_f32_bf16 v6, v73, v12, v6
    v_dot2_f32_bf16 v7, v73, v73, v7
    v_dot2_f32_bf16 v6, v74, v12, v6
    v_dot2_f32_bf16 v7, v74, v74, v7
    v_dot2_f32_bf16 v6, v75, v12, v6
    v_dot2_f32_bf16 v7, v75, v75, v7
    s_waitcnt vmcnt(24)
    v_dot2_f32_bf16 v6, v76, v12, v6
    v_dot2_f32_bf16 v7, v76, v76, v7
    v_dot2_f32_bf16 v6, v77, v12, v6
    v_dot2_f32_bf16 v7, v77, v77, v7
    v_dot2_f32_bf16 v6, v78, v12, v6
    v_dot2_f32_bf16 v7, v78, v78, v7
    v_dot2_f32_bf16 v6, v79, v12, v6
    v_dot2_f32_bf16 v7, v79, v79, v7
    s_waitcnt vmcnt(23)
    v_dot2_f32_bf16 v6, v80, v12, v6
    v_dot2_f32_bf16 v7, v80, v80, v7
    v_dot2_f32_bf16 v6, v81, v12, v6
    v_dot2_f32_bf16 v7, v81, v81, v7
    v_dot2_f32_bf16 v6, v82, v12, v6
    v_dot2_f32_bf16 v7, v82, v82, v7
    v_dot2_f32_bf16 v6, v83, v12, v6
    v_dot2_f32_bf16 v7, v83, v83, v7
    s_waitcnt vmcnt(22)
    v_dot2_f32_bf16 v6, v84, v12, v6
    v_dot2_f32_bf16 v7, v84, v84, v7
    v_dot2_f32_bf16 v6, v85, v12, v6
    v_dot2_f32_bf16 v7, v85, v85, v7
    v_dot2_f32_bf16 v6, v86, v12, v6
    v_dot2_f32_bf16 v7, v86, v86, v7
    v_dot2_f32_bf16 v6, v87, v12, v6
    v_dot2_f32_bf16 v7, v87, v87, v7
    s_waitcnt vmcnt(21)
    v_dot2_f32_bf16 v6, v88, v12, v6
    v_dot2_f32_bf16 v7, v88, v88, v7
    v_dot2_f32_bf16 v6, v89, v12, v6
    v_dot2_f32_bf16 v7, v89, v89, v7
    v_dot2_f32_bf16 v6, v90, v12, v6
    v_dot2_f32_bf16 v7, v90, v90, v7
    v_dot2_f32_bf16 v6, v91, v12, v6
    v_dot2_f32_bf16 v7, v91, v91, v7
    s_waitcnt vmcnt(20)
    v_dot2_f32_bf16 v6, v92, v12, v6
    v_dot2_f32_bf16 v7, v92, v92, v7
    v_dot2_f32_bf16 v6, v93, v12, v6
    v_dot2_f32_bf16 v7, v93, v93, v7
    v_dot2_f32_bf16 v6, v94, v12, v6
    v_dot2_f32_bf16 v7, v94, v94, v7
    v_dot2_f32_bf16 v6, v95, v12, v6
    v_dot2_f32_bf16 v7, v95, v95, v7
    v_cmp_eq_u32 vcc, 16, v2
    s_nop 0
    v_add_f32_dpp v6, v6, v6 quad_perm:[1,0,3,2] row_mask:0xf bank_mask:0xf
    v_add_f32_dpp v7, v7, v7 quad_perm:[1,0,3,2] row_mask:0xf bank_mask:0xf
    s_nop 0
    v_add_f32_dpp v6, v6, v6 quad_perm:[2,3,0,1] row_mask:0xf bank_mask:0xf
    v_add_f32_dpp v7, v7, v7 quad_perm:[2,3,0,1] row_mask:0xf bank_mask:0xf
    s_nop 0
    v_add_f32_dpp v6, v6, v6 row_half_mirror row_mask:0xf bank_mask:0xf
    v_add_f32_dpp v7, v7, v7 row_half_mirror row_mask:0xf bank_mask:0xf
    v_cndmask_b32 v8, v8, v6, vcc
    v_cndmask_b32 v9, v9, v7, vcc
    s_waitcnt vmcnt(19)
    v_dot2_f32_bf16 v6, v96, v12, 0
    v_dot2_f32_bf16 v7, v96, v96, 0
    v_dot2_f32_bf16 v6, v97, v12, v6
    v_dot2_f32_bf16 v7, v97, v97, v7
    v_dot2_f32_bf16 v6, v98, v12, v6
    v_dot2_f32_bf16 v7, v98, v98, v7
    v_dot2_f32_bf16 v6, v99, v12, v6
    v_dot2_f32_bf16 v7, v99, v99, v7
    s_waitcnt vmcnt(18)
    v_dot2_f32_bf16 v6, v100, v12, v6
    v_dot2_f32_bf16 v7, v100, v100, v7
    v_dot2_f32_bf16 v6, v101, v12, v6
    v_dot2_f32_bf16 v7, v101, v101, v7
    v_dot2_f32_bf16 v6, v102, v12, v6
    v_dot2_f32_bf16 v7, v102, v102, v7
    v_dot2_f32_bf16 v6, v103, v12, v6
    v_dot2_f32_bf16 v7, v103, v103, v7
    s_waitcnt vmcnt(17)
    v_dot2_f32_bf16 v6, v104, v12, v6
    v_dot2_f32_bf16 v7, v104, v104, v7
    v_dot2_f32_bf16 v6, v105, v12, v6
    v_dot2_f32_bf16 v7, v105, v105, v7
    v_dot2_f32_bf16 v6, v106, v12, v6
    v_dot2_f32_bf16 v7, v106, v106, v7
    v_dot2_f32_bf16 v6, v107, v12, v6
    v_dot2_f32_bf16 v7, v107, v107, v7
    s_waitcnt vmcnt(16)
    v_dot2_f32_bf16 v6, v108, v12, v6
    v_dot2_f32_bf16 v7, v108, v108, v7
    v_dot2_f32_bf16 v6, v109, v12, v6
    v_dot2_f32_bf16 v7, v109, v109, v7
    v_dot2_f32_bf16 v6, v110, v12, v6
    v_dot2_f32_bf16 v7, v110, v110, v7
    v_dot2_f32_bf16 v6, v111, v12, v6
    v_dot2_f32_bf16 v7, v111, v111, v7
    s_waitcnt vmcnt(15)
    v_dot2_f32_bf16 v6, v112, v12, v6
    v_dot2_f32_bf16 v7, v112, v112, v7
    v_dot2_f32_bf16 v6, v113, v12, v6
    v_dot2_f32_bf16 v7, v113, v113, v7
    v_dot2_f32_bf16 v6, v114, v12, v6
    v_dot2_f32_bf16 v7, v114, v114, v7
    v_dot2_f32_bf16 v6, v115, v12, v6
    v_dot2_f32_bf16 v7, v115, v115, v7
    s_waitcnt vmcnt(14)
    v_dot2_f32_bf16 v6, v116, v12, v6
    v_dot2_f32_bf16 v7, v116, v116, v7
    v_dot2_f32_bf16 v6, v117, v12, v6
    v_dot2_f32_bf16 v7, v117, v117, v7
    v_dot2_f32_bf16 v6, v118, v12, v6
    v_dot2_f32_bf16 v7, v118, v118, v7
    v_dot2_f32_bf16 v6, v119, v12, v6
    v_dot2_f32_bf16 v7, v119, v119, v7
    s_waitcnt vmcnt(13)
    v_dot2_f32_bf16 v6, v120, v12, v6
    v_dot2_f32_bf16 v7, v120, v120, v7
    v_dot2_f32_bf16 v6, v121, v12, v6
    v_dot2_f32_bf16 v7, v121, v121, v7
    v_dot2_f32_bf16 v6, v122, v12, v6
    v_dot2_f32_bf16 v7, v122, v122, v7
    v_dot2_f32_bf16 v6, v123, v12, v6
    v_dot2_f32_bf16 v7, v123, v123, v7
    s_waitcnt vmcnt(12)
    v_dot2_f32_bf16 v6, v124, v12, v6
    v_dot2_f32_bf16 v7, v124, v124, v7
    v_dot2_f32_bf16 v6, v125, v12, v6
    v_dot2_f32_bf16 v7, v125, v125, v7
    v_dot2_f32_bf16 v6, v126, v12, v6
    v_dot2_f32_bf16 v7, v126, v126, v7
    v_dot2_f32_bf16 v6, v127, v12, v6
    v_dot2_f32_bf16 v7, v127, v127, v7
    s_waitcnt vmcnt(11)
    v_dot2_f32_bf16 v6, v128, v12, v6
    v_dot2_f32_bf16 v7, v128, v128, v7
    v_dot2_f32_bf16 v6, v129, v12, v6
    v_dot2_f32_bf16 v7, v129, v129, v7
    v_dot2_f32_bf16 v6, v130, v12, v6
    v_dot2_f32_bf16 v7, v130, v130, v7
    v_dot2_f32_bf16 v6, v131, v12, v6
    v_dot2_f32_bf16 v7, v131, v131, v7
    s_waitcnt vmcnt(10)
    v_dot2_f32_bf16 v6, v132, v12, v6
    v_dot2_f32_bf16 v7, v132, v132, v7
    v_dot2_f32_bf16 v6, v133, v12, v6
    v_dot2_f32_bf16 v7, v133, v133, v7
    v_dot2_f32_bf16 v6, v134, v12, v6
    v_dot2_f32_bf16 v7, v134, v134, v7
    v_dot2_f32_bf16 v6, v135, v12, v6
    v_dot2_f32_bf16 v7, v135, v135, v7
    v_cmp_eq_u32 vcc, 32, v2
    s_nop 0
    v_add_f32_dpp v6, v6, v6 quad_perm:[1,0,3,2] row_mask:0xf bank_mask:0xf
    v_add_f32_dpp v7, v7, v7 quad_perm:[1,0,3,2] row_mask:0xf bank_mask:0xf
    s_nop 0
    v_add_f32_dpp v6, v6, v6 quad_perm:[2,3,0,1] row_mask:0xf bank_mask:0xf
    v_add_f32_dpp v7, v7, v7 quad_perm:[2,3,0,1] row_mask:0xf bank_mask:0xf
    s_nop 0
    v_add_f32_dpp v6, v6, v6 row_half_mirror row_mask:0xf bank_mask:0xf
    v_add_f32_dpp v7, v7, v7 row_half_mirror row_mask:0xf bank_mask:0xf
    v_cndmask_b32 v8, v8, v6, vcc
    v_cndmask_b32 v9, v9, v7, vcc
    s_waitcnt vmcnt(9)
    v_dot2_f32_bf16 v6, v136, v12, 0
    v_dot2_f32_bf16 v7, v136, v136, 0
    v_dot2_f32_bf16 v6, v137, v12, v6
    v_dot2_f32_bf16 v7, v137, v137, v7
    v_dot2_f32_bf16 v6, v138, v12, v6
    v_dot2_f32_bf16 v7, v138, v138, v7
    v_dot2_f32_bf16 v6, v139, v12, v6
    v_dot2_f32_bf16 v7, v139, v139, v7
    s_waitcnt vmcnt(8)
    v_dot2_f32_bf16 v6, v140, v12, v6
    v_dot2_f32_bf16 v7, v140, v140, v7
    v_dot2_f32_bf16 v6, v141, v12, v6
    v_dot2_f32_bf16 v7, v141, v141, v7
    v_dot2_f32_bf16 v6, v142, v12, v6
    v_dot2_f32_bf16 v7, v142, v142, v7
    v_dot2_f32_bf16 v6, v143, v12, v6
    v_dot2_f32_bf16 v7, v143, v143, v7
    s_waitcnt vmcnt(7)
    v_dot2_f32_bf16 v6, v144, v12, v6
    v_dot2_f32_bf16 v7, v144, v144, v7
    v_dot2_f32_bf16 v6, v145, v12, v6
    v_dot2_f32_bf16 v7, v145, v145, v7
    v_dot2_f32_bf16 v6, v146, v12, v6
    v_dot2_f32_bf16 v7, v146, v146, v7
    v_dot2_f32_bf16 v6, v147, v12, v6
    v_dot2_f32_bf16 v7, v147, v147, v7
    s_waitcnt vmcnt(6)
    v_dot2_f32_bf16 v6, v148, v12, v6
    v_dot2_f32_bf16 v7, v148, v148, v7
    v_dot2_f32_bf16 v6, v149, v12, v6
    v_dot2_f32_bf16 v7, v149, v149, v7
    v_dot2_f32_bf16 v6, v150, v12, v6
    v_dot2_f32_bf16 v7, v150, v150, v7
    v_dot2_f32_bf16 v6, v151, v12, v6
    v_dot2_f32_bf16 v7, v151, v151, v7
    s_waitcnt vmcnt(5)
    v_dot2_f32_bf16 v6, v152, v12, v6
    v_dot2_f32_bf16 v7, v152, v152, v7
    v_dot2_f32_bf16 v6, v153, v12, v6
    v_dot2_f32_bf16 v7, v153, v153, v7
    v_dot2_f32_bf16 v6, v154, v12, v6
    v_dot2_f32_bf16 v7, v154, v154, v7
    v_dot2_f32_bf16 v6, v155, v12, v6
    v_dot2_f32_bf16 v7, v155, v155, v7
    s_waitcnt vmcnt(4)
    v_dot2_f32_bf16 v6, v156, v12, v6
    v_dot2_f32_bf16 v7, v156, v156, v7
    v_dot2_f32_bf16 v6, v157, v12, v6
    v_dot2_f32_bf16 v7, v157, v157, v7
    v_dot2_f32_bf16 v6, v158, v12, v6
    v_dot2_f32_bf16 v7, v158, v158, v7
    v_dot2_f32_bf16 v6, v159, v12, v6
    v_dot2_f32_bf16 v7, v159, v159, v7
    s_waitcnt vmcnt(3)
    v_dot2_f32_bf16 v6, v160, v12, v6
    v_dot2_f32_bf16 v7, v160, v160, v7
    v_dot2_f32_bf16 v6, v161, v12, v6
    v_dot2_f32_bf16 v7, v161, v161, v7
    v_dot2_f32_bf16 v6, v162, v12, v6
    v_dot2_f32_bf16 v7, v162, v162, v7
    v_dot2_f32_bf16 v6, v163, v12, v6
    v_dot2_f32_bf16 v7, v163, v163, v7
    s_waitcnt vmcnt(2)
    v_dot2_f32_bf16 v6, v164, v12, v6
    v_dot2_f32_bf16 v7, v164, v164, v7
    v_dot2_f32_bf16 v6, v165, v12, v6
    v_dot2_f32_bf16 v7, v165, v165, v7
    v_dot2_f32_bf16 v6, v166, v12, v6
    v_dot2_f32_bf16 v7, v166, v166, v7
    v_dot2_f32_bf16 v6, v167, v12, v6
    v_dot2_f32_bf16 v7, v167, v167, v7
    s_waitcnt vmcnt(1)
    v_dot2_f32_bf16 v6, v168, v12, v6
    v_dot2_f32_bf16 v7, v168, v168, v7
    v_dot2_f32_bf16 v6, v169, v12, v6
    v_dot2_f32_bf16 v7, v169, v169, v7
    v_dot2_f32_bf16 v6, v170, v12, v6
    v_dot2_f32_bf16 v7, v170, v170, v7
    v_dot2_f32_bf16 v6, v171, v12, v6
    v_dot2_f32_bf16 v7, v171, v171, v7
    s_waitcnt vmcnt(0)
    v_dot2_f32_bf16 v6, v172, v12, v6
    v_dot2_f32_bf16 v7, v172, v172, v7
    v_dot2_f32_bf16 v6, v173, v12, v6
    v_dot2_f32_bf16 v7, v173, v173, v7
    v_dot2_f32_bf16 v6, v174, v12, v6
    v_dot2_f32_bf16 v7, v174, v174, v7
    v_dot2_f32_bf16 v6, v175, v12, v6
    v_dot2_f32_bf16 v7, v175, v175, v7
    v_cmp_eq_u32 vcc, 48, v2
    s_nop 0
    v_add_f32_dpp v6, v6, v6 quad_perm:[1,0,3,2] row_mask:0xf bank_mask:0xf
    v_add_f32_dpp v7, v7, v7 quad_perm:[1,0,3,2] row_mask:0xf bank_mask:0xf
    s_nop 0
    v_add_f32_dpp v6, v6, v6 quad_perm:[2,3,0,1] row_mask:0xf bank_mask:0xf
    v_add_f32_dpp v7, v7, v7 quad_perm:[2,3,0,1] row_mask:0xf bank_mask:0xf
    s_nop 0
    v_add_f32_dpp v6, v6, v6 row_half_mirror row_mask:0xf bank_mask:0xf
    v_add_f32_dpp v7, v7, v7 row_half_mirror row_mask:0xf bank_mask:0xf
    v_cndmask_b32 v8, v8, v6, vcc
    v_cndmask_b32 v9, v9, v7, vcc
    v_mul_f32 v8, 0xbacccccd, v8
    v_mov_b32 v6, 0x3727c5ac
    v_fmac_f32 v6, 0x3acccccd, v9
    v_fma_f32 v6, -v8, v8, v6
    v_max_f32 v6, 0x3727c5ac, v6
    v_rsq_f32 v6, v6
    s_add_u32 s91, s91, 5242880
    v_mul_f32 v7, v6, v8
    buffer_store_dword v6, v4, s[8:11], s91 offen sc1
    s_add_u32 s91, s91, 8192
    buffer_store_dword v7, v4, s[8:11], s91 offen sc1
    s_mov_b32 s16, s58
    s_mov_b32 s17, s59
    s_mov_b32 s18, 256
    s_mov_b32 s19, 0x20000
    v_mov_b32 v251, 0
    buffer_load_dword v11, v251, s[16:19], 0 offen sc1
    s_waitcnt vmcnt(0)
    v_readfirstlane_b32 s68, v11
    s_nop 0
    s_cmp_lg_u32 s68, 0
    s_cbranch_scc1 L_nd_51
L_nn_50:
    s_cmp_eq_u32 s72, 0
    s_cbranch_scc1 L_nd_51
    s_sub_u32 s72, s72, 1
    buffer_load_dword v11, v251, s[16:19], 0 offen sc1
    s_waitcnt vmcnt(0)
    v_readfirstlane_b32 s68, v11
    s_nop 0
    s_cmp_eq_u32 s68, 0
    s_cbranch_scc1 L_nn_50
L_nd_51:
    s_barrier
    s_lshl_b32 s90, s88, 6
    s_add_u32 s90, s90, 28327936
    v_mov_b32 v11, s68
    s_add_u32 s90, s90, s83
    s_mov_b64 exec, 15
    buffer_store_dword v11, v0, s[8:11], s90 offen sc1
    s_mov_b64 exec, -1
    s_add_u32 m0, s96, 0
    s_add_u32 s84, s95, 0
    buffer_load_dwordx4 v200, s[24:27], s84 offen offset:0 lds
    buffer_load_dwordx4 v201, s[24:27], s84 offen offset:1024 lds
    buffer_load_dwordx4 v202, s[24:27], s84 offen offset:2048 lds
    buffer_load_dwordx4 v203, s[24:27], s84 offen offset:3072 lds
    s_add_u32 m0, s96, 4096
    s_add_u32 s84, s95, 4096
    buffer_load_dwordx4 v204, s[24:27], s84 offen lds
    s_bfe_u32 s84, s2, 0x20003
    s_lshr_b32 s90, s2, 5
    s_add_u32 s85, s90, 8
    s_cmp_eq_u32 s84, 3
    s_cselect_b32 s90, s90, s85
    s_lshl_b32 s90, s90, 1
    s_add_u32 s90, s90, s69
    s_add_u32 s90, s90, 144
    s_mul_i32 s90, s90, 3072
    s_and_b32 s84, s2, 3
    s_mul_i32 s84, s84, 768
    s_add_u32 s90, s90, s84
    v_lshrrev_b32 v248, 4, v0
    v_add_u32 v248, 0, v248
    v_mul_u32_u24 v249, 43691, v248
    v_lshrrev_b32 v249, 18, v249
    v_mul_u32_u24 v250, 6, v249
    v_sub_u32 v248, v248, v250
    v_lshlrev_b32 v248, 7, v248
    v_mul_u32_u24 v249, 73728, v249
    v_add_u32 v248, v248, v249
    s_mov_b32 exec_hi, 0xffff
    buffer_load_dword v252, v248, s[20:23], s90 offen
    s_mov_b64 exec, -1
    s_add_u32 s84, s98, 0
    s_add_u32 m0, s99, 24576
    s_nop 0
    buffer_load_dwordx4 v240, s[20:23], s84 offen offset:0 lds
    buffer_load_dwordx4 v241, s[20:23], s84 offen offset:1024 lds
    buffer_load_dwordx4 v242, s[20:23], s84 offen offset:2048 lds
    s_add_u32 s84, s98, 98304
    s_add_u32 m0, s99, 36864
    s_nop 0
    buffer_load_dwordx4 v240, s[20:23], s84 offen offset:0 lds
    buffer_load_dwordx4 v241, s[20:23], s84 offen offset:1024 lds
    buffer_load_dwordx4 v242, s[20:23], s84 offen offset:2048 lds
    s_add_u32 s84, s98, 196608
    s_add_u32 m0, s99, 49152
    s_nop 0
    buffer_load_dwordx4 v240, s[20:23], s84 offen offset:0 lds
    buffer_load_dwordx4 v241, s[20:23], s84 offen offset:1024 lds
    buffer_load_dwordx4 v242, s[20:23], s84 offen offset:2048 lds
    s_add_u32 s84, s98, 294912
    s_add_u32 m0, s99, 61440
    s_nop 0
    buffer_load_dwordx4 v240, s[20:23], s84 offen offset:0 lds
    buffer_load_dwordx4 v241, s[20:23], s84 offen offset:1024 lds
    buffer_load_dwordx4 v242, s[20:23], s84 offen offset:2048 lds
L_nonconv:
    s_waitcnt vmcnt(12)
    v_lshrrev_b32 v1, 6, v0
    v_mul_u32_u24 v1, 160, v1
    v_bfe_u32 v2, v0, 4, 2
    v_lshl_add_u32 v1, v2, 3, v1
    v_add_u32 v1, s96, v1
    s_mul_i32 s84, s86, 245760
    s_mul_i32 s85, s62, 61440
    s_add_u32 s84, s84, s85
    s_mul_i32 s85, s87, 5120
    s_add_u32 s84, s84, s85
    s_add_u32 s89, s84, 33554432
    ds_read_b64_tr_b16 v[64:65], v1 offset:0
    ds_read_b64_tr_b16 v[66:67], v1 offset:2560
    ds_read_b64_tr_b16 v[68:69], v1 offset:32
    ds_read_b64_tr_b16 v[70:71], v1 offset:2592
    ds_read_b64_tr_b16 v[72:73], v1 offset:64
    ds_read_b64_tr_b16 v[74:75], v1 offset:2624
    ds_read_b64_tr_b16 v[76:77], v1 offset:96
    ds_read_b64_tr_b16 v[78:79], v1 offset:2656
    ds_read_b64_tr_b16 v[80:81], v1 offset:128
    ds_read_b64_tr_b16 v[82:83], v1 offset:2688
    s_waitcnt lgkmcnt(8)
    buffer_store_dwordx4 v[64:67], v0, s[8:11], s89 offen offset:0 sc1
    s_waitcnt lgkmcnt(6)
    buffer_store_dwordx4 v[68:71], v0, s[8:11], s89 offen offset:1024 sc1
    s_waitcnt lgkmcnt(4)
    buffer_store_dwordx4 v[72:75], v0, s[8:11], s89 offen offset:2048 sc1
    s_waitcnt lgkmcnt(2)
    buffer_store_dwordx4 v[76:79], v0, s[8:11], s89 offen offset:3072 sc1
    s_add_u32 s89, s89, 4096
    s_waitcnt lgkmcnt(0)
    buffer_store_dwordx4 v[80:83], v0, s[8:11], s89 offen offset:0 sc1
    s_add_u32 s84, s98, 393216
    s_add_u32 m0, s99, 0
    s_nop 0
    buffer_load_dwordx4 v240, s[20:23], s84 offen offset:0 lds
    buffer_load_dwordx4 v241, s[20:23], s84 offen offset:1024 lds
    buffer_load_dwordx4 v242, s[20:23], s84 offen offset:2048 lds
    s_add_u32 s84, s98, 491520
    s_add_u32 m0, s99, 12288
    s_nop 0
    buffer_load_dwordx4 v240, s[20:23], s84 offen offset:0 lds
    buffer_load_dwordx4 v241, s[20:23], s84 offen offset:1024 lds
    buffer_load_dwordx4 v242, s[20:23], s84 offen offset:2048 lds
    s_lshl_b32 s93, s1, 10
    s_add_u32 s93, s93, 28590592
    v_min_u32 v24, 304, v0
    buffer_load_dword v24, v24, s[8:11], s93 offen sc1
    s_waitcnt vmcnt(7)
    s_barrier
    s_lshl_b32 s84, s86, 4
    s_add_u32 s84, s84, s87
    s_lshl_b32 s84, s84, 6
    s_add_u32 s84, s84, 28606464
    v_mov_b32 v11, s68
    s_add_u32 s84, s84, s83
    s_mov_b64 exec, 15
    buffer_store_dword v11, v0, s[8:11], s84 offen sc1
    s_mov_b64 exec, -1
    ds_read_b64_tr_b16 a[0:1], v243 offset:24576
    ds_read_b64_tr_b16 a[2:3], v243 offset:27648
    ds_read_b64_tr_b16 a[4:5], v243 offset:30720
    ds_read_b64_tr_b16 a[6:7], v243 offset:33792
    ds_read_b64_tr_b16 a[8:9], v244 offset:24576
    ds_read_b64_tr_b16 a[10:11], v244 offset:27648
    ds_read_b64_tr_b16 a[60:61], v245 offset:24576
    ds_read_b64_tr_b16 a[62:63], v245 offset:27648
    ds_read_b64_tr_b16 a[64:65], v245 offset:30720
    ds_read_b64_tr_b16 a[66:67], v245 offset:33792
    ds_read_b64_tr_b16 a[68:69], v246 offset:24576
    ds_read_b64_tr_b16 a[70:71], v246 offset:27648
    s_waitcnt lgkmcnt(0)
    s_barrier
    ds_read_b64_tr_b16 a[12:13], v243 offset:49152
    ds_read_b64_tr_b16 a[14:15], v243 offset:52224
    ds_read_b64_tr_b16 a[16:17], v243 offset:55296
    ds_read_b64_tr_b16 a[18:19], v243 offset:58368
    ds_read_b64_tr_b16 a[20:21], v244 offset:49152
    ds_read_b64_tr_b16 a[22:23], v244 offset:52224
    ds_read_b64_tr_b16 a[72:73], v245 offset:49152
    ds_read_b64_tr_b16 a[74:75], v245 offset:52224
    ds_read_b64_tr_b16 a[76:77], v245 offset:55296
    ds_read_b64_tr_b16 a[78:79], v245 offset:58368
    ds_read_b64_tr_b16 a[80:81], v246 offset:49152
    ds_read_b64_tr_b16 a[82:83], v246 offset:52224
    s_add_u32 s84, s98, 589824
    s_add_u32 m0, s99, 24576
    s_nop 0
    buffer_load_dwordx4 v240, s[20:23], s84 offen offset:0 lds
    v_mfma_f32_16x16x32_bf16 v[28:31], a[0:3], v[12:15], 0
    buffer_load_dwordx4 v241, s[20:23], s84 offen offset:1024 lds
    v_mfma_f32_16x16x32_bf16 v[32:35], a[4:7], v[12:15], 0
    buffer_load_dwordx4 v242, s[20:23], s84 offen offset:2048 lds
    v_mfma_f32_16x16x32_bf16 v[36:39], a[8:11], v[12:15], 0
    s_add_u32 s84, s98, 688128
    s_add_u32 m0, s99, 36864
    s_nop 0
    buffer_load_dwordx4 v240, s[20:23], s84 offen offset:0 lds
    v_mfma_f32_16x16x32_bf16 v[28:31], a[60:63], v[12:15], v[28:31]
    buffer_load_dwordx4 v241, s[20:23], s84 offen offset:1024 lds
    v_mfma_f32_16x16x32_bf16 v[32:35], a[64:67], v[12:15], v[32:35]
    buffer_load_dwordx4 v242, s[20:23], s84 offen offset:2048 lds
    v_mfma_f32_16x16x32_bf16 v[36:39], a[68:71], v[12:15], v[36:39]
    s_waitcnt vmcnt(8) lgkmcnt(0)
    s_barrier
    ds_read_b64_tr_b16 a[24:25], v243 offset:0
    ds_read_b64_tr_b16 a[26:27], v243 offset:3072
    ds_read_b64_tr_b16 a[28:29], v243 offset:6144
    ds_read_b64_tr_b16 a[30:31], v243 offset:9216
    ds_read_b64_tr_b16 a[32:33], v244 offset:0
    ds_read_b64_tr_b16 a[34:35], v244 offset:3072
    ds_read_b64_tr_b16 a[84:85], v245 offset:0
    ds_read_b64_tr_b16 a[86:87], v245 offset:3072
    ds_read_b64_tr_b16 a[88:89], v245 offset:6144
    ds_read_b64_tr_b16 a[90:91], v245 offset:9216
    ds_read_b64_tr_b16 a[92:93], v246 offset:0
    ds_read_b64_tr_b16 a[94:95], v246 offset:3072
    s_add_u32 s84, s98, 786432
    s_add_u32 m0, s99, 49152
    s_nop 0
    buffer_load_dwordx4 v240, s[20:23], s84 offen offset:0 lds
    v_mfma_f32_16x16x32_bf16 v[28:31], a[12:15], v[12:15], v[28:31]
    buffer_load_dwordx4 v241, s[20:23], s84 offen offset:1024 lds
    v_mfma_f32_16x16x32_bf16 v[32:35], a[16:19], v[12:15], v[32:35]
    buffer_load_dwordx4 v242, s[20:23], s84 offen offset:2048 lds
    v_mfma_f32_16x16x32_bf16 v[36:39], a[20:23], v[12:15], v[36:39]
    s_add_u32 s84, s98, 884736
    s_add_u32 m0, s99, 61440
    s_nop 0
    buffer_load_dwordx4 v240, s[20:23], s84 offen offset:0 lds
    v_mfma_f32_16x16x32_bf16 v[28:31], a[72:75], v[12:15], v[28:31]
    buffer_load_dwordx4 v241, s[20:23], s84 offen offset:1024 lds
    v_mfma_f32_16x16x32_bf16 v[32:35], a[76:79], v[12:15], v[32:35]
    buffer_load_dwordx4 v242, s[20:23], s84 offen offset:2048 lds
    v_mfma_f32_16x16x32_bf16 v[36:39], a[80:83], v[12:15], v[36:39]
    s_mul_i32 s98, s1, 245760
    s_mul_i32 s84, s62, 3072
    s_add_u32 s98, s98, s84
    s_add_u32 s98, s98, 29360128
    s_mul_i32 s84, s69, 12288
    s_add_u32 s99, s98, 12288
    s_sub_u32 s99, s99, s84
    s_add_u32 s98, s98, s84
    s_waitcnt vmcnt(13)
    v_cmp_ne_u32 vcc, s68, v24
    s_cbranch_vccz L_pd_53
L_pl_52:
    s_cmp_eq_u32 s72, 0
    s_cbranch_scc1 L_pd_53
    s_sub_u32 s72, s72, 1
    v_min_u32 v24, 304, v0
    buffer_load_dword v24, v24, s[8:11], s93 offen sc1
    s_waitcnt vmcnt(0)
    v_cmp_ne_u32 vcc, s68, v24
    s_cbranch_vccnz L_pl_52
L_pd_53:
    s_add_u32 s86, s98, 122880
    buffer_load_dwordx4 a[120:123], v0, s[8:11], s86 offen offset:0 sc1
    buffer_load_dwordx4 a[124:127], v0, s[8:11], s86 offen offset:1024 sc1
    buffer_load_dwordx4 a[128:131], v0, s[8:11], s86 offen offset:2048 sc1
    s_add_u32 s86, s98, 147456
    buffer_load_dwordx4 a[132:135], v0, s[8:11], s86 offen offset:0 sc1
    buffer_load_dwordx4 a[136:139], v0, s[8:11], s86 offen offset:1024 sc1
    buffer_load_dwordx4 a[140:143], v0, s[8:11], s86 offen offset:2048 sc1
    s_add_u32 s86, s98, 172032
    buffer_load_dwordx4 a[144:147], v0, s[8:11], s86 offen offset:0 sc1
    buffer_load_dwordx4 a[148:151], v0, s[8:11], s86 offen offset:1024 sc1
    buffer_load_dwordx4 a[152:155], v0, s[8:11], s86 offen offset:2048 sc1
    s_waitcnt vmcnt(15) lgkmcnt(0)
    s_barrier
    ds_read_b64_tr_b16 a[36:37], v243 offset:24576
    ds_read_b64_tr_b16 a[38:39], v243 offset:27648
    ds_read_b64_tr_b16 a[40:41], v243 offset:30720
    ds_read_b64_tr_b16 a[42:43], v243 offset:33792
    ds_read_b64_tr_b16 a[44:45], v244 offset:24576
    ds_read_b64_tr_b16 a[46:47], v244 offset:27648
    ds_read_b64_tr_b16 a[96:97], v245 offset:24576
    ds_read_b64_tr_b16 a[98:99], v245 offset:27648
    ds_read_b64_tr_b16 a[100:101], v245 offset:30720
    ds_read_b64_tr_b16 a[102:103], v245 offset:33792
    ds_read_b64_tr_b16 a[104:105], v246 offset:24576
    ds_read_b64_tr_b16 a[106:107], v246 offset:27648
    v_mfma_f32_16x16x32_bf16 v[28:31], a[24:27], v[12:15], v[28:31]
    v_mfma_f32_16x16x32_bf16 v[32:35], a[28:31], v[12:15], v[32:35]
    v_mfma_f32_16x16x32_bf16 v[36:39], a[32:35], v[12:15], v[36:39]
    v_mfma_f32_16x16x32_bf16 v[28:31], a[84:87], v[12:15], v[28:31]
    v_mfma_f32_16x16x32_bf16 v[32:35], a[88:91], v[12:15], v[32:35]
    v_mfma_f32_16x16x32_bf16 v[36:39], a[92:95], v[12:15], v[36:39]
    s_add_u32 s86, s98, 196608
    buffer_load_dwordx4 a[156:159], v0, s[8:11], s86 offen offset:0 sc1
    buffer_load_dwordx4 a[160:163], v0, s[8:11], s86 offen offset:1024 sc1
    buffer_load_dwordx4 a[164:167], v0, s[8:11], s86 offen offset:2048 sc1
    s_add_u32 s86, s98, 221184
    buffer_load_dwordx4 a[168:171], v0, s[8:11], s86 offen offset:0 sc1
    buffer_load_dwordx4 a[172:175], v0, s[8:11], s86 offen offset:1024 sc1
    buffer_load_dwordx4 a[176:179], v0, s[8:11], s86 offen offset:2048 sc1
    s_add_u32 s86, s99, 122880
    buffer_load_dwordx4 a[180:183], v0, s[8:11], s86 offen offset:0 sc1
    buffer_load_dwordx4 a[184:187], v0, s[8:11], s86 offen offset:1024 sc1
    buffer_load_dwordx4 a[188:191], v0, s[8:11], s86 offen offset:2048 sc1
    s_waitcnt vmcnt(18) lgkmcnt(0)
    s_barrier
    ds_read_b64_tr_b16 a[48:49], v243 offset:49152
    ds_read_b64_tr_b16 a[50:51], v243 offset:52224
    ds_read_b64_tr_b16 a[52:53], v243 offset:55296
    ds_read_b64_tr_b16 a[54:55], v243 offset:58368
    ds_read_b64_tr_b16 a[56:57], v244 offset:49152
    ds_read_b64_tr_b16 a[58:59], v244 offset:52224
    ds_read_b64_tr_b16 a[108:109], v245 offset:49152
    ds_read_b64_tr_b16 a[110:111], v245 offset:52224
    ds_read_b64_tr_b16 a[112:113], v245 offset:55296
    ds_read_b64_tr_b16 a[114:115], v245 offset:58368
    ds_read_b64_tr_b16 a[116:117], v246 offset:49152
    ds_read_b64_tr_b16 a[118:119], v246 offset:52224
    v_mfma_f32_16x16x32_bf16 v[28:31], a[36:39], v[12:15], v[28:31]
    v_mfma_f32_16x16x32_bf16 v[32:35], a[40:43], v[12:15], v[32:35]
    v_mfma_f32_16x16x32_bf16 v[36:39], a[44:47], v[12:15], v[36:39]
    v_mfma_f32_16x16x32_bf16 v[28:31], a[96:99], v[12:15], v[28:31]
    v_mfma_f32_16x16x32_bf16 v[32:35], a[100:103], v[12:15], v[32:35]
    v_mfma_f32_16x16x32_bf16 v[36:39], a[104:107], v[12:15], v[36:39]
    s_add_u32 s86, s99, 147456
    buffer_load_dwordx4 a[192:195], v0, s[8:11], s86 offen offset:0 sc1
    buffer_load_dwordx4 a[196:199], v0, s[8:11], s86 offen offset:1024 sc1
    buffer_load_dwordx4 a[200:203], v0, s[8:11], s86 offen offset:2048 sc1
    s_add_u32 s86, s99, 172032
    buffer_load_dwordx4 a[204:207], v0, s[8:11], s86 offen offset:0 sc1
    buffer_load_dwordx4 a[208:211], v0, s[8:11], s86 offen offset:1024 sc1
    buffer_load_dwordx4 a[212:215], v0, s[8:11], s86 offen offset:2048 sc1
    s_add_u32 s86, s99, 196608
    buffer_load_dwordx4 a[216:219], v0, s[8:11], s86 offen offset:0 sc1
    buffer_load_dwordx4 a[220:223], v0, s[8:11], s86 offen offset:1024 sc1
    buffer_load_dwordx4 a[224:227], v0, s[8:11], s86 offen offset:2048 sc1
    s_add_u32 s86, s99, 221184
    buffer_load_dwordx4 a[228:231], v0, s[8:11], s86 offen offset:0 sc1
    buffer_load_dwordx4 a[232:235], v0, s[8:11], s86 offen offset:1024 sc1
    buffer_load_dwordx4 a[236:239], v0, s[8:11], s86 offen offset:2048 sc1
    s_waitcnt lgkmcnt(10)
    v_mfma_f32_16x16x32_bf16 v[28:31], a[48:51], v[12:15], v[28:31]
    s_waitcnt lgkmcnt(8)
    v_mfma_f32_16x16x32_bf16 v[32:35], a[52:55], v[12:15], v[32:35]
    s_waitcnt lgkmcnt(6)
    v_mfma_f32_16x16x32_bf16 v[36:39], a[56:59], v[12:15], v[36:39]
    s_waitcnt lgkmcnt(4)
    v_mfma_f32_16x16x32_bf16 v[28:31], a[108:111], v[12:15], v[28:31]
    s_waitcnt lgkmcnt(2)
    v_mfma_f32_16x16x32_bf16 v[32:35], a[112:115], v[12:15], v[32:35]
    s_waitcnt lgkmcnt(0)
    v_mfma_f32_16x16x32_bf16 v[36:39], a[116:119], v[12:15], v[36:39]
    s_waitcnt vmcnt(29)
    v_mfma_f32_16x16x32_bf16 v[28:31], a[120:123], v[12:15], v[28:31]
    s_waitcnt vmcnt(28)
    v_mfma_f32_16x16x32_bf16 v[32:35], a[124:127], v[12:15], v[32:35]
    s_waitcnt vmcnt(27)
    v_mfma_f32_16x16x32_bf16 v[36:39], a[128:131], v[12:15], v[36:39]
    s_waitcnt vmcnt(26)
    v_mfma_f32_16x16x32_bf16 v[28:31], a[132:135], v[12:15], v[28:31]
    s_waitcnt vmcnt(25)
    v_mfma_f32_16x16x32_bf16 v[32:35], a[136:139], v[12:15], v[32:35]
    s_waitcnt vmcnt(24)
    v_mfma_f32_16x16x32_bf16 v[36:39], a[140:143], v[12:15], v[36:39]
    s_waitcnt vmcnt(23)
    v_mfma_f32_16x16x32_bf16 v[28:31], a[144:147], v[12:15], v[28:31]
    s_waitcnt vmcnt(22)
    v_mfma_f32_16x16x32_bf16 v[32:35], a[148:151], v[12:15], v[32:35]
    s_waitcnt vmcnt(21)
    v_mfma_f32_16x16x32_bf16 v[36:39], a[152:155], v[12:15], v[36:39]
    s_waitcnt vmcnt(20)
    v_mfma_f32_16x16x32_bf16 v[28:31], a[156:159], v[12:15], v[28:31]
    s_waitcnt vmcnt(19)
    v_mfma_f32_16x16x32_bf16 v[32:35], a[160:163], v[12:15], v[32:35]
    s_waitcnt vmcnt(18)
    v_mfma_f32_16x16x32_bf16 v[36:39], a[164:167], v[12:15], v[36:39]
    s_waitcnt vmcnt(17)
    v_mfma_f32_16x16x32_bf16 v[28:31], a[168:171], v[12:15], v[28:31]
    s_waitcnt vmcnt(16)
    v_mfma_f32_16x16x32_bf16 v[32:35], a[172:175], v[12:15], v[32:35]
    s_waitcnt vmcnt(15)
    v_mfma_f32_16x16x32_bf16 v[36:39], a[176:179], v[12:15], v[36:39]
    s_waitcnt vmcnt(14)
    v_mfma_f32_16x16x32_bf16 v[28:31], a[180:183], v[12:15], v[28:31]
    s_waitcnt vmcnt(13)
    v_mfma_f32_16x16x32_bf16 v[32:35], a[184:187], v[12:15], v[32:35]
    s_waitcnt vmcnt(12)
    v_mfma_f32_16x16x32_bf16 v[36:39], a[188:191], v[12:15], v[36:39]
    s_waitcnt vmcnt(11)
    v_mfma_f32_16x16x32_bf16 v[28:31], a[192:195], v[12:15], v[28:31]
    s_waitcnt vmcnt(10)
    v_mfma_f32_16x16x32_bf16 v[32:35], a[196:199], v[12:15], v[32:35]
    s_waitcnt vmcnt(9)
    v_mfma_f32_16x16x32_bf16 v[36:39], a[200:203], v[12:15], v[36:39]
    s_waitcnt vmcnt(8)
    v_mfma_f32_16x16x32_bf16 v[28:31], a[204:207], v[12:15], v[28:31]
    s_waitcnt vmcnt(7)
    v_mfma_f32_16x16x32_bf16 v[32:35], a[208:211], v[12:15], v[32:35]
    s_waitcnt vmcnt(6)
    v_mfma_f32_16x16x32_bf16 v[36:39], a[212:215], v[12:15], v[36:39]
    s_waitcnt vmcnt(5)
    v_mfma_f32_16x16x32_bf16 v[28:31], a[216:219], v[12:15], v[28:31]
    s_waitcnt vmcnt(4)
    v_mfma_f32_16x16x32_bf16 v[32:35], a[220:223], v[12:15], v[32:35]
    s_waitcnt vmcnt(3)
    v_mfma_f32_16x16x32_bf16 v[36:39], a[224:227], v[12:15], v[36:39]
    s_waitcnt vmcnt(2)
    v_mfma_f32_16x16x32_bf16 v[28:31], a[228:231], v[12:15], v[28:31]
    s_waitcnt vmcnt(1)
    v_mfma_f32_16x16x32_bf16 v[32:35], a[232:235], v[12:15], v[32:35]
    s_waitcnt vmcnt(0)
    v_mfma_f32_16x16x32_bf16 v[36:39], a[236:239], v[12:15], v[36:39]
    s_mul_i32 s91, s62, 2560
    s_add_u32 s91, s91, 28344320
    v_min_u32 v11, 624, v0
    v_lshlrev_b32 v11, 2, v11
    buffer_load_dword v11, v11, s[8:11], s91 offen sc1
    s_lshl_b32 s93, s65, 10
    s_add_u32 s93, s93, 28606464
    v_min_u32 v24, 752, v0
    buffer_load_dword v24, v24, s[8:11], s93 offen sc1
    v_bfe_u32 v5, v0, 8, 1
    v_lshlrev_b32 v5, 5, v5
    v_xor_b32 v5, v5, v0
    s_mul_i32 s84, s62, 5120
    s_mul_i32 s73, s3, 81920
    s_add_u32 s73, s73, s84
    s_add_u32 s73, s73, 7864320
    s_mul_i32 s97, s62, 5120
    s_waitcnt vmcnt(0)
    v_cmp_ne_u32 vcc, s68, v24
    s_cbranch_vccz L_pd_55
L_pl_54:
    s_cmp_eq_u32 s72, 0
    s_cbranch_scc1 L_pd_55
    s_sub_u32 s72, s72, 1
    v_min_u32 v24, 752, v0
    buffer_load_dword v24, v24, s[8:11], s93 offen sc1
    s_waitcnt vmcnt(0)
    v_cmp_ne_u32 vcc, s68, v24
    s_cbranch_vccnz L_pl_54
L_pd_55:
    v_cmp_ne_u32 vcc, s68, v11
    s_cbranch_vccz L_pd_57
L_pl_56:
    s_cmp_eq_u32 s72, 0
    s_cbranch_scc1 L_pd_57
    s_sub_u32 s72, s72, 1
    v_min_u32 v11, 624, v0
    v_lshlrev_b32 v11, 2, v11
    buffer_load_dword v11, v11, s[8:11], s91 offen sc1
    s_waitcnt vmcnt(0)
    v_cmp_ne_u32 vcc, s68, v11
    s_cbranch_vccnz L_pl_56
L_pd_57:
    s_barrier
    s_add_u32 m0, s97, 0
    s_add_u32 s84, s73, 0
    buffer_load_dwordx4 v5, s[8:11], s84 offen offset:0 sc1 lds
    buffer_load_dwordx4 v5, s[8:11], s84 offen offset:1024 sc1 lds
    buffer_load_dwordx4 v5, s[8:11], s84 offen offset:2048 sc1 lds
    buffer_load_dwordx4 v5, s[8:11], s84 offen offset:3072 sc1 lds
    s_add_u32 m0, s97, 4096
    s_add_u32 s84, s73, 4096
    buffer_load_dwordx4 v5, s[8:11], s84 offen sc1 lds
    s_add_u32 m0, s97, 20480
    s_add_u32 s84, s73, 20480
    buffer_load_dwordx4 v5, s[8:11], s84 offen offset:0 sc1 lds
    buffer_load_dwordx4 v5, s[8:11], s84 offen offset:1024 sc1 lds
    buffer_load_dwordx4 v5, s[8:11], s84 offen offset:2048 sc1 lds
    buffer_load_dwordx4 v5, s[8:11], s84 offen offset:3072 sc1 lds
    s_add_u32 m0, s97, 24576
    s_add_u32 s84, s73, 24576
    buffer_load_dwordx4 v5, s[8:11], s84 offen sc1 lds
    s_waitcnt vmcnt(0) lgkmcnt(0)
    s_branch L_gemm
L_code_end:
.section .rodata,"a"
.p2align 6
.amdhsa_kernel interleave_layers__ssm_conv_h3__glu_gated_reglu__prompt_kernel
  .amdhsa_next_free_vgpr 512
  .amdhsa_next_free_sgpr 102
  .amdhsa_accum_offset 256
  .amdhsa_group_segment_fixed_size 0
  .amdhsa_kernarg_size 104
  .amdhsa_user_sgpr_count 2
  .amdhsa_user_sgpr_kernarg_segment_ptr 1
  .amdhsa_system_sgpr_workgroup_id_x 1
  .amdhsa_float_denorm_mode_32 3
.end_amdhsa_kernel
```
